```python
import torch

def _softmax(x, axis=-1):
    return torch.softmax(x, dim=axis)
def _gelu(x):
    return torch.nn.functional.gelu(x, approximate="tanh")
def _silu(x):
    return torch.nn.functional.silu(x)
def _sigmoid(x):
    return torch.sigmoid(x)
def _layernorm(x, axis=-1, eps=1e-5):
    m = x.mean(dim=axis, keepdim=True)
    v = x.var(dim=axis, keepdim=True, unbiased=False)
    return (x - m) / torch.sqrt(v + eps)
def _scatter_add(tgt, idx, src, axis=0):
    return tgt.clone().index_add_(axis, idx, src)
def _segment_sum(src, seg, n):
    out = torch.zeros((n,) + src.shape[1:], dtype=src.dtype)
    return out.index_add_(0, seg, src)
def _pad(x, pw):
    flat = tuple(v for pair in reversed(pw) for v in pair)
    return torch.nn.functional.pad(x, flat)

kernel_name = 'interleave_layers__grouped_kv_mqa__glu_gated_bilinear__prompt'

def setup_inputs():

    _w = (lambda a: (lambda t: t.to(torch.bfloat16) if t.is_floating_point() else t)(torch.as_tensor(a)))
    def _A_setup():
        B, S, D, H = 1, 2048, 448, 16
        Dh = D // H
        return {
            "x": _w((lambda *s: torch.randn(*s, dtype=torch.bfloat16) * 0.05)(B, S, D)),
            "wq": _w((lambda *s: torch.randn(*s, dtype=torch.bfloat16) * 0.05)(D, H * Dh)),
            "wk": _w((lambda *s: torch.randn(*s, dtype=torch.bfloat16) * 0.05)(D, Dh)),
            "wv": _w((lambda *s: torch.randn(*s, dtype=torch.bfloat16) * 0.05)(D, Dh)),
            "wo": _w((lambda *s: torch.randn(*s, dtype=torch.bfloat16) * 0.05)(H * Dh, D)),
        }
    _A_in = _A_setup()

    def _B_setup():
        B, S, D, F = 1, 2048, 448, 1792
        return {
            "x": _w((lambda *s: torch.randn(*s, dtype=torch.bfloat16) * 0.05)(B, S, D)),
            "w_gate": _w((lambda *s: torch.randn(*s, dtype=torch.bfloat16) * 0.4)(D, F) * (D ** -0.5)),
            "w_up": _w((lambda *s: torch.randn(*s, dtype=torch.bfloat16) * 0.4)(D, F) * (D ** -0.5)),
            "w_down": _w((lambda *s: torch.randn(*s, dtype=torch.bfloat16) * 0.4)(F, D) * (F ** -0.5)),
        }
    _B_in = _B_setup()

    return {
        "A_x": _A_in["x"],
        "A_wq": _A_in["wq"],
        "A_wk": _A_in["wk"],
        "A_wv": _A_in["wv"],
        "A_wo": _A_in["wo"],
        "B_x": _B_in["x"],
        "B_w_gate": _B_in["w_gate"],
        "B_w_up": _B_in["w_up"],
        "B_w_down": _B_in["w_down"],
    }

def reference(A_x, A_wq, A_wk, A_wv, A_wo, B_x, B_w_gate, B_w_up, B_w_down):
    def _A_ref(x, wq, wk, wv, wo):
        B, S, D = x.shape
        H = 16
        Dh = D // H
        q = (lambda x, *d: x.permute(*d))((x @ wq).reshape(B, S, H, Dh), 0, 2, 1, 3)
        k = x @ wk
        v = x @ wv
        scores = torch.einsum("bhqd,bkd->bhqk", q, k) * (Dh ** -0.5)
        p = _softmax(scores, axis=-1)
        o = torch.einsum("bhqk,bkd->bhqd", p, v)
        return (lambda x, *d: x.permute(*d))(o, 0, 2, 1, 3).reshape(B, S, H * Dh) @ wo

    def _B_ref(x, w_gate, w_up, w_down):
        g = torch.einsum("bsd,df->bsf", x, w_gate)
        u = torch.einsum("bsd,df->bsf", x, w_up)
        h = g * u
        return torch.einsum("bsf,fd->bsd", h, w_down)

    x = A_x
    x = x + _A_ref(_layernorm(x, axis=-1), A_wq, A_wk, A_wv, A_wo)
    x = x + _B_ref(_layernorm(x, axis=-1), B_w_gate, B_w_up, B_w_down)
    x = x + _A_ref(_layernorm(x, axis=-1), A_wq, A_wk, A_wv, A_wo)
    x = x + _B_ref(_layernorm(x, axis=-1), B_w_gate, B_w_up, B_w_down)
    return x
```

```asm
; @launch kernel=pq_kernel grid=(256,1,1) block=(448,1,1) lds=160000
; @launch kernel=main0_kernel grid=(256,1,1) block=(256,1,1) lds=163840
.amdgcn_target "amdgcn-amd-amdhsa--gfx950"
.text
.globl pq_kernel
.p2align 8
.type pq_kernel,@function
pq_kernel:
    s_cmp_ge_u32 s2, 256
    s_cbranch_scc1 pq_end
    s_load_dwordx8 s[4:11], s[0:1], 8
    s_load_dwordx2 s[44:45], s[0:1], 0
    s_load_dwordx2 s[18:19], s[0:1], 88
    s_load_dwordx4 s[12:15], s[0:1], 48
    s_load_dwordx2 s[16:17], s[0:1], 64
    v_lshrrev_b32 v1, 6, v0
    v_and_b32 v2, 63, v0
    s_getpc_b64 s[40:41]
pq_pc:
    v_lshlrev_b32 v11, 7, v0
    v_min_u32 v11, main0_kernel - pq_pc - 4, v11
    global_load_dword v255, v11, s[40:41]
    v_readfirstlane_b32 s3, v1
    v_lshlrev_b32 v3, 4, v2
    v_add_u32 v3, 157696, v3
    v_mov_b32 v4, -1
    v_mov_b32 v5, -1
    v_mov_b32 v6, -1
    v_mov_b32 v7, -1
    v_lshlrev_b32 v8, 2, v2
    v_min_u32 v8, 28, v8
    v_add_u32 v8, 159744, v8
    v_mov_b32 v9, 0
    ds_write_b128 v3, v[4:7]
    ds_write_b32 v8, v9
    s_waitcnt lgkmcnt(0)
    s_barrier
    s_cmp_eq_u32 s3, 2
    s_cbranch_scc1 pq_x
    s_cmp_gt_u32 s3, 2
    s_cbranch_scc1 pq_q
    s_waitcnt lgkmcnt(0)
    s_mov_b32 s45, 0
    v_and_b32 v3, 15, v0
    v_bfe_u32 v4, v0, 4, 2
    v_lshlrev_b32 v6, 4, v2
    v_and_b32 v8, 3, v3
    v_and_b32 v7, 12, v3
    v_lshl_add_u32 v5, v7, 1, v8
    v_and_b32 v7, 4, v3
    v_lshl_or_b32 v8, v7, 1, v8
    v_and_b32 v7, 8, v3
    v_lshrrev_b32 v7, 1, v7
    v_or_b32 v8, v8, v7
    v_add_u32 v9, 16, v8
    v_and_b32 v7, 1, v4
    v_lshlrev_b32 v7, 9, v7
    v_lshl_add_u32 v7, v3, 4, v7
    v_lshrrev_b32 v10, 1, v4
    s_mov_b32 s28, s18
    s_and_b32 s29, s19, 0xffff
    s_mov_b32 s30, 268435456
    s_mov_b32 s31, 0x20000
    s_mov_b32 s27, 0x20000
    s_and_b32 s32, s2, 7
    s_lshr_b32 s33, s2, 5
    s_lshl_b32 s33, s33, 1
    s_bfe_u32 s34, s2, 0x10003
    s_add_u32 s38, s33, s34
    s_mov_b32 s41, 1.0
    s_mov_b32 s43, 1
    s_mov_b32 s22, 64
    s_bitcmp1_b32 s2, 4
    s_cbranch_scc1 pr_wgu
    s_lshl_b32 s33, s38, 3
    s_add_u32 s39, s32, s33
    s_mov_b32 s33, 896
    s_mov_b32 s26, 401408
    s_cmp_lt_u32 s39, 18
    s_cbranch_scc1 pr_qkv
    s_mov_b32 s43, 0
    s_cmp_lt_u32 s38, 3
    s_cbranch_scc1 pq_end
    s_cmp_lt_u32 s38, 5
    s_cbranch_scc1 pr_wo
    s_cmp_ge_u32 s38, 12
    s_cbranch_scc1 pr_flags
    s_mul_i32 s32, s32, 7
    s_add_u32 s32, s32, s38
    s_sub_u32 s32, s32, 5
    s_mul_i32 s38, s32, 4682
    s_lshr_b32 s38, s38, 16
    s_mul_i32 s39, s38, 14
    s_sub_u32 s39, s32, s39
    s_lshl_b32 s38, s38, 1
    s_add_u32 s38, s38, s3
    s_mov_b32 s24, s16
    s_and_b32 s25, s17, 0xffff
    s_mov_b32 s26, 1605632
    s_mul_i32 s34, s38, 200704
    s_lshl_b32 s35, s39, 6
    s_add_u32 s34, s34, s35
    s_lshr_b32 s35, s39, 1
    s_mul_i32 s35, s35, 229376
    s_and_b32 s39, s39, 1
    s_lshl_b32 s39, s39, 10
    s_add_u32 s35, s35, s39
    s_mul_i32 s38, s38, 28672
    s_add_u32 s35, s35, s38
    s_add_u32 s35, s35, 4325376
    s_mov_b32 s20, 2048
    s_branch pr_std
pr_wo:
    s_sub_u32 s38, s38, 3
    s_lshl_b32 s38, s38, 3
    s_add_u32 s32, s32, s38
    s_lshl_b32 s32, s32, 1
    s_add_u32 s32, s32, s3
    s_mul_i32 s32, s32, 7
    s_and_b32 s22, s32, 15
    s_mul_i32 s34, s22, 25088
    s_lshr_b32 s35, s32, 4
    s_lshl_b32 s35, s35, 6
    s_add_u32 s34, s34, s35
    s_mov_b32 s24, s10
    s_and_b32 s25, s11, 0xffff
    s_lshl_b32 s35, s32, 11
    s_add_u32 s35, s35, 524288
    s_add_u32 s37, s35, 256
    v_and_b32 v11, 1, v4
    v_lshlrev_b32 v11, 10, v11
    v_lshl_add_u32 v11, v10, 9, v11
    v_lshl_add_u32 v11, v3, 4, v11
    v_mov_b32 v12, v11
    s_mov_b32 s36, 2048
    s_mov_b32 s42, 2048
    s_branch pr_go
pr_qkv:
    s_mul_i32 s35, s39, 28672
    s_mul_i32 s38, s3, 14336
    s_add_u32 s35, s35, s38
    s_add_u32 s35, s35, 0
    s_mov_b32 s20, 1024
    s_mov_b32 s24, s4
    s_and_b32 s25, s5, 0xffff
    s_mul_i32 s34, s39, 56
    s_mov_b32 s41, 0x3e8b97f6
    s_cmp_lt_u32 s39, 16
    s_cbranch_scc1 pr_q
    s_mov_b32 s41, 1.0
    s_mov_b32 s33, 56
    s_mov_b32 s34, 0
    s_mov_b32 s26, 25088
    s_mov_b32 s24, s6
    s_and_b32 s25, s7, 0xffff
    s_mov_b32 s45, 1
    s_cmp_eq_u32 s39, 16
    s_cbranch_scc1 pr_q
    s_mov_b32 s45, 0
    s_mov_b32 s24, s8
    s_and_b32 s25, s9, 0xffff
    v_and_b32 v8, 3, v3
    v_lshrrev_b32 v9, 3, v3
    v_lshl_add_u32 v8, v9, 2, v8
    v_bfe_u32 v9, v3, 2, 1
    v_lshl_add_u32 v8, v9, 4, v8
    v_add_u32 v9, 8, v8
pr_q:
    s_mul_i32 s38, s33, 224
    s_mul_i32 s38, s38, s3
    s_add_u32 s34, s34, s38
    v_cmp_gt_u32 vcc, 28, v9
    v_mov_b32 v11, 64
    s_nop 0
    v_cndmask_b32 v9, v11, v9, vcc
pr_std:
    s_add_u32 s37, s35, 256
    s_mov_b32 s21, s20
    s_branch pr_fin
pr_wgu:
    s_cmp_ge_u32 s38, 14
    s_cbranch_scc1 pr_code
    s_and_b32 s39, s38, 1
    s_cselect_b32 s24, s14, s12
    s_cselect_b32 s25, s15, s13
    s_and_b32 s25, s25, 0xffff
    s_mov_b32 s26, 1605632
    s_mov_b32 s33, 3584
    s_mul_i32 s32, s32, 14
    s_and_b32 s38, s38, 14
    s_add_u32 s32, s32, s38
    s_mul_i32 s34, s3, 802816
    s_lshl_b32 s38, s32, 5
    s_add_u32 s34, s34, s38
    s_lshl_b32 s39, s39, 8
    s_add_u32 s39, s39, 1048576
    s_add_u32 s40, s32, 0
    s_mul_i32 s38, s40, 9363
    s_lshr_b32 s38, s38, 16
    s_mul_i32 s35, s38, 200704
    s_mul_i32 s38, s38, 7
    s_sub_u32 s38, s40, s38
    s_mov_b32 s20, 3072
    s_mov_b32 s40, 0
    s_cmp_ge_u32 s38, 3
    s_cselect_b32 s20, 2048, s20
    s_cselect_b32 s40, 82944, s40
    s_cmp_ge_u32 s38, 5
    s_cselect_b32 s20, 2048, s20
    s_cselect_b32 s40, 138240, s40
    s_add_u32 s35, s35, s40
    s_lshl_b32 s38, s38, 10
    s_add_u32 s35, s35, s38
    s_mul_i32 s38, s20, 14
    s_mul_i32 s38, s38, s3
    s_add_u32 s35, s35, s38
    s_add_u32 s35, s35, s39
    s_add_u32 s40, s32, 1
    s_mul_i32 s38, s40, 9363
    s_lshr_b32 s38, s38, 16
    s_mul_i32 s37, s38, 200704
    s_mul_i32 s38, s38, 7
    s_sub_u32 s38, s40, s38
    s_mov_b32 s21, 3072
    s_mov_b32 s40, 0
    s_cmp_ge_u32 s38, 3
    s_cselect_b32 s21, 2048, s21
    s_cselect_b32 s40, 82944, s40
    s_cmp_ge_u32 s38, 5
    s_cselect_b32 s21, 2048, s21
    s_cselect_b32 s40, 138240, s40
    s_add_u32 s37, s37, s40
    s_lshl_b32 s38, s38, 10
    s_add_u32 s37, s37, s38
    s_mul_i32 s38, s21, 14
    s_mul_i32 s38, s38, s3
    s_add_u32 s37, s37, s38
    s_add_u32 s37, s37, s39
pr_fin:
    v_mad_u32_u24 v11, v10, s20, v7
    v_mad_u32_u24 v12, v10, s21, v7
    s_lshl_b32 s36, s20, 1
    s_lshl_b32 s42, s21, 1
pr_go:
    s_nop 1
    v_mov_b32 v252, 159768
    s_mov_b32 s23, 200000
ls0:
    s_sleep 2
    ds_read_b32 v248, v252
    s_sub_u32 s23, s23, 1
    s_cmp_eq_u32 s23, 0
    s_waitcnt lgkmcnt(0)
    s_cbranch_scc1 ls_out0
    v_cmp_ne_u32 vcc, 1, v248
    s_cbranch_vccnz ls0
ls_out0:
    v_mul_lo_u32 v5, v5, s33
    v_lshl_add_u32 v5, v4, 4, v5
    s_lshl_b32 s38, s33, 2
    v_add_u32 v7, s38, v5
    s_lshl_b32 s33, s33, 5
    s_cmp_lt_u32 s22, 16
    s_cselect_b32 s33, 25088, s33
    s_cselect_b32 s38, 12, 16
    v_cmp_le_u32 vcc, s38, v3
    v_mov_b32 v13, 0x7fffff00
    s_nop 0
    v_cndmask_b32 v7, v7, v13, vcc
    buffer_load_dwordx4 v[16:19], v5, s[24:27], s34 offen
    buffer_load_dwordx4 v[20:23], v7, s[24:27], s34 offen
    s_add_u32 s34, s34, s33
    s_add_u32 s22, s22, 1
    s_cmp_eq_u32 s22, 16
    s_cselect_b32 s23, 0xfff9e040, 0
    s_add_u32 s34, s34, s23
    buffer_load_dwordx4 v[24:27], v5, s[24:27], s34 offen
    buffer_load_dwordx4 v[28:31], v7, s[24:27], s34 offen
    s_add_u32 s34, s34, s33
    s_add_u32 s22, s22, 1
    s_cmp_eq_u32 s22, 16
    s_cselect_b32 s23, 0xfff9e040, 0
    s_add_u32 s34, s34, s23
    buffer_load_dwordx4 v[32:35], v5, s[24:27], s34 offen
    buffer_load_dwordx4 v[36:39], v7, s[24:27], s34 offen
    s_add_u32 s34, s34, s33
    s_add_u32 s22, s22, 1
    s_cmp_eq_u32 s22, 16
    s_cselect_b32 s23, 0xfff9e040, 0
    s_add_u32 s34, s34, s23
    buffer_load_dwordx4 v[40:43], v5, s[24:27], s34 offen
    buffer_load_dwordx4 v[44:47], v7, s[24:27], s34 offen
    s_add_u32 s34, s34, s33
    s_add_u32 s22, s22, 1
    s_cmp_eq_u32 s22, 16
    s_cselect_b32 s23, 0xfff9e040, 0
    s_add_u32 s34, s34, s23
    buffer_load_dwordx4 v[48:51], v5, s[24:27], s34 offen
    buffer_load_dwordx4 v[52:55], v7, s[24:27], s34 offen
    s_add_u32 s34, s34, s33
    s_add_u32 s22, s22, 1
    s_cmp_eq_u32 s22, 16
    s_cselect_b32 s23, 0xfff9e040, 0
    s_add_u32 s34, s34, s23
    buffer_load_dwordx4 v[56:59], v5, s[24:27], s34 offen
    buffer_load_dwordx4 v[60:63], v7, s[24:27], s34 offen
    s_add_u32 s34, s34, s33
    s_add_u32 s22, s22, 1
    s_cmp_eq_u32 s22, 16
    s_cselect_b32 s23, 0xfff9e040, 0
    s_add_u32 s34, s34, s23
    buffer_load_dwordx4 v[64:67], v5, s[24:27], s34 offen
    buffer_load_dwordx4 v[68:71], v7, s[24:27], s34 offen
    s_lshl_b32 s38, s3, 2
    s_add_u32 s38, s38, 159760
    v_mov_b32 v250, s38
    v_mov_b32 v251, 1
    v_mov_b32 v252, 159760
    v_mov_b32 v15, 0x3f80
    v_lshlrev_b32 v14, 2, v4
    v_and_b32 v13, 1, v8
    v_lshlrev_b32 v13, 4, v13
    v_lshlrev_b32 v13, v13, v15
    v_lshrrev_b32 v10, 1, v8
    v_sub_u32 v10, v10, v14
    v_cmp_eq_u32 vcc, 0, v10
    s_nop 1
    v_cndmask_b32 v72, 0, v13, vcc
    v_cmp_eq_u32 vcc, 1, v10
    s_nop 1
    v_cndmask_b32 v73, 0, v13, vcc
    v_cmp_eq_u32 vcc, 2, v10
    s_nop 1
    v_cndmask_b32 v74, 0, v13, vcc
    v_cmp_eq_u32 vcc, 3, v10
    s_nop 1
    v_cndmask_b32 v75, 0, v13, vcc
    v_and_b32 v13, 1, v9
    v_lshlrev_b32 v13, 4, v13
    v_lshlrev_b32 v13, v13, v15
    v_lshrrev_b32 v10, 1, v9
    v_sub_u32 v10, v10, v14
    v_cmp_eq_u32 vcc, 0, v10
    s_nop 1
    v_cndmask_b32 v76, 0, v13, vcc
    v_cmp_eq_u32 vcc, 1, v10
    s_nop 1
    v_cndmask_b32 v77, 0, v13, vcc
    v_cmp_eq_u32 vcc, 2, v10
    s_nop 1
    v_cndmask_b32 v78, 0, v13, vcc
    v_cmp_eq_u32 vcc, 3, v10
    s_nop 1
    v_cndmask_b32 v79, 0, v13, vcc
    s_cmp_eq_u32 s43, 1
    s_cbranch_scc1 pr_center
    s_waitcnt vmcnt(12)
    v_mfma_f32_16x16x32_bf16 v[80:83], v[16:19], v[72:75], 0
    v_mfma_f32_16x16x32_bf16 v[84:87], v[20:23], v[72:75], 0
    v_mfma_f32_16x16x32_bf16 v[88:91], v[16:19], v[76:79], 0
    v_mfma_f32_16x16x32_bf16 v[92:95], v[20:23], v[76:79], 0
    s_waitcnt vmcnt(10)
    v_mfma_f32_16x16x32_bf16 v[96:99], v[24:27], v[72:75], 0
    v_mfma_f32_16x16x32_bf16 v[100:103], v[28:31], v[72:75], 0
    v_mfma_f32_16x16x32_bf16 v[104:107], v[24:27], v[76:79], 0
    v_mfma_f32_16x16x32_bf16 v[108:111], v[28:31], v[76:79], 0
    v_cvt_pk_bf16_f32 v16, v80, v81
    v_cvt_pk_bf16_f32 v17, v82, v83
    v_cvt_pk_bf16_f32 v18, v84, v85
    v_cvt_pk_bf16_f32 v19, v86, v87
    buffer_store_dwordx4 v[16:19], v11, s[28:31], s35 offen
    v_cvt_pk_bf16_f32 v20, v88, v89
    v_cvt_pk_bf16_f32 v21, v90, v91
    v_cvt_pk_bf16_f32 v22, v92, v93
    v_cvt_pk_bf16_f32 v23, v94, v95
    buffer_store_dwordx4 v[20:23], v12, s[28:31], s37 offen
    s_add_u32 s35, s35, s36
    s_add_u32 s37, s37, s42
    s_waitcnt vmcnt(10)
    v_mfma_f32_16x16x32_bf16 v[112:115], v[32:35], v[72:75], 0
    v_mfma_f32_16x16x32_bf16 v[116:119], v[36:39], v[72:75], 0
    v_mfma_f32_16x16x32_bf16 v[120:123], v[32:35], v[76:79], 0
    v_mfma_f32_16x16x32_bf16 v[124:127], v[36:39], v[76:79], 0
    v_cvt_pk_bf16_f32 v24, v96, v97
    v_cvt_pk_bf16_f32 v25, v98, v99
    v_cvt_pk_bf16_f32 v26, v100, v101
    v_cvt_pk_bf16_f32 v27, v102, v103
    buffer_store_dwordx4 v[24:27], v11, s[28:31], s35 offen
    v_cvt_pk_bf16_f32 v28, v104, v105
    v_cvt_pk_bf16_f32 v29, v106, v107
    v_cvt_pk_bf16_f32 v30, v108, v109
    v_cvt_pk_bf16_f32 v31, v110, v111
    buffer_store_dwordx4 v[28:31], v12, s[28:31], s37 offen
    s_add_u32 s35, s35, s36
    s_add_u32 s37, s37, s42
    s_waitcnt vmcnt(10)
    v_mfma_f32_16x16x32_bf16 v[128:131], v[40:43], v[72:75], 0
    v_mfma_f32_16x16x32_bf16 v[132:135], v[44:47], v[72:75], 0
    v_mfma_f32_16x16x32_bf16 v[136:139], v[40:43], v[76:79], 0
    v_mfma_f32_16x16x32_bf16 v[140:143], v[44:47], v[76:79], 0
    v_cvt_pk_bf16_f32 v32, v112, v113
    v_cvt_pk_bf16_f32 v33, v114, v115
    v_cvt_pk_bf16_f32 v34, v116, v117
    v_cvt_pk_bf16_f32 v35, v118, v119
    buffer_store_dwordx4 v[32:35], v11, s[28:31], s35 offen
    v_cvt_pk_bf16_f32 v36, v120, v121
    v_cvt_pk_bf16_f32 v37, v122, v123
    v_cvt_pk_bf16_f32 v38, v124, v125
    v_cvt_pk_bf16_f32 v39, v126, v127
    buffer_store_dwordx4 v[36:39], v12, s[28:31], s37 offen
    s_add_u32 s35, s35, s36
    s_add_u32 s37, s37, s42
    s_waitcnt vmcnt(10)
    v_mfma_f32_16x16x32_bf16 v[144:147], v[48:51], v[72:75], 0
    v_mfma_f32_16x16x32_bf16 v[148:151], v[52:55], v[72:75], 0
    v_mfma_f32_16x16x32_bf16 v[152:155], v[48:51], v[76:79], 0
    v_mfma_f32_16x16x32_bf16 v[156:159], v[52:55], v[76:79], 0
    v_cvt_pk_bf16_f32 v40, v128, v129
    v_cvt_pk_bf16_f32 v41, v130, v131
    v_cvt_pk_bf16_f32 v42, v132, v133
    v_cvt_pk_bf16_f32 v43, v134, v135
    buffer_store_dwordx4 v[40:43], v11, s[28:31], s35 offen
    v_cvt_pk_bf16_f32 v44, v136, v137
    v_cvt_pk_bf16_f32 v45, v138, v139
    v_cvt_pk_bf16_f32 v46, v140, v141
    v_cvt_pk_bf16_f32 v47, v142, v143
    buffer_store_dwordx4 v[44:47], v12, s[28:31], s37 offen
    s_add_u32 s35, s35, s36
    s_add_u32 s37, s37, s42
    s_waitcnt vmcnt(10)
    v_mfma_f32_16x16x32_bf16 v[160:163], v[56:59], v[72:75], 0
    v_mfma_f32_16x16x32_bf16 v[164:167], v[60:63], v[72:75], 0
    v_mfma_f32_16x16x32_bf16 v[168:171], v[56:59], v[76:79], 0
    v_mfma_f32_16x16x32_bf16 v[172:175], v[60:63], v[76:79], 0
    v_cvt_pk_bf16_f32 v48, v144, v145
    v_cvt_pk_bf16_f32 v49, v146, v147
    v_cvt_pk_bf16_f32 v50, v148, v149
    v_cvt_pk_bf16_f32 v51, v150, v151
    buffer_store_dwordx4 v[48:51], v11, s[28:31], s35 offen
    v_cvt_pk_bf16_f32 v52, v152, v153
    v_cvt_pk_bf16_f32 v53, v154, v155
    v_cvt_pk_bf16_f32 v54, v156, v157
    v_cvt_pk_bf16_f32 v55, v158, v159
    buffer_store_dwordx4 v[52:55], v12, s[28:31], s37 offen
    s_add_u32 s35, s35, s36
    s_add_u32 s37, s37, s42
    s_waitcnt vmcnt(10)
    v_mfma_f32_16x16x32_bf16 v[176:179], v[64:67], v[72:75], 0
    v_mfma_f32_16x16x32_bf16 v[180:183], v[68:71], v[72:75], 0
    v_mfma_f32_16x16x32_bf16 v[184:187], v[64:67], v[76:79], 0
    v_mfma_f32_16x16x32_bf16 v[188:191], v[68:71], v[76:79], 0
    v_cvt_pk_bf16_f32 v56, v160, v161
    v_cvt_pk_bf16_f32 v57, v162, v163
    v_cvt_pk_bf16_f32 v58, v164, v165
    v_cvt_pk_bf16_f32 v59, v166, v167
    buffer_store_dwordx4 v[56:59], v11, s[28:31], s35 offen
    v_cvt_pk_bf16_f32 v60, v168, v169
    v_cvt_pk_bf16_f32 v61, v170, v171
    v_cvt_pk_bf16_f32 v62, v172, v173
    v_cvt_pk_bf16_f32 v63, v174, v175
    buffer_store_dwordx4 v[60:63], v12, s[28:31], s37 offen
    s_add_u32 s35, s35, s36
    s_add_u32 s37, s37, s42
    v_cvt_pk_bf16_f32 v64, v176, v177
    v_cvt_pk_bf16_f32 v65, v178, v179
    v_cvt_pk_bf16_f32 v66, v180, v181
    v_cvt_pk_bf16_f32 v67, v182, v183
    buffer_store_dwordx4 v[64:67], v11, s[28:31], s35 offen
    v_cvt_pk_bf16_f32 v68, v184, v185
    v_cvt_pk_bf16_f32 v69, v186, v187
    v_cvt_pk_bf16_f32 v70, v188, v189
    v_cvt_pk_bf16_f32 v71, v190, v191
    buffer_store_dwordx4 v[68:71], v12, s[28:31], s37 offen
    s_endpgm
pr_center:
    s_waitcnt vmcnt(12)
    v_mfma_f32_16x16x32_bf16 v[192:195], v[16:19], v[72:75], 0
    v_mfma_f32_16x16x32_bf16 v[196:199], v[16:19], v[76:79], 0
    v_mfma_f32_16x16x32_bf16 v[192:195], v[20:23], v[72:75], v[192:195]
    v_mfma_f32_16x16x32_bf16 v[196:199], v[20:23], v[76:79], v[196:199]
    v_mfma_f32_16x16x32_bf16 v[80:83], v[16:19], v[72:75], 0
    v_mfma_f32_16x16x32_bf16 v[84:87], v[20:23], v[72:75], 0
    v_mfma_f32_16x16x32_bf16 v[88:91], v[16:19], v[76:79], 0
    v_mfma_f32_16x16x32_bf16 v[92:95], v[20:23], v[76:79], 0
    s_waitcnt vmcnt(10)
    v_mfma_f32_16x16x32_bf16 v[192:195], v[24:27], v[72:75], v[192:195]
    v_mfma_f32_16x16x32_bf16 v[196:199], v[24:27], v[76:79], v[196:199]
    v_mfma_f32_16x16x32_bf16 v[192:195], v[28:31], v[72:75], v[192:195]
    v_mfma_f32_16x16x32_bf16 v[196:199], v[28:31], v[76:79], v[196:199]
    v_mfma_f32_16x16x32_bf16 v[96:99], v[24:27], v[72:75], 0
    v_mfma_f32_16x16x32_bf16 v[100:103], v[28:31], v[72:75], 0
    v_mfma_f32_16x16x32_bf16 v[104:107], v[24:27], v[76:79], 0
    v_mfma_f32_16x16x32_bf16 v[108:111], v[28:31], v[76:79], 0
    s_waitcnt vmcnt(8)
    v_mfma_f32_16x16x32_bf16 v[192:195], v[32:35], v[72:75], v[192:195]
    v_mfma_f32_16x16x32_bf16 v[196:199], v[32:35], v[76:79], v[196:199]
    v_mfma_f32_16x16x32_bf16 v[192:195], v[36:39], v[72:75], v[192:195]
    v_mfma_f32_16x16x32_bf16 v[196:199], v[36:39], v[76:79], v[196:199]
    v_mfma_f32_16x16x32_bf16 v[112:115], v[32:35], v[72:75], 0
    v_mfma_f32_16x16x32_bf16 v[116:119], v[36:39], v[72:75], 0
    v_mfma_f32_16x16x32_bf16 v[120:123], v[32:35], v[76:79], 0
    v_mfma_f32_16x16x32_bf16 v[124:127], v[36:39], v[76:79], 0
    s_waitcnt vmcnt(6)
    v_mfma_f32_16x16x32_bf16 v[192:195], v[40:43], v[72:75], v[192:195]
    v_mfma_f32_16x16x32_bf16 v[196:199], v[40:43], v[76:79], v[196:199]
    v_mfma_f32_16x16x32_bf16 v[192:195], v[44:47], v[72:75], v[192:195]
    v_mfma_f32_16x16x32_bf16 v[196:199], v[44:47], v[76:79], v[196:199]
    v_mfma_f32_16x16x32_bf16 v[128:131], v[40:43], v[72:75], 0
    v_mfma_f32_16x16x32_bf16 v[132:135], v[44:47], v[72:75], 0
    v_mfma_f32_16x16x32_bf16 v[136:139], v[40:43], v[76:79], 0
    v_mfma_f32_16x16x32_bf16 v[140:143], v[44:47], v[76:79], 0
    s_waitcnt vmcnt(4)
    v_mfma_f32_16x16x32_bf16 v[192:195], v[48:51], v[72:75], v[192:195]
    v_mfma_f32_16x16x32_bf16 v[196:199], v[48:51], v[76:79], v[196:199]
    v_mfma_f32_16x16x32_bf16 v[192:195], v[52:55], v[72:75], v[192:195]
    v_mfma_f32_16x16x32_bf16 v[196:199], v[52:55], v[76:79], v[196:199]
    v_mfma_f32_16x16x32_bf16 v[144:147], v[48:51], v[72:75], 0
    v_mfma_f32_16x16x32_bf16 v[148:151], v[52:55], v[72:75], 0
    v_mfma_f32_16x16x32_bf16 v[152:155], v[48:51], v[76:79], 0
    v_mfma_f32_16x16x32_bf16 v[156:159], v[52:55], v[76:79], 0
    s_waitcnt vmcnt(2)
    v_mfma_f32_16x16x32_bf16 v[192:195], v[56:59], v[72:75], v[192:195]
    v_mfma_f32_16x16x32_bf16 v[196:199], v[56:59], v[76:79], v[196:199]
    v_mfma_f32_16x16x32_bf16 v[192:195], v[60:63], v[72:75], v[192:195]
    v_mfma_f32_16x16x32_bf16 v[196:199], v[60:63], v[76:79], v[196:199]
    v_mfma_f32_16x16x32_bf16 v[160:163], v[56:59], v[72:75], 0
    v_mfma_f32_16x16x32_bf16 v[164:167], v[60:63], v[72:75], 0
    v_mfma_f32_16x16x32_bf16 v[168:171], v[56:59], v[76:79], 0
    v_mfma_f32_16x16x32_bf16 v[172:175], v[60:63], v[76:79], 0
    s_waitcnt vmcnt(0)
    v_mfma_f32_16x16x32_bf16 v[192:195], v[64:67], v[72:75], v[192:195]
    v_mfma_f32_16x16x32_bf16 v[196:199], v[64:67], v[76:79], v[196:199]
    v_mfma_f32_16x16x32_bf16 v[192:195], v[68:71], v[72:75], v[192:195]
    v_mfma_f32_16x16x32_bf16 v[196:199], v[68:71], v[76:79], v[196:199]
    v_mfma_f32_16x16x32_bf16 v[176:179], v[64:67], v[72:75], 0
    v_mfma_f32_16x16x32_bf16 v[180:183], v[68:71], v[72:75], 0
    v_mfma_f32_16x16x32_bf16 v[184:187], v[64:67], v[76:79], 0
    v_mfma_f32_16x16x32_bf16 v[188:191], v[68:71], v[76:79], 0
    v_lshlrev_b32 v14, 3, v3
    v_add_u32 v14, 158720, v14
    v_lshl_add_u32 v15, v4, 7, v14
    s_lshl_b32 s38, s3, 9
    v_add_u32 v15, s38, v15
    v_pk_add_f32 v[192:193], v[192:193], v[194:195]
    v_pk_add_f32 v[196:197], v[196:197], v[198:199]
    v_add_f32 v192, v192, v193
    v_add_f32 v193, v196, v197
    ds_write_b64 v15, v[192:193]
    ds_write_b32 v250, v251
    s_mov_b32 s23, 200000
ls1:
    ds_read_b64 v[248:249], v252
    s_sub_u32 s23, s23, 1
    s_cmp_eq_u32 s23, 0
    s_waitcnt lgkmcnt(0)
    s_cbranch_scc1 ls_out1
    v_and_b32 v248, v248, v249
    v_cmp_ne_u32 vcc, 1, v248
    s_cbranch_vccnz ls1
ls_out1:
    ds_read2_b64 v[208:211], v14 offset0:0 offset1:16
    ds_read2_b64 v[212:215], v14 offset0:32 offset1:48
    ds_read2_b64 v[216:219], v14 offset0:64 offset1:80
    ds_read2_b64 v[220:223], v14 offset0:96 offset1:112
    v_mov_b32 v8, s41
    v_mov_b32 v9, s41
    v_mul_f32 v10, 0xbb124925, v8
    s_waitcnt lgkmcnt(0)
    v_pk_add_f32 v[208:209], v[208:209], v[216:217]
    v_pk_add_f32 v[210:211], v[210:211], v[218:219]
    v_pk_add_f32 v[212:213], v[212:213], v[220:221]
    v_pk_add_f32 v[214:215], v[214:215], v[222:223]
    v_pk_add_f32 v[208:209], v[208:209], v[212:213]
    v_pk_add_f32 v[210:211], v[210:211], v[214:215]
    v_pk_add_f32 v[208:209], v[208:209], v[210:211]
    v_mul_f32 v200, v10, v208
    v_mul_f32 v201, v10, v208
    v_mul_f32 v202, v10, v209
    v_mul_f32 v203, v10, v209
    v_pk_fma_f32 v[80:81], v[80:81], v[8:9], v[200:201]
    v_pk_fma_f32 v[82:83], v[82:83], v[8:9], v[200:201]
    v_pk_fma_f32 v[84:85], v[84:85], v[8:9], v[200:201]
    v_pk_fma_f32 v[86:87], v[86:87], v[8:9], v[200:201]
    v_cvt_pk_bf16_f32 v16, v80, v81
    v_cvt_pk_bf16_f32 v17, v82, v83
    v_cvt_pk_bf16_f32 v18, v84, v85
    v_cvt_pk_bf16_f32 v19, v86, v87
    buffer_store_dwordx4 v[16:19], v11, s[28:31], s35 offen
    v_pk_fma_f32 v[88:89], v[88:89], v[8:9], v[202:203]
    v_pk_fma_f32 v[90:91], v[90:91], v[8:9], v[202:203]
    v_pk_fma_f32 v[92:93], v[92:93], v[8:9], v[202:203]
    v_pk_fma_f32 v[94:95], v[94:95], v[8:9], v[202:203]
    v_cvt_pk_bf16_f32 v20, v88, v89
    v_cvt_pk_bf16_f32 v21, v90, v91
    v_cvt_pk_bf16_f32 v22, v92, v93
    v_cvt_pk_bf16_f32 v23, v94, v95
    buffer_store_dwordx4 v[20:23], v12, s[28:31], s37 offen
    s_add_u32 s35, s35, s36
    s_add_u32 s37, s37, s42
    v_pk_fma_f32 v[96:97], v[96:97], v[8:9], v[200:201]
    v_pk_fma_f32 v[98:99], v[98:99], v[8:9], v[200:201]
    v_pk_fma_f32 v[100:101], v[100:101], v[8:9], v[200:201]
    v_pk_fma_f32 v[102:103], v[102:103], v[8:9], v[200:201]
    v_cvt_pk_bf16_f32 v24, v96, v97
    v_cvt_pk_bf16_f32 v25, v98, v99
    v_cvt_pk_bf16_f32 v26, v100, v101
    v_cvt_pk_bf16_f32 v27, v102, v103
    buffer_store_dwordx4 v[24:27], v11, s[28:31], s35 offen
    v_pk_fma_f32 v[104:105], v[104:105], v[8:9], v[202:203]
    v_pk_fma_f32 v[106:107], v[106:107], v[8:9], v[202:203]
    v_pk_fma_f32 v[108:109], v[108:109], v[8:9], v[202:203]
    v_pk_fma_f32 v[110:111], v[110:111], v[8:9], v[202:203]
    v_cvt_pk_bf16_f32 v28, v104, v105
    v_cvt_pk_bf16_f32 v29, v106, v107
    v_cvt_pk_bf16_f32 v30, v108, v109
    v_cvt_pk_bf16_f32 v31, v110, v111
    buffer_store_dwordx4 v[28:31], v12, s[28:31], s37 offen
    s_add_u32 s35, s35, s36
    s_add_u32 s37, s37, s42
    v_pk_fma_f32 v[112:113], v[112:113], v[8:9], v[200:201]
    v_pk_fma_f32 v[114:115], v[114:115], v[8:9], v[200:201]
    v_pk_fma_f32 v[116:117], v[116:117], v[8:9], v[200:201]
    v_pk_fma_f32 v[118:119], v[118:119], v[8:9], v[200:201]
    v_cvt_pk_bf16_f32 v32, v112, v113
    v_cvt_pk_bf16_f32 v33, v114, v115
    v_cvt_pk_bf16_f32 v34, v116, v117
    v_cvt_pk_bf16_f32 v35, v118, v119
    buffer_store_dwordx4 v[32:35], v11, s[28:31], s35 offen
    v_pk_fma_f32 v[120:121], v[120:121], v[8:9], v[202:203]
    v_pk_fma_f32 v[122:123], v[122:123], v[8:9], v[202:203]
    v_pk_fma_f32 v[124:125], v[124:125], v[8:9], v[202:203]
    v_pk_fma_f32 v[126:127], v[126:127], v[8:9], v[202:203]
    v_cvt_pk_bf16_f32 v36, v120, v121
    v_cvt_pk_bf16_f32 v37, v122, v123
    v_cvt_pk_bf16_f32 v38, v124, v125
    v_cvt_pk_bf16_f32 v39, v126, v127
    buffer_store_dwordx4 v[36:39], v12, s[28:31], s37 offen
    s_add_u32 s35, s35, s36
    s_add_u32 s37, s37, s42
    v_pk_fma_f32 v[128:129], v[128:129], v[8:9], v[200:201]
    v_pk_fma_f32 v[130:131], v[130:131], v[8:9], v[200:201]
    v_pk_fma_f32 v[132:133], v[132:133], v[8:9], v[200:201]
    v_pk_fma_f32 v[134:135], v[134:135], v[8:9], v[200:201]
    v_cvt_pk_bf16_f32 v40, v128, v129
    v_cvt_pk_bf16_f32 v41, v130, v131
    v_cvt_pk_bf16_f32 v42, v132, v133
    v_cvt_pk_bf16_f32 v43, v134, v135
    buffer_store_dwordx4 v[40:43], v11, s[28:31], s35 offen
    v_pk_fma_f32 v[136:137], v[136:137], v[8:9], v[202:203]
    v_pk_fma_f32 v[138:139], v[138:139], v[8:9], v[202:203]
    v_pk_fma_f32 v[140:141], v[140:141], v[8:9], v[202:203]
    v_pk_fma_f32 v[142:143], v[142:143], v[8:9], v[202:203]
    v_cvt_pk_bf16_f32 v44, v136, v137
    v_cvt_pk_bf16_f32 v45, v138, v139
    v_cvt_pk_bf16_f32 v46, v140, v141
    v_cvt_pk_bf16_f32 v47, v142, v143
    buffer_store_dwordx4 v[44:47], v12, s[28:31], s37 offen
    s_add_u32 s35, s35, s36
    s_add_u32 s37, s37, s42
    v_pk_fma_f32 v[144:145], v[144:145], v[8:9], v[200:201]
    v_pk_fma_f32 v[146:147], v[146:147], v[8:9], v[200:201]
    v_pk_fma_f32 v[148:149], v[148:149], v[8:9], v[200:201]
    v_pk_fma_f32 v[150:151], v[150:151], v[8:9], v[200:201]
    v_cvt_pk_bf16_f32 v48, v144, v145
    v_cvt_pk_bf16_f32 v49, v146, v147
    v_cvt_pk_bf16_f32 v50, v148, v149
    v_cvt_pk_bf16_f32 v51, v150, v151
    buffer_store_dwordx4 v[48:51], v11, s[28:31], s35 offen
    v_pk_fma_f32 v[152:153], v[152:153], v[8:9], v[202:203]
    v_pk_fma_f32 v[154:155], v[154:155], v[8:9], v[202:203]
    v_pk_fma_f32 v[156:157], v[156:157], v[8:9], v[202:203]
    v_pk_fma_f32 v[158:159], v[158:159], v[8:9], v[202:203]
    v_cvt_pk_bf16_f32 v52, v152, v153
    v_cvt_pk_bf16_f32 v53, v154, v155
    v_cvt_pk_bf16_f32 v54, v156, v157
    v_cvt_pk_bf16_f32 v55, v158, v159
    buffer_store_dwordx4 v[52:55], v12, s[28:31], s37 offen
    s_add_u32 s35, s35, s36
    s_add_u32 s37, s37, s42
    v_pk_fma_f32 v[160:161], v[160:161], v[8:9], v[200:201]
    v_pk_fma_f32 v[162:163], v[162:163], v[8:9], v[200:201]
    v_pk_fma_f32 v[164:165], v[164:165], v[8:9], v[200:201]
    v_pk_fma_f32 v[166:167], v[166:167], v[8:9], v[200:201]
    v_cvt_pk_bf16_f32 v56, v160, v161
    v_cvt_pk_bf16_f32 v57, v162, v163
    v_cvt_pk_bf16_f32 v58, v164, v165
    v_cvt_pk_bf16_f32 v59, v166, v167
    buffer_store_dwordx4 v[56:59], v11, s[28:31], s35 offen
    v_pk_fma_f32 v[168:169], v[168:169], v[8:9], v[202:203]
    v_pk_fma_f32 v[170:171], v[170:171], v[8:9], v[202:203]
    v_pk_fma_f32 v[172:173], v[172:173], v[8:9], v[202:203]
    v_pk_fma_f32 v[174:175], v[174:175], v[8:9], v[202:203]
    v_cvt_pk_bf16_f32 v60, v168, v169
    v_cvt_pk_bf16_f32 v61, v170, v171
    v_cvt_pk_bf16_f32 v62, v172, v173
    v_cvt_pk_bf16_f32 v63, v174, v175
    buffer_store_dwordx4 v[60:63], v12, s[28:31], s37 offen
    s_add_u32 s35, s35, s36
    s_add_u32 s37, s37, s42
    v_pk_fma_f32 v[176:177], v[176:177], v[8:9], v[200:201]
    v_pk_fma_f32 v[178:179], v[178:179], v[8:9], v[200:201]
    v_pk_fma_f32 v[180:181], v[180:181], v[8:9], v[200:201]
    v_pk_fma_f32 v[182:183], v[182:183], v[8:9], v[200:201]
    v_cvt_pk_bf16_f32 v64, v176, v177
    v_cvt_pk_bf16_f32 v65, v178, v179
    v_cvt_pk_bf16_f32 v66, v180, v181
    v_cvt_pk_bf16_f32 v67, v182, v183
    buffer_store_dwordx4 v[64:67], v11, s[28:31], s35 offen
    v_pk_fma_f32 v[184:185], v[184:185], v[8:9], v[202:203]
    v_pk_fma_f32 v[186:187], v[186:187], v[8:9], v[202:203]
    v_pk_fma_f32 v[188:189], v[188:189], v[8:9], v[202:203]
    v_pk_fma_f32 v[190:191], v[190:191], v[8:9], v[202:203]
    v_cvt_pk_bf16_f32 v68, v184, v185
    v_cvt_pk_bf16_f32 v69, v186, v187
    v_cvt_pk_bf16_f32 v70, v188, v189
    v_cvt_pk_bf16_f32 v71, v190, v191
    buffer_store_dwordx4 v[68:71], v12, s[28:31], s37 offen
    s_cmp_eq_u32 s45, 1
    s_cbranch_scc1 pr_wkn
    s_endpgm
pr_wkn:
    v_pk_mul_f32 v[192:193], v[80:81], v[80:81]
    v_pk_mul_f32 v[194:195], v[82:83], v[82:83]
    v_pk_mul_f32 v[196:197], v[84:85], v[84:85]
    v_pk_mul_f32 v[198:199], v[86:87], v[86:87]
    v_pk_fma_f32 v[192:193], v[88:89], v[88:89], v[192:193]
    v_pk_fma_f32 v[194:195], v[90:91], v[90:91], v[194:195]
    v_pk_fma_f32 v[196:197], v[92:93], v[92:93], v[196:197]
    v_pk_fma_f32 v[198:199], v[94:95], v[94:95], v[198:199]
    v_pk_fma_f32 v[192:193], v[96:97], v[96:97], v[192:193]
    v_pk_fma_f32 v[194:195], v[98:99], v[98:99], v[194:195]
    v_pk_fma_f32 v[196:197], v[100:101], v[100:101], v[196:197]
    v_pk_fma_f32 v[198:199], v[102:103], v[102:103], v[198:199]
    v_pk_fma_f32 v[192:193], v[104:105], v[104:105], v[192:193]
    v_pk_fma_f32 v[194:195], v[106:107], v[106:107], v[194:195]
    v_pk_fma_f32 v[196:197], v[108:109], v[108:109], v[196:197]
    v_pk_fma_f32 v[198:199], v[110:111], v[110:111], v[198:199]
    v_pk_fma_f32 v[192:193], v[112:113], v[112:113], v[192:193]
    v_pk_fma_f32 v[194:195], v[114:115], v[114:115], v[194:195]
    v_pk_fma_f32 v[196:197], v[116:117], v[116:117], v[196:197]
    v_pk_fma_f32 v[198:199], v[118:119], v[118:119], v[198:199]
    v_pk_fma_f32 v[192:193], v[120:121], v[120:121], v[192:193]
    v_pk_fma_f32 v[194:195], v[122:123], v[122:123], v[194:195]
    v_pk_fma_f32 v[196:197], v[124:125], v[124:125], v[196:197]
    v_pk_fma_f32 v[198:199], v[126:127], v[126:127], v[198:199]
    v_pk_fma_f32 v[192:193], v[128:129], v[128:129], v[192:193]
    v_pk_fma_f32 v[194:195], v[130:131], v[130:131], v[194:195]
    v_pk_fma_f32 v[196:197], v[132:133], v[132:133], v[196:197]
    v_pk_fma_f32 v[198:199], v[134:135], v[134:135], v[198:199]
    v_pk_fma_f32 v[192:193], v[136:137], v[136:137], v[192:193]
    v_pk_fma_f32 v[194:195], v[138:139], v[138:139], v[194:195]
    v_pk_fma_f32 v[196:197], v[140:141], v[140:141], v[196:197]
    v_pk_fma_f32 v[198:199], v[142:143], v[142:143], v[198:199]
    v_pk_fma_f32 v[192:193], v[144:145], v[144:145], v[192:193]
    v_pk_fma_f32 v[194:195], v[146:147], v[146:147], v[194:195]
    v_pk_fma_f32 v[196:197], v[148:149], v[148:149], v[196:197]
    v_pk_fma_f32 v[198:199], v[150:151], v[150:151], v[198:199]
    v_pk_fma_f32 v[192:193], v[152:153], v[152:153], v[192:193]
    v_pk_fma_f32 v[194:195], v[154:155], v[154:155], v[194:195]
    v_pk_fma_f32 v[196:197], v[156:157], v[156:157], v[196:197]
    v_pk_fma_f32 v[198:199], v[158:159], v[158:159], v[198:199]
    v_pk_fma_f32 v[192:193], v[160:161], v[160:161], v[192:193]
    v_pk_fma_f32 v[194:195], v[162:163], v[162:163], v[194:195]
    v_pk_fma_f32 v[196:197], v[164:165], v[164:165], v[196:197]
    v_pk_fma_f32 v[198:199], v[166:167], v[166:167], v[198:199]
    v_pk_fma_f32 v[192:193], v[168:169], v[168:169], v[192:193]
    v_pk_fma_f32 v[194:195], v[170:171], v[170:171], v[194:195]
    v_pk_fma_f32 v[196:197], v[172:173], v[172:173], v[196:197]
    v_pk_fma_f32 v[198:199], v[174:175], v[174:175], v[198:199]
    v_pk_fma_f32 v[192:193], v[176:177], v[176:177], v[192:193]
    v_pk_fma_f32 v[194:195], v[178:179], v[178:179], v[194:195]
    v_pk_fma_f32 v[196:197], v[180:181], v[180:181], v[196:197]
    v_pk_fma_f32 v[198:199], v[182:183], v[182:183], v[198:199]
    v_pk_fma_f32 v[192:193], v[184:185], v[184:185], v[192:193]
    v_pk_fma_f32 v[194:195], v[186:187], v[186:187], v[194:195]
    v_pk_fma_f32 v[196:197], v[188:189], v[188:189], v[196:197]
    v_pk_fma_f32 v[198:199], v[190:191], v[190:191], v[198:199]
    v_pk_add_f32 v[192:193], v[192:193], v[194:195]
    v_pk_add_f32 v[196:197], v[196:197], v[198:199]
    v_pk_add_f32 v[192:193], v[192:193], v[196:197]
    v_add_f32 v192, v192, v193
    s_nop 1
    v_add_f32_dpp v192, v192, v192 row_shr:1 row_mask:0xf bank_mask:0xf bound_ctrl:0
    s_nop 1
    v_add_f32_dpp v192, v192, v192 row_shr:2 row_mask:0xf bank_mask:0xf bound_ctrl:0
    s_nop 1
    v_add_f32_dpp v192, v192, v192 row_shr:4 row_mask:0xf bank_mask:0xf bound_ctrl:0
    s_nop 1
    v_add_f32_dpp v192, v192, v192 row_shr:8 row_mask:0xf bank_mask:0xf bound_ctrl:0
    s_nop 0
    v_readlane_b32 s32, v192, 15
    v_readlane_b32 s33, v192, 31
    v_readlane_b32 s34, v192, 47
    v_readlane_b32 s35, v192, 63
    v_mov_b32 v192, s32
    v_add_f32 v192, s33, v192
    v_add_f32 v192, s34, v192
    v_add_f32 v192, s35, v192
    s_lshl_b32 s32, s3, 2
    s_add_u32 s32, s32, 8650752
    v_mov_b32 v193, 0
    s_mov_b64 exec, 1
    buffer_store_dword v192, v193, s[28:31], s32 offen
    s_endpgm
pr_flags:
    s_sub_u32 s32, s39, 96
    s_mul_i32 s33, s3, 278528
    s_add_u32 s33, s33, 42729472
    s_cmp_eq_u32 s32, 0
    s_cselect_b32 s33, s33, s30
    s_lshl_b32 s32, s32, 1
    s_add_u32 s32, s32, s3
    s_mul_i32 s32, s32, 3072
    s_add_u32 s32, s32, 41943040
    v_mov_b32 v16, 0
    v_mov_b32 v17, 0
    v_mov_b32 v18, 0
    v_mov_b32 v19, 0
    v_mul_u32_u24 v20, 4352, v2
    s_xor_b32 s34, s3, 1
    v_mov_b32 v24, s34
    v_mov_b32 v25, s34
    v_mov_b32 v26, s34
    v_mov_b32 v27, s34
    buffer_store_dwordx4 v[24:27], v20, s[28:31], s33 offen
    buffer_store_dwordx4 v[16:19], v6, s[28:31], s32 offen
    buffer_store_dwordx4 v[16:19], v6, s[28:31], s32 offen offset:1024
    buffer_store_dwordx4 v[16:19], v6, s[28:31], s32 offen offset:2048
    s_endpgm
pr_code:
    s_getpc_b64 s[46:47]
cpf_pc:
    s_add_u32 s46, s46, main0_kernel - cpf_pc
    s_addc_u32 s47, s47, 0
    s_sub_u32 s33, s38, 14
    s_lshl_b32 s33, s33, 1
    s_add_u32 s33, s33, s3
    s_lshl_b32 s33, s33, 13
    v_lshlrev_b32 v10, 7, v2
    v_add_u32 v10, s33, v10
    v_add_u32 v11, 0x8000, v10
    v_min_u32 v10, code_end - main0_kernel - 4, v10
    v_min_u32 v11, code_end - main0_kernel - 4, v11
    global_load_dword v16, v10, s[46:47]
    global_load_dword v17, v11, s[46:47]
pq_end:
    s_endpgm
pq_x:
    v_lshlrev_b32 v6, 4, v2
    s_and_b32 s33, s2, 7
    s_lshl_b32 s33, s33, 3
    s_lshr_b32 s34, s2, 5
    s_add_u32 s33, s33, s34
    s_bfe_u32 s34, s2, 0x20003
    v_and_b32 v3, 31, v0
    v_bfe_u32 v4, v0, 5, 1
    v_mul_u32_u24 v7, 224, v3
    v_lshl_add_u32 v7, v4, 4, v7
    s_mul_i32 s36, s33, 28672
    s_mov_b32 s22, 1835008
    s_mov_b32 s23, 0x20000
    s_mov_b32 s30, 268435456
    s_mov_b32 s31, 0x20000
    v_lshlrev_b32 v9, 3, v3
    v_add_u32 v9, 157696, v9
    v_mov_b32 v19, 159744
    s_mul_i32 s37, s34, 224
    s_add_u32 s36, s36, s37
    s_mul_i32 s37, s33, 28672
    s_mul_i32 s38, s34, 7168
    s_add_u32 s37, s37, s38
    s_add_u32 s37, s37, 8912896
    s_add_u32 s38, s37, 4096
    s_lshl_b32 s39, s33, 12
    s_lshl_b32 s35, s34, 9
    s_add_u32 s35, s35, s39
    s_add_u32 s35, s35, 42205184
    v_lshlrev_b32 v8, 4, v3
    v_lshl_add_u32 v8, v4, 11, v8
    s_lshr_b32 s42, s2, 3
    s_mul_i32 s42, s42, 12544
    v_lshlrev_b32 v5, 7, v2
    s_mov_b32 s26, 401408
    s_mov_b32 s27, 0x20000
    s_waitcnt lgkmcnt(0)
    s_mov_b32 s20, s44
    s_and_b32 s21, s45, 0xffff
    s_mov_b32 s28, s18
    s_and_b32 s29, s19, 0xffff
    s_mov_b32 s24, s4
    s_and_b32 s25, s5, 0xffff
    buffer_load_dword v254, v5, s[24:27], s42 offen
    s_add_u32 s42, s42, 4352
    buffer_load_dword v253, v5, s[24:27], s42 offen
    v_mov_b32 v12, 0
    v_mov_b32 v13, 0
    v_mov_b32 v14, 0
    v_mov_b32 v15, 0
    buffer_store_dwordx4 v[12:15], v8, s[28:31], s35 offen
    s_mul_i32 s42, s34, 7168
    s_add_u32 s42, s42, 100352
    v_add_u32 v7, s42, v7
    s_sleep 16
    s_mov_b32 s23, 200000
ls2:
    s_sleep 2
    ds_read_b64 v[10:11], v9 offset:0
    ds_read_b64 v[12:13], v9 offset:256
    ds_read_b64 v[14:15], v9 offset:512
    ds_read_b64 v[16:17], v9 offset:768
    s_sub_u32 s23, s23, 1
    s_cmp_eq_u32 s23, 0
    s_waitcnt lgkmcnt(0)
    s_cbranch_scc1 ls_out2
    v_max3_u32 v18, v11, v13, v15
    v_max_u32 v18, v18, v17
    v_cmp_eq_u32 vcc, -1, v18
    s_cbranch_vccnz ls2
ls_out2:
    v_pk_add_f32 v[10:11], v[10:11], v[12:13]
    v_pk_add_f32 v[14:15], v[14:15], v[16:17]
    v_pk_add_f32 v[10:11], v[10:11], v[14:15]
    v_mul_f32 v12, 0xbb124925, v10
    v_mul_f32 v11, 0x3b124925, v11
    v_mov_b32 v13, v12
    v_fma_f32 v11, -v12, v12, v11
    v_max_f32 v11, 0, v11
    v_add_f32 v11, 0x3727c5ac, v11
    v_rsq_f32 v10, v11
    s_nop 0
    v_mov_b32 v11, v10
    ds_read_b128 v[24:27], v7 offset:0
    ds_read_b128 v[28:31], v7 offset:32
    ds_read_b128 v[32:35], v7 offset:64
    ds_read_b128 v[36:39], v7 offset:96
    ds_read_b128 v[40:43], v7 offset:128
    ds_read_b128 v[44:47], v7 offset:160
    ds_read_b128 v[48:51], v7 offset:192
    s_waitcnt lgkmcnt(6)
    buffer_store_dwordx4 v[24:27], v6, s[28:31], s37 offen offset:0
    s_waitcnt lgkmcnt(5)
    buffer_store_dwordx4 v[28:31], v6, s[28:31], s37 offen offset:1024
    s_waitcnt lgkmcnt(4)
    buffer_store_dwordx4 v[32:35], v6, s[28:31], s37 offen offset:2048
    s_waitcnt lgkmcnt(3)
    buffer_store_dwordx4 v[36:39], v6, s[28:31], s37 offen offset:3072
    s_waitcnt lgkmcnt(2)
    buffer_store_dwordx4 v[40:43], v6, s[28:31], s38 offen offset:0
    s_waitcnt lgkmcnt(1)
    buffer_store_dwordx4 v[44:47], v6, s[28:31], s38 offen offset:1024
    s_waitcnt lgkmcnt(0)
    buffer_store_dwordx4 v[48:51], v6, s[28:31], s38 offen offset:2048
    s_cmp_lt_u32 s34, 2
    s_cbranch_scc1 pq_kv
    s_endpgm
pq_kv:
    s_lshl_b32 s36, s33, 12
    s_lshl_b32 s38, s34, 11
    s_add_u32 s36, s36, s38
    s_add_u32 s36, s36, 8388608
    v_lshlrev_b32 v7, 2, v3
    v_add_u32 v7, 159872, v7
    v_lshlrev_b32 v8, 4, v4
    v_add_u32 v8, 159872, v8
    v_add_u32 v5, 50176, v6
    ds_write_b32 v7, v10
    ds_read_b128 v[128:131], v8 offset:0
    ds_read_b128 v[132:135], v8 offset:32
    ds_read_b128 v[136:139], v8 offset:64
    ds_read_b128 v[140:143], v8 offset:96
    v_cmp_eq_u32 vcc, 28, v3
    s_nop 1
    v_cndmask_b32 v9, 0, 1.0, vcc
    v_cmp_le_u32 s[38:39], 28, v3
    s_mov_b32 s23, 200000
ls3:
    s_sleep 1
    ds_read_b128 v[20:23], v19
    s_sub_u32 s23, s23, 1
    s_cmp_eq_u32 s23, 0
    s_waitcnt lgkmcnt(0)
    s_cbranch_scc1 ls_out3
    v_and_b32 v20, v20, v21
    v_and_b32 v22, v22, v23
    v_and_b32 v20, v20, v22
    v_cmp_ne_u32 vcc, 1, v20
    s_cbranch_vccnz ls3
ls_out3:
    ds_read_b128 v[64:67], v6 offset:12288
    ds_read_b128 v[68:71], v6 offset:13312
    ds_read_b128 v[72:75], v6 offset:14336
    ds_read_b128 v[76:79], v6 offset:15360
    ds_read_b128 v[80:83], v6 offset:37376
    ds_read_b128 v[84:87], v6 offset:38400
    ds_read_b128 v[88:91], v6 offset:39424
    ds_read_b128 v[92:95], v6 offset:40448
    ds_read_b128 v[96:99], v5 offset:12288
    ds_read_b128 v[100:103], v5 offset:13312
    ds_read_b128 v[104:107], v5 offset:14336
    ds_read_b128 v[108:111], v5 offset:15360
    ds_read_b128 v[112:115], v5 offset:37376
    ds_read_b128 v[116:119], v5 offset:38400
    ds_read_b128 v[120:123], v5 offset:39424
    ds_read_b128 v[124:127], v5 offset:40448
    s_waitcnt lgkmcnt(8)
    v_pk_add_f32 v[64:65], v[64:65], v[80:81]
    v_pk_add_f32 v[66:67], v[66:67], v[82:83]
    v_pk_add_f32 v[68:69], v[68:69], v[84:85]
    v_pk_add_f32 v[70:71], v[70:71], v[86:87]
    v_pk_add_f32 v[72:73], v[72:73], v[88:89]
    v_pk_add_f32 v[74:75], v[74:75], v[90:91]
    v_pk_add_f32 v[76:77], v[76:77], v[92:93]
    v_pk_add_f32 v[78:79], v[78:79], v[94:95]
    s_waitcnt lgkmcnt(4)
    v_pk_add_f32 v[64:65], v[64:65], v[96:97]
    v_pk_add_f32 v[66:67], v[66:67], v[98:99]
    v_pk_add_f32 v[68:69], v[68:69], v[100:101]
    v_pk_add_f32 v[70:71], v[70:71], v[102:103]
    v_pk_add_f32 v[72:73], v[72:73], v[104:105]
    v_pk_add_f32 v[74:75], v[74:75], v[106:107]
    v_pk_add_f32 v[76:77], v[76:77], v[108:109]
    v_pk_add_f32 v[78:79], v[78:79], v[110:111]
    s_waitcnt lgkmcnt(0)
    v_pk_add_f32 v[64:65], v[64:65], v[112:113]
    v_pk_add_f32 v[66:67], v[66:67], v[114:115]
    v_pk_add_f32 v[68:69], v[68:69], v[116:117]
    v_pk_add_f32 v[70:71], v[70:71], v[118:119]
    v_pk_add_f32 v[72:73], v[72:73], v[120:121]
    v_pk_add_f32 v[74:75], v[74:75], v[122:123]
    v_pk_add_f32 v[76:77], v[76:77], v[124:125]
    v_pk_add_f32 v[78:79], v[78:79], v[126:127]
    s_cmp_eq_u32 s34, 0
    s_cbranch_scc1 pq_k
    v_pk_mul_f32 v[64:65], v[64:65], v[128:129]
    v_pk_mul_f32 v[66:67], v[66:67], v[130:131]
    v_pk_mul_f32 v[68:69], v[68:69], v[132:133]
    v_pk_mul_f32 v[70:71], v[70:71], v[134:135]
    v_pk_mul_f32 v[72:73], v[72:73], v[136:137]
    v_pk_mul_f32 v[74:75], v[74:75], v[138:139]
    v_pk_mul_f32 v[76:77], v[76:77], v[140:141]
    v_pk_mul_f32 v[78:79], v[78:79], v[142:143]
    v_cndmask_b32 v64, v64, v9, s[38:39]
    v_cndmask_b32 v65, v65, v9, s[38:39]
    v_cndmask_b32 v66, v66, v9, s[38:39]
    v_cndmask_b32 v67, v67, v9, s[38:39]
    v_cndmask_b32 v68, v68, v9, s[38:39]
    v_cndmask_b32 v69, v69, v9, s[38:39]
    v_cndmask_b32 v70, v70, v9, s[38:39]
    v_cndmask_b32 v71, v71, v9, s[38:39]
    v_cndmask_b32 v72, v72, v9, s[38:39]
    v_cndmask_b32 v73, v73, v9, s[38:39]
    v_cndmask_b32 v74, v74, v9, s[38:39]
    v_cndmask_b32 v75, v75, v9, s[38:39]
    v_cndmask_b32 v76, v76, v9, s[38:39]
    v_cndmask_b32 v77, v77, v9, s[38:39]
    v_cndmask_b32 v78, v78, v9, s[38:39]
    v_cndmask_b32 v79, v79, v9, s[38:39]
    v_cvt_pk_bf16_f32 v144, v64, v65
    v_cvt_pk_bf16_f32 v145, v66, v67
    v_cvt_pk_bf16_f32 v146, v68, v69
    v_cvt_pk_bf16_f32 v147, v70, v71
    v_cvt_pk_bf16_f32 v148, v72, v73
    v_cvt_pk_bf16_f32 v149, v74, v75
    v_cvt_pk_bf16_f32 v150, v76, v77
    v_cvt_pk_bf16_f32 v151, v78, v79
    buffer_store_dwordx4 v[144:147], v6, s[28:31], s36 offen
    buffer_store_dwordx4 v[148:151], v6, s[28:31], s36 offen offset:1024
    s_endpgm
pq_k:
    v_pk_mul_f32 v[64:65], v[64:65], v[10:11]
    v_pk_mul_f32 v[66:67], v[66:67], v[10:11]
    v_pk_mul_f32 v[68:69], v[68:69], v[10:11]
    v_pk_mul_f32 v[70:71], v[70:71], v[10:11]
    v_pk_mul_f32 v[72:73], v[72:73], v[10:11]
    v_pk_mul_f32 v[74:75], v[74:75], v[10:11]
    v_pk_mul_f32 v[76:77], v[76:77], v[10:11]
    v_pk_mul_f32 v[78:79], v[78:79], v[10:11]
    v_cvt_pk_bf16_f32 v144, v64, v65
    v_cvt_pk_bf16_f32 v145, v66, v67
    v_cvt_pk_bf16_f32 v146, v68, v69
    v_cvt_pk_bf16_f32 v147, v70, v71
    v_cvt_pk_bf16_f32 v148, v72, v73
    v_cvt_pk_bf16_f32 v149, v74, v75
    v_cvt_pk_bf16_f32 v150, v76, v77
    v_cvt_pk_bf16_f32 v151, v78, v79
    buffer_store_dwordx4 v[144:147], v6, s[28:31], s36 offen
    s_mov_b32 exec_lo, 0
    v_mov_b32 v150, 0
    v_mov_b32 v151, 0
    s_mov_b32 exec_lo, -1
    v_mov_b32 v12, 0
    v_mov_b32 v13, 0
    v_dot2_f32_bf16 v12, v144, v144, v12
    v_dot2_f32_bf16 v13, v145, v145, v13
    v_dot2_f32_bf16 v12, v146, v146, v12
    v_dot2_f32_bf16 v13, v147, v147, v13
    v_dot2_f32_bf16 v12, v148, v148, v12
    v_dot2_f32_bf16 v13, v149, v149, v13
    v_dot2_f32_bf16 v12, v150, v150, v12
    v_dot2_f32_bf16 v13, v151, v151, v13
    s_nop 2
    v_add_f32 v12, v12, v13
    v_mov_b32 v13, v12
    s_nop 1
    v_permlane32_swap_b32 v12, v13
    v_add_f32 v12, v12, v13
    s_mov_b32 exec_lo, 0
    v_mov_b32 v150, 0x3f803f80
    v_mov_b32 v151, 0x00003f80
    s_mov_b32 exec_lo, -1
    buffer_store_dwordx4 v[148:151], v6, s[28:31], s36 offen offset:1024
    v_max_f32_dpp v12, v12, v12 row_shr:1 row_mask:0xf bank_mask:0xf
    s_nop 1
    v_max_f32_dpp v12, v12, v12 row_shr:2 row_mask:0xf bank_mask:0xf
    s_nop 1
    v_max_f32_dpp v12, v12, v12 row_shr:4 row_mask:0xf bank_mask:0xf
    s_nop 1
    v_max_f32_dpp v12, v12, v12 row_shr:8 row_mask:0xf bank_mask:0xf
    s_nop 0
    v_readlane_b32 s42, v12, 15
    v_readlane_b32 s43, v12, 31
    s_nop 0
    s_max_u32 s42, s42, s43
    v_sqrt_f32 v12, s42
    s_nop 0
    v_mul_f32 v12, 0x3f8147ae, v12
    v_or_b32 v12, 1, v12
    s_lshl_b32 s36, s33, 2
    s_add_u32 s36, s36, 41942784
    v_mov_b32 v13, 0
    s_mov_b64 exec, 1
    buffer_store_dword v12, v13, s[28:31], s36 offen sc1
    s_endpgm
pq_q:
    v_lshlrev_b32 v6, 4, v2
    s_and_b32 s33, s2, 7
    s_lshl_b32 s33, s33, 3
    s_lshr_b32 s34, s2, 5
    s_add_u32 s33, s33, s34
    s_bfe_u32 s34, s2, 0x20003
    v_and_b32 v3, 31, v0
    v_bfe_u32 v4, v0, 5, 1
    v_mul_u32_u24 v7, 224, v3
    v_lshl_add_u32 v7, v4, 4, v7
    s_mul_i32 s36, s33, 28672
    s_mov_b32 s22, 1835008
    s_mov_b32 s23, 0x20000
    s_mov_b32 s30, 268435456
    s_mov_b32 s31, 0x20000
    v_lshlrev_b32 v9, 3, v3
    v_add_u32 v9, 157696, v9
    v_mov_b32 v19, 159744
    s_sub_u32 s3, s3, 3
    s_mul_i32 s37, s3, 224
    s_add_u32 s36, s36, s37
    s_lshl_b32 s38, s3, 8
    v_add_u32 v8, s38, v9
    s_lshl_b32 s38, s3, 2
    v_add_u32 v5, s38, v19
    v_mul_u32_u24 v12, 4682, v2
    s_movk_i32 s42, 672
    s_mul_i32 s35, s3, 100352
    s_mul_i32 s38, s34, 224
    s_add_u32 s35, s35, s38
    s_mul_i32 s32, s3, 25088
    s_mov_b32 s26, 401408
    s_mov_b32 s27, 0x20000
    s_mul_i32 s37, s3, 6272
    s_mul_i32 s39, s3, 7168
    s_add_u32 s43, s39, 100352
    s_add_u32 s39, s39, 129024
    s_mov_b32 m0, s43
    v_add_u32 v7, s43, v7
    s_waitcnt lgkmcnt(0)
    s_mov_b32 s20, s44
    s_and_b32 s21, s45, 0xffff
    s_mov_b32 s28, s18
    s_and_b32 s29, s19, 0xffff
    v_add_u32 v13, 0, v12
    v_lshrrev_b32 v13, 16, v13
    v_mad_u32_u24 v244, v13, s42, v6
    buffer_load_dwordx4 v244, s[20:23], s36 offen offset:0 lds
    v_add_u32 v13, 299648, v12
    v_lshrrev_b32 v13, 16, v13
    v_mad_u32_u24 v245, v13, s42, v6
    buffer_load_dwordx4 v245, s[20:23], s36 offen offset:1024 lds
    v_add_u32 v13, 599296, v12
    v_lshrrev_b32 v13, 16, v13
    v_mad_u32_u24 v246, v13, s42, v6
    buffer_load_dwordx4 v246, s[20:23], s36 offen offset:2048 lds
    v_add_u32 v13, 898944, v12
    v_lshrrev_b32 v13, 16, v13
    v_mad_u32_u24 v247, v13, s42, v6
    buffer_load_dwordx4 v247, s[20:23], s36 offen offset:3072 lds
    v_add_u32 v13, 1198592, v12
    v_lshrrev_b32 v13, 16, v13
    v_mad_u32_u24 v248, v13, s42, v6
    s_add_u32 m0, m0, 4096
    s_add_u32 s36, s36, 4096
    buffer_load_dwordx4 v248, s[20:23], s36 offen offset:0 lds
    v_add_u32 v13, 1498240, v12
    v_lshrrev_b32 v13, 16, v13
    v_mad_u32_u24 v249, v13, s42, v6
    buffer_load_dwordx4 v249, s[20:23], s36 offen offset:1024 lds
    v_add_u32 v13, 1797888, v12
    v_lshrrev_b32 v13, 16, v13
    v_mad_u32_u24 v250, v13, s42, v6
    buffer_load_dwordx4 v250, s[20:23], s36 offen offset:2048 lds
    s_mov_b32 s24, s4
    s_and_b32 s25, s5, 0xffff
    s_cmp_eq_u32 s34, 0
    s_cselect_b32 s12, s6, s8
    s_cselect_b32 s13, s7, s9
    s_and_b32 s13, s13, 0xffff
    s_mov_b32 s14, 25088
    s_mov_b32 s15, 0x20000
    s_cmp_eq_u32 s34, 0
    s_cbranch_scc1 pq_q1
    s_cmp_eq_u32 s34, 1
    s_cbranch_scc1 pq_q2
    s_mov_b32 s43, 0
    v_mov_b32 v23, 1
    v_bfe_u32 v12, v2, 2, 2
    v_and_b32 v13, 3, v2
    v_bfe_u32 v14, v2, 4, 1
    v_lshlrev_b32 v12, 1, v12
    v_lshl_add_u32 v15, v4, 3, v12
    v_and_b32 v16, 1, v13
    v_lshrrev_b32 v17, 1, v13
    v_lshl_add_u32 v20, v16, 1, v17
    v_lshl_add_u32 v20, v14, 2, v20
    v_lshlrev_b32 v20, 3, v20
    v_mul_u32_u24 v22, 224, v15
    v_add3_u32 v22, v22, v20, s32
    s_xor_b32 s38, s3, 0
    s_mul_i32 s42, s38, 25088
    s_mul_i32 s38, s38, 56
    v_add_u32 v232, s38, v22
    v_add_u32 v237, s42, v6
    s_xor_b32 s38, s3, 1
    s_mul_i32 s42, s38, 25088
    s_mul_i32 s38, s38, 56
    v_add_u32 v233, s38, v22
    v_add_u32 v238, s42, v6
    s_xor_b32 s38, s3, 2
    s_mul_i32 s42, s38, 25088
    s_mul_i32 s38, s38, 56
    v_add_u32 v234, s38, v22
    v_add_u32 v239, s42, v6
    s_xor_b32 s38, s3, 3
    s_mul_i32 s42, s38, 25088
    s_mul_i32 s38, s38, 56
    v_add_u32 v235, s38, v22
    v_add_u32 v240, s42, v6
    s_waitcnt vmcnt(0)
    ds_write_b32 v19, v23 offset:24
    ds_read_b128 v[24:27], v7 offset:0
    ds_read_b128 v[28:31], v7 offset:32
    ds_read_b128 v[32:35], v7 offset:64
    ds_read_b128 v[36:39], v7 offset:96
    ds_read_b128 v[40:43], v7 offset:128
    ds_read_b128 v[44:47], v7 offset:160
    ds_read_b128 v[48:51], v7 offset:192
    s_waitcnt lgkmcnt(6)
    s_mov_b32 m0, s32
    s_nop 0
    buffer_load_dwordx4 v244, s[24:27], s35 offen offset:0 lds
    v_lshlrev_b32 v52, 16, v24
    v_and_b32 v53, 0xffff0000, v24
    v_pk_mul_f32 v[10:11], v[52:53], v[52:53]
    v_pk_add_f32 v[12:13], v[52:53], 0
    v_lshlrev_b32 v54, 16, v25
    v_and_b32 v55, 0xffff0000, v25
    v_pk_mul_f32 v[14:15], v[54:55], v[54:55]
    v_pk_add_f32 v[16:17], v[54:55], 0
    v_lshlrev_b32 v56, 16, v26
    v_and_b32 v57, 0xffff0000, v26
    v_pk_fma_f32 v[10:11], v[56:57], v[56:57], v[10:11]
    v_pk_add_f32 v[12:13], v[12:13], v[56:57]
    v_lshlrev_b32 v58, 16, v27
    v_and_b32 v59, 0xffff0000, v27
    v_pk_fma_f32 v[14:15], v[58:59], v[58:59], v[14:15]
    v_pk_add_f32 v[16:17], v[16:17], v[58:59]
    s_waitcnt lgkmcnt(5)
    v_lshlrev_b32 v60, 16, v28
    v_and_b32 v61, 0xffff0000, v28
    v_pk_fma_f32 v[10:11], v[60:61], v[60:61], v[10:11]
    v_pk_add_f32 v[12:13], v[12:13], v[60:61]
    v_lshlrev_b32 v62, 16, v29
    v_and_b32 v63, 0xffff0000, v29
    v_pk_fma_f32 v[14:15], v[62:63], v[62:63], v[14:15]
    v_pk_add_f32 v[16:17], v[16:17], v[62:63]
    v_lshlrev_b32 v64, 16, v30
    v_and_b32 v65, 0xffff0000, v30
    v_pk_fma_f32 v[10:11], v[64:65], v[64:65], v[10:11]
    v_pk_add_f32 v[12:13], v[12:13], v[64:65]
    v_lshlrev_b32 v66, 16, v31
    v_and_b32 v67, 0xffff0000, v31
    v_pk_fma_f32 v[14:15], v[66:67], v[66:67], v[14:15]
    v_pk_add_f32 v[16:17], v[16:17], v[66:67]
    s_waitcnt lgkmcnt(4)
    v_lshlrev_b32 v68, 16, v32
    v_and_b32 v69, 0xffff0000, v32
    v_pk_fma_f32 v[10:11], v[68:69], v[68:69], v[10:11]
    v_pk_add_f32 v[12:13], v[12:13], v[68:69]
    v_lshlrev_b32 v70, 16, v33
    v_and_b32 v71, 0xffff0000, v33
    v_pk_fma_f32 v[14:15], v[70:71], v[70:71], v[14:15]
    v_pk_add_f32 v[16:17], v[16:17], v[70:71]
    v_lshlrev_b32 v72, 16, v34
    v_and_b32 v73, 0xffff0000, v34
    v_pk_fma_f32 v[10:11], v[72:73], v[72:73], v[10:11]
    v_pk_add_f32 v[12:13], v[12:13], v[72:73]
    v_lshlrev_b32 v74, 16, v35
    v_and_b32 v75, 0xffff0000, v35
    v_pk_fma_f32 v[14:15], v[74:75], v[74:75], v[14:15]
    v_pk_add_f32 v[16:17], v[16:17], v[74:75]
    s_waitcnt lgkmcnt(3)
    v_lshlrev_b32 v76, 16, v36
    v_and_b32 v77, 0xffff0000, v36
    v_pk_fma_f32 v[10:11], v[76:77], v[76:77], v[10:11]
    v_pk_add_f32 v[12:13], v[12:13], v[76:77]
    v_lshlrev_b32 v78, 16, v37
    v_and_b32 v79, 0xffff0000, v37
    v_pk_fma_f32 v[14:15], v[78:79], v[78:79], v[14:15]
    v_pk_add_f32 v[16:17], v[16:17], v[78:79]
    v_lshlrev_b32 v80, 16, v38
    v_and_b32 v81, 0xffff0000, v38
    v_pk_fma_f32 v[10:11], v[80:81], v[80:81], v[10:11]
    v_pk_add_f32 v[12:13], v[12:13], v[80:81]
    v_lshlrev_b32 v82, 16, v39
    v_and_b32 v83, 0xffff0000, v39
    v_pk_fma_f32 v[14:15], v[82:83], v[82:83], v[14:15]
    v_pk_add_f32 v[16:17], v[16:17], v[82:83]
    s_waitcnt lgkmcnt(2)
    v_lshlrev_b32 v84, 16, v40
    v_and_b32 v85, 0xffff0000, v40
    v_pk_fma_f32 v[10:11], v[84:85], v[84:85], v[10:11]
    v_pk_add_f32 v[12:13], v[12:13], v[84:85]
    v_lshlrev_b32 v86, 16, v41
    v_and_b32 v87, 0xffff0000, v41
    v_pk_fma_f32 v[14:15], v[86:87], v[86:87], v[14:15]
    v_pk_add_f32 v[16:17], v[16:17], v[86:87]
    v_lshlrev_b32 v88, 16, v42
    v_and_b32 v89, 0xffff0000, v42
    v_pk_fma_f32 v[10:11], v[88:89], v[88:89], v[10:11]
    v_pk_add_f32 v[12:13], v[12:13], v[88:89]
    v_lshlrev_b32 v90, 16, v43
    v_and_b32 v91, 0xffff0000, v43
    v_pk_fma_f32 v[14:15], v[90:91], v[90:91], v[14:15]
    v_pk_add_f32 v[16:17], v[16:17], v[90:91]
    s_waitcnt lgkmcnt(1)
    v_lshlrev_b32 v92, 16, v44
    v_and_b32 v93, 0xffff0000, v44
    v_pk_fma_f32 v[10:11], v[92:93], v[92:93], v[10:11]
    v_pk_add_f32 v[12:13], v[12:13], v[92:93]
    v_lshlrev_b32 v94, 16, v45
    v_and_b32 v95, 0xffff0000, v45
    v_pk_fma_f32 v[14:15], v[94:95], v[94:95], v[14:15]
    v_pk_add_f32 v[16:17], v[16:17], v[94:95]
    v_lshlrev_b32 v96, 16, v46
    v_and_b32 v97, 0xffff0000, v46
    v_pk_fma_f32 v[10:11], v[96:97], v[96:97], v[10:11]
    v_pk_add_f32 v[12:13], v[12:13], v[96:97]
    v_lshlrev_b32 v98, 16, v47
    v_and_b32 v99, 0xffff0000, v47
    v_pk_fma_f32 v[14:15], v[98:99], v[98:99], v[14:15]
    v_pk_add_f32 v[16:17], v[16:17], v[98:99]
    s_waitcnt lgkmcnt(0)
    v_lshlrev_b32 v100, 16, v48
    v_and_b32 v101, 0xffff0000, v48
    v_pk_fma_f32 v[10:11], v[100:101], v[100:101], v[10:11]
    v_pk_add_f32 v[12:13], v[12:13], v[100:101]
    v_lshlrev_b32 v102, 16, v49
    v_and_b32 v103, 0xffff0000, v49
    v_pk_fma_f32 v[14:15], v[102:103], v[102:103], v[14:15]
    v_pk_add_f32 v[16:17], v[16:17], v[102:103]
    v_lshlrev_b32 v104, 16, v50
    v_and_b32 v105, 0xffff0000, v50
    v_pk_fma_f32 v[10:11], v[104:105], v[104:105], v[10:11]
    v_pk_add_f32 v[12:13], v[12:13], v[104:105]
    v_lshlrev_b32 v106, 16, v51
    v_and_b32 v107, 0xffff0000, v51
    v_pk_fma_f32 v[14:15], v[106:107], v[106:107], v[14:15]
    v_pk_add_f32 v[16:17], v[16:17], v[106:107]
    v_pk_add_f32 v[10:11], v[10:11], v[14:15]
    v_pk_add_f32 v[12:13], v[12:13], v[16:17]
    v_add_f32 v15, v10, v11
    v_add_f32 v14, v12, v13
    v_mov_b32 v16, v14
    v_mov_b32 v17, v15
    s_nop 0
    v_permlane32_swap_b32 v14, v16
    v_permlane32_swap_b32 v15, v17
    v_pk_add_f32 v[14:15], v[14:15], v[16:17]
    ds_write_b64 v8, v[14:15]
    buffer_load_dwordx4 v245, s[24:27], s35 offen offset:1024 lds
    buffer_load_dwordx4 v246, s[24:27], s35 offen offset:2048 lds
    buffer_load_dwordx4 v247, s[24:27], s35 offen offset:3072 lds
    s_add_u32 m0, m0, 4096
    s_add_u32 s35, s35, 4096
    buffer_load_dwordx4 v248, s[24:27], s35 offen offset:0 lds
    buffer_load_dwordx4 v249, s[24:27], s35 offen offset:1024 lds
    buffer_load_dwordx4 v250, s[24:27], s35 offen offset:2048 lds
    s_add_u32 m0, m0, 3072
    s_add_u32 s35, s35, 24576
    buffer_load_dwordx4 v244, s[24:27], s35 offen offset:0 lds
    buffer_load_dwordx4 v245, s[24:27], s35 offen offset:1024 lds
    s_mov_b32 s23, 200000
ls4:
    ds_read_b64 v[10:11], v9 offset:0
    ds_read_b64 v[12:13], v9 offset:256
    ds_read_b64 v[14:15], v9 offset:512
    ds_read_b64 v[16:17], v9 offset:768
    s_sub_u32 s23, s23, 1
    s_cmp_eq_u32 s23, 0
    s_waitcnt lgkmcnt(0)
    s_cbranch_scc1 ls_out4
    v_max3_u32 v20, v11, v13, v15
    v_max_u32 v20, v20, v17
    v_cmp_eq_u32 vcc, -1, v20
    s_cbranch_vccnz ls4
ls_out4:
    v_pk_add_f32 v[10:11], v[10:11], v[12:13]
    v_pk_add_f32 v[14:15], v[14:15], v[16:17]
    v_pk_add_f32 v[10:11], v[10:11], v[14:15]
    v_mul_f32 v12, 0xbb124925, v10
    v_mul_f32 v11, 0x3b124925, v11
    v_mov_b32 v13, v12
    v_fma_f32 v11, -v12, v12, v11
    v_max_f32 v11, 0, v11
    v_add_f32 v11, 0x3727c5ac, v11
    v_rsq_f32 v10, v11
    s_nop 0
    v_mul_f32 v10, 0x3e8b97f6, v10
    v_mov_b32 v11, v10
    buffer_load_dwordx4 v246, s[24:27], s35 offen offset:2048 lds
    buffer_load_dwordx4 v247, s[24:27], s35 offen offset:3072 lds
    s_add_u32 m0, m0, 4096
    s_add_u32 s35, s35, 4096
    buffer_load_dwordx4 v248, s[24:27], s35 offen offset:0 lds
    buffer_load_dwordx4 v249, s[24:27], s35 offen offset:1024 lds
    s_waitcnt vmcnt(9)
    ds_read_b64_tr_b16 v[196:197], v233 offset:0
    ds_read_b64_tr_b16 v[198:199], v233 offset:224
    ds_read_b64_tr_b16 v[200:201], v234 offset:0
    ds_read_b64_tr_b16 v[202:203], v234 offset:224
    ds_read_b64_tr_b16 v[204:205], v235 offset:0
    ds_read_b64_tr_b16 v[206:207], v235 offset:224
    ds_read_b64_tr_b16 v[192:193], v232 offset:0
    ds_read_b64_tr_b16 v[194:195], v232 offset:224
    v_pk_add_f32 v[52:53], v[52:53], v[12:13]
    v_pk_add_f32 v[54:55], v[54:55], v[12:13]
    v_pk_add_f32 v[56:57], v[56:57], v[12:13]
    v_pk_add_f32 v[58:59], v[58:59], v[12:13]
    v_cvt_pk_bf16_f32 v24, v52, v54
    v_cvt_pk_bf16_f32 v25, v56, v58
    v_cvt_pk_bf16_f32 v26, v53, v55
    v_cvt_pk_bf16_f32 v27, v57, v59
    s_waitcnt lgkmcnt(6)
    s_nop 0
    v_mfma_f32_32x32x16_bf16 v[128:143], v[196:199], v[24:27], 0
    buffer_load_dwordx4 v250, s[24:27], s35 offen offset:2048 lds
    s_waitcnt vmcnt(7)
    ds_read_b64_tr_b16 v[216:217], v233 offset:3584
    ds_read_b64_tr_b16 v[218:219], v233 offset:3808
    v_pk_add_f32 v[60:61], v[60:61], v[12:13]
    v_pk_add_f32 v[62:63], v[62:63], v[12:13]
    s_waitcnt lgkmcnt(6)
    v_mfma_f32_32x32x16_bf16 v[144:159], v[200:203], v[24:27], 0
    s_add_u32 m0, m0, 3072
    s_add_u32 s35, s35, 24576
    buffer_load_dwordx4 v244, s[24:27], s35 offen offset:0 lds
    ds_read_b64_tr_b16 v[220:221], v234 offset:3584
    ds_read_b64_tr_b16 v[222:223], v234 offset:3808
    v_pk_add_f32 v[64:65], v[64:65], v[12:13]
    v_pk_add_f32 v[66:67], v[66:67], v[12:13]
    s_waitcnt lgkmcnt(6)
    v_mfma_f32_32x32x16_bf16 v[160:175], v[204:207], v[24:27], 0
    buffer_load_dwordx4 v245, s[24:27], s35 offen offset:1024 lds
    ds_read_b64_tr_b16 v[224:225], v235 offset:3584
    ds_read_b64_tr_b16 v[226:227], v235 offset:3808
    v_cvt_pk_bf16_f32 v28, v60, v62
    v_cvt_pk_bf16_f32 v29, v64, v66
    s_waitcnt lgkmcnt(6)
    v_mfma_f32_32x32x16_bf16 v[112:127], v[192:195], v[24:27], 0
    buffer_load_dwordx4 v246, s[24:27], s35 offen offset:2048 lds
    ds_read_b64_tr_b16 v[212:213], v232 offset:3584
    ds_read_b64_tr_b16 v[214:215], v232 offset:3808
    v_cvt_pk_bf16_f32 v30, v61, v63
    v_cvt_pk_bf16_f32 v31, v65, v67
    s_waitcnt lgkmcnt(6)
    s_nop 0
    v_mfma_f32_32x32x16_bf16 v[128:143], v[216:219], v[28:31], v[128:143]
    buffer_load_dwordx4 v247, s[24:27], s35 offen offset:3072 lds
    s_waitcnt vmcnt(7)
    ds_read_b64_tr_b16 v[196:197], v233 offset:7168
    ds_read_b64_tr_b16 v[198:199], v233 offset:7392
    v_pk_add_f32 v[68:69], v[68:69], v[12:13]
    v_pk_add_f32 v[70:71], v[70:71], v[12:13]
    s_waitcnt lgkmcnt(6)
    v_mfma_f32_32x32x16_bf16 v[144:159], v[220:223], v[28:31], v[144:159]
    s_add_u32 m0, m0, 4096
    s_add_u32 s35, s35, 4096
    buffer_load_dwordx4 v248, s[24:27], s35 offen offset:0 lds
    ds_read_b64_tr_b16 v[200:201], v234 offset:7168
    ds_read_b64_tr_b16 v[202:203], v234 offset:7392
    v_pk_add_f32 v[72:73], v[72:73], v[12:13]
    v_pk_add_f32 v[74:75], v[74:75], v[12:13]
    s_waitcnt lgkmcnt(6)
    v_mfma_f32_32x32x16_bf16 v[160:175], v[224:227], v[28:31], v[160:175]
    buffer_load_dwordx4 v249, s[24:27], s35 offen offset:1024 lds
    ds_read_b64_tr_b16 v[204:205], v235 offset:7168
    ds_read_b64_tr_b16 v[206:207], v235 offset:7392
    v_cvt_pk_bf16_f32 v32, v68, v70
    v_cvt_pk_bf16_f32 v33, v72, v74
    s_waitcnt lgkmcnt(6)
    v_mfma_f32_32x32x16_bf16 v[112:127], v[212:215], v[28:31], v[112:127]
    buffer_load_dwordx4 v250, s[24:27], s35 offen offset:2048 lds
    ds_read_b64_tr_b16 v[192:193], v232 offset:7168
    ds_read_b64_tr_b16 v[194:195], v232 offset:7392
    v_cvt_pk_bf16_f32 v34, v69, v71
    v_cvt_pk_bf16_f32 v35, v73, v75
    s_waitcnt lgkmcnt(6)
    s_nop 0
    v_mfma_f32_32x32x16_bf16 v[128:143], v[196:199], v[32:35], v[128:143]
    s_add_u32 m0, m0, 3072
    s_add_u32 s35, s35, 24576
    buffer_load_dwordx4 v244, s[24:27], s35 offen offset:0 lds
    s_waitcnt vmcnt(8)
    ds_read_b64_tr_b16 v[216:217], v233 offset:10752
    ds_read_b64_tr_b16 v[218:219], v233 offset:10976
    v_pk_add_f32 v[76:77], v[76:77], v[12:13]
    v_pk_add_f32 v[78:79], v[78:79], v[12:13]
    s_waitcnt lgkmcnt(6)
    v_mfma_f32_32x32x16_bf16 v[144:159], v[200:203], v[32:35], v[144:159]
    buffer_load_dwordx4 v245, s[24:27], s35 offen offset:1024 lds
    ds_read_b64_tr_b16 v[220:221], v234 offset:10752
    ds_read_b64_tr_b16 v[222:223], v234 offset:10976
    v_pk_add_f32 v[80:81], v[80:81], v[12:13]
    v_pk_add_f32 v[82:83], v[82:83], v[12:13]
    s_waitcnt lgkmcnt(6)
    v_mfma_f32_32x32x16_bf16 v[160:175], v[204:207], v[32:35], v[160:175]
    buffer_load_dwordx4 v246, s[24:27], s35 offen offset:2048 lds
    ds_read_b64_tr_b16 v[224:225], v235 offset:10752
    ds_read_b64_tr_b16 v[226:227], v235 offset:10976
    v_cvt_pk_bf16_f32 v36, v76, v78
    v_cvt_pk_bf16_f32 v37, v80, v82
    s_waitcnt lgkmcnt(6)
    v_mfma_f32_32x32x16_bf16 v[112:127], v[192:195], v[32:35], v[112:127]
    s_mov_b32 exec_hi, 0
    buffer_load_dwordx4 v247, s[24:27], s35 offen offset:3072 lds
    s_mov_b32 exec_hi, -1
    ds_read_b64_tr_b16 v[212:213], v232 offset:10752
    ds_read_b64_tr_b16 v[214:215], v232 offset:10976
    v_cvt_pk_bf16_f32 v38, v77, v79
    v_cvt_pk_bf16_f32 v39, v81, v83
    s_waitcnt lgkmcnt(6)
    s_nop 0
    v_mfma_f32_32x32x16_bf16 v[128:143], v[216:219], v[36:39], v[128:143]
    s_waitcnt vmcnt(7)
    ds_read_b64_tr_b16 v[196:197], v233 offset:14336
    ds_read_b64_tr_b16 v[198:199], v233 offset:14560
    v_pk_add_f32 v[84:85], v[84:85], v[12:13]
    v_pk_add_f32 v[86:87], v[86:87], v[12:13]
    s_waitcnt lgkmcnt(6)
    v_mfma_f32_32x32x16_bf16 v[144:159], v[220:223], v[36:39], v[144:159]
    ds_read_b64_tr_b16 v[200:201], v234 offset:14336
    ds_read_b64_tr_b16 v[202:203], v234 offset:14560
    v_pk_add_f32 v[88:89], v[88:89], v[12:13]
    v_pk_add_f32 v[90:91], v[90:91], v[12:13]
    s_waitcnt lgkmcnt(6)
    v_mfma_f32_32x32x16_bf16 v[160:175], v[224:227], v[36:39], v[160:175]
    ds_read_b64_tr_b16 v[204:205], v235 offset:14336
    ds_read_b64_tr_b16 v[206:207], v235 offset:14560
    v_cvt_pk_bf16_f32 v40, v84, v86
    v_cvt_pk_bf16_f32 v41, v88, v90
    s_waitcnt lgkmcnt(6)
    v_mfma_f32_32x32x16_bf16 v[112:127], v[212:215], v[36:39], v[112:127]
    ds_read_b64_tr_b16 v[192:193], v232 offset:14336
    ds_read_b64_tr_b16 v[194:195], v232 offset:14560
    v_cvt_pk_bf16_f32 v42, v85, v87
    v_cvt_pk_bf16_f32 v43, v89, v91
    s_waitcnt lgkmcnt(6)
    s_nop 0
    v_mfma_f32_32x32x16_bf16 v[128:143], v[196:199], v[40:43], v[128:143]
    s_waitcnt vmcnt(4)
    ds_read_b64_tr_b16 v[216:217], v233 offset:17920
    ds_read_b64_tr_b16 v[218:219], v233 offset:18144
    v_pk_add_f32 v[92:93], v[92:93], v[12:13]
    v_pk_add_f32 v[94:95], v[94:95], v[12:13]
    s_waitcnt lgkmcnt(6)
    v_mfma_f32_32x32x16_bf16 v[144:159], v[200:203], v[40:43], v[144:159]
    ds_read_b64_tr_b16 v[220:221], v234 offset:17920
    ds_read_b64_tr_b16 v[222:223], v234 offset:18144
    v_pk_add_f32 v[96:97], v[96:97], v[12:13]
    v_pk_add_f32 v[98:99], v[98:99], v[12:13]
    s_waitcnt lgkmcnt(6)
    v_mfma_f32_32x32x16_bf16 v[160:175], v[204:207], v[40:43], v[160:175]
    ds_read_b64_tr_b16 v[224:225], v235 offset:17920
    ds_read_b64_tr_b16 v[226:227], v235 offset:18144
    v_cvt_pk_bf16_f32 v44, v92, v94
    v_cvt_pk_bf16_f32 v45, v96, v98
    s_waitcnt lgkmcnt(6)
    v_mfma_f32_32x32x16_bf16 v[112:127], v[192:195], v[40:43], v[112:127]
    ds_read_b64_tr_b16 v[212:213], v232 offset:17920
    ds_read_b64_tr_b16 v[214:215], v232 offset:18144
    v_cvt_pk_bf16_f32 v46, v93, v95
    v_cvt_pk_bf16_f32 v47, v97, v99
    s_waitcnt lgkmcnt(6)
    s_nop 0
    v_mfma_f32_32x32x16_bf16 v[128:143], v[216:219], v[44:47], v[128:143]
    s_waitcnt vmcnt(0)
    ds_read_b64_tr_b16 v[196:197], v233 offset:21504
    ds_read_b64_tr_b16 v[198:199], v233 offset:21728
    v_pk_add_f32 v[100:101], v[100:101], v[12:13]
    v_pk_add_f32 v[102:103], v[102:103], v[12:13]
    s_waitcnt lgkmcnt(6)
    v_mfma_f32_32x32x16_bf16 v[144:159], v[220:223], v[44:47], v[144:159]
    ds_read_b64_tr_b16 v[200:201], v234 offset:21504
    ds_read_b64_tr_b16 v[202:203], v234 offset:21728
    v_pk_add_f32 v[104:105], v[104:105], v[12:13]
    v_pk_add_f32 v[106:107], v[106:107], v[12:13]
    s_waitcnt lgkmcnt(6)
    v_mfma_f32_32x32x16_bf16 v[160:175], v[224:227], v[44:47], v[160:175]
    ds_read_b64_tr_b16 v[204:205], v235 offset:21504
    ds_read_b64_tr_b16 v[206:207], v235 offset:21728
    v_cvt_pk_bf16_f32 v48, v100, v102
    v_cvt_pk_bf16_f32 v49, v104, v106
    s_waitcnt lgkmcnt(6)
    v_mfma_f32_32x32x16_bf16 v[112:127], v[212:215], v[44:47], v[112:127]
    ds_read_b64_tr_b16 v[192:193], v232 offset:21504
    ds_read_b64_tr_b16 v[194:195], v232 offset:21728
    v_cvt_pk_bf16_f32 v50, v101, v103
    v_cvt_pk_bf16_f32 v51, v105, v107
    s_waitcnt lgkmcnt(6)
    s_nop 0
    v_mfma_f32_32x32x16_bf16 v[128:143], v[196:199], v[48:51], v[128:143]
    s_waitcnt lgkmcnt(4)
    v_mfma_f32_32x32x16_bf16 v[144:159], v[200:203], v[48:51], v[144:159]
    s_waitcnt lgkmcnt(2)
    v_mfma_f32_32x32x16_bf16 v[160:175], v[204:207], v[48:51], v[160:175]
    s_waitcnt lgkmcnt(0)
    v_mfma_f32_32x32x16_bf16 v[112:127], v[192:195], v[48:51], v[112:127]
    ds_write_b128 v237, v[128:131] offset:0
    ds_write_b128 v237, v[132:135] offset:1024
    ds_write_b128 v237, v[136:139] offset:2048
    ds_write_b128 v237, v[140:143] offset:3072
    ds_write_b128 v237, v[144:147] offset:4096
    ds_write_b128 v237, v[148:151] offset:5120
    ds_write_b128 v237, v[152:155] offset:6144
    ds_write_b128 v237, v[156:159] offset:7168
    ds_write_b128 v237, v[160:163] offset:8192
    ds_write_b128 v237, v[164:167] offset:9216
    ds_write_b128 v237, v[168:171] offset:10240
    ds_write_b128 v237, v[172:175] offset:11264
    s_branch pq_qr
pq_q1:
    s_mov_b32 s43, 0
    v_mov_b32 v23, 1
    v_bfe_u32 v12, v2, 2, 2
    v_and_b32 v13, 3, v2
    v_bfe_u32 v14, v2, 4, 1
    v_lshlrev_b32 v12, 1, v12
    v_lshl_add_u32 v15, v4, 3, v12
    v_and_b32 v16, 1, v13
    v_lshrrev_b32 v17, 1, v13
    v_lshl_add_u32 v20, v16, 1, v17
    v_lshl_add_u32 v20, v14, 2, v20
    v_lshlrev_b32 v20, 3, v20
    v_mul_u32_u24 v22, 224, v15
    v_add3_u32 v22, v22, v20, s32
    s_xor_b32 s38, s3, 0
    s_mul_i32 s42, s38, 25088
    s_mul_i32 s38, s38, 56
    v_add_u32 v232, s38, v22
    v_add_u32 v237, s42, v6
    s_xor_b32 s38, s3, 1
    s_mul_i32 s42, s38, 25088
    s_mul_i32 s38, s38, 56
    v_add_u32 v233, s38, v22
    v_add_u32 v238, s42, v6
    s_xor_b32 s38, s3, 2
    s_mul_i32 s42, s38, 25088
    s_mul_i32 s38, s38, 56
    v_add_u32 v234, s38, v22
    v_add_u32 v239, s42, v6
    s_xor_b32 s38, s3, 3
    s_mul_i32 s42, s38, 25088
    s_mul_i32 s38, s38, 56
    v_add_u32 v235, s38, v22
    v_add_u32 v240, s42, v6
    v_mul_u32_u24 v15, 56, v15
    v_add3_u32 v236, v15, v20, s39
    s_waitcnt vmcnt(0)
    ds_write_b32 v19, v23 offset:24
    ds_read_b128 v[24:27], v7 offset:0
    ds_read_b128 v[28:31], v7 offset:32
    ds_read_b128 v[32:35], v7 offset:64
    ds_read_b128 v[36:39], v7 offset:96
    ds_read_b128 v[40:43], v7 offset:128
    ds_read_b128 v[44:47], v7 offset:160
    ds_read_b128 v[48:51], v7 offset:192
    s_waitcnt lgkmcnt(6)
    s_mov_b32 m0, s39
    s_nop 0
    buffer_load_dwordx4 v6, s[12:15], s37 offen offset:0 lds
    v_lshlrev_b32 v52, 16, v24
    v_and_b32 v53, 0xffff0000, v24
    v_pk_mul_f32 v[10:11], v[52:53], v[52:53]
    v_pk_add_f32 v[12:13], v[52:53], 0
    v_lshlrev_b32 v54, 16, v25
    v_and_b32 v55, 0xffff0000, v25
    v_pk_mul_f32 v[14:15], v[54:55], v[54:55]
    v_pk_add_f32 v[16:17], v[54:55], 0
    v_lshlrev_b32 v56, 16, v26
    v_and_b32 v57, 0xffff0000, v26
    v_pk_fma_f32 v[10:11], v[56:57], v[56:57], v[10:11]
    v_pk_add_f32 v[12:13], v[12:13], v[56:57]
    v_lshlrev_b32 v58, 16, v27
    v_and_b32 v59, 0xffff0000, v27
    v_pk_fma_f32 v[14:15], v[58:59], v[58:59], v[14:15]
    v_pk_add_f32 v[16:17], v[16:17], v[58:59]
    s_waitcnt lgkmcnt(5)
    v_lshlrev_b32 v60, 16, v28
    v_and_b32 v61, 0xffff0000, v28
    v_pk_fma_f32 v[10:11], v[60:61], v[60:61], v[10:11]
    v_pk_add_f32 v[12:13], v[12:13], v[60:61]
    v_lshlrev_b32 v62, 16, v29
    v_and_b32 v63, 0xffff0000, v29
    v_pk_fma_f32 v[14:15], v[62:63], v[62:63], v[14:15]
    v_pk_add_f32 v[16:17], v[16:17], v[62:63]
    v_lshlrev_b32 v64, 16, v30
    v_and_b32 v65, 0xffff0000, v30
    v_pk_fma_f32 v[10:11], v[64:65], v[64:65], v[10:11]
    v_pk_add_f32 v[12:13], v[12:13], v[64:65]
    v_lshlrev_b32 v66, 16, v31
    v_and_b32 v67, 0xffff0000, v31
    v_pk_fma_f32 v[14:15], v[66:67], v[66:67], v[14:15]
    v_pk_add_f32 v[16:17], v[16:17], v[66:67]
    s_waitcnt lgkmcnt(4)
    v_lshlrev_b32 v68, 16, v32
    v_and_b32 v69, 0xffff0000, v32
    v_pk_fma_f32 v[10:11], v[68:69], v[68:69], v[10:11]
    v_pk_add_f32 v[12:13], v[12:13], v[68:69]
    v_lshlrev_b32 v70, 16, v33
    v_and_b32 v71, 0xffff0000, v33
    v_pk_fma_f32 v[14:15], v[70:71], v[70:71], v[14:15]
    v_pk_add_f32 v[16:17], v[16:17], v[70:71]
    v_lshlrev_b32 v72, 16, v34
    v_and_b32 v73, 0xffff0000, v34
    v_pk_fma_f32 v[10:11], v[72:73], v[72:73], v[10:11]
    v_pk_add_f32 v[12:13], v[12:13], v[72:73]
    v_lshlrev_b32 v74, 16, v35
    v_and_b32 v75, 0xffff0000, v35
    v_pk_fma_f32 v[14:15], v[74:75], v[74:75], v[14:15]
    v_pk_add_f32 v[16:17], v[16:17], v[74:75]
    s_waitcnt lgkmcnt(3)
    v_lshlrev_b32 v76, 16, v36
    v_and_b32 v77, 0xffff0000, v36
    v_pk_fma_f32 v[10:11], v[76:77], v[76:77], v[10:11]
    v_pk_add_f32 v[12:13], v[12:13], v[76:77]
    v_lshlrev_b32 v78, 16, v37
    v_and_b32 v79, 0xffff0000, v37
    v_pk_fma_f32 v[14:15], v[78:79], v[78:79], v[14:15]
    v_pk_add_f32 v[16:17], v[16:17], v[78:79]
    v_lshlrev_b32 v80, 16, v38
    v_and_b32 v81, 0xffff0000, v38
    v_pk_fma_f32 v[10:11], v[80:81], v[80:81], v[10:11]
    v_pk_add_f32 v[12:13], v[12:13], v[80:81]
    v_lshlrev_b32 v82, 16, v39
    v_and_b32 v83, 0xffff0000, v39
    v_pk_fma_f32 v[14:15], v[82:83], v[82:83], v[14:15]
    v_pk_add_f32 v[16:17], v[16:17], v[82:83]
    s_waitcnt lgkmcnt(2)
    v_lshlrev_b32 v84, 16, v40
    v_and_b32 v85, 0xffff0000, v40
    v_pk_fma_f32 v[10:11], v[84:85], v[84:85], v[10:11]
    v_pk_add_f32 v[12:13], v[12:13], v[84:85]
    v_lshlrev_b32 v86, 16, v41
    v_and_b32 v87, 0xffff0000, v41
    v_pk_fma_f32 v[14:15], v[86:87], v[86:87], v[14:15]
    v_pk_add_f32 v[16:17], v[16:17], v[86:87]
    v_lshlrev_b32 v88, 16, v42
    v_and_b32 v89, 0xffff0000, v42
    v_pk_fma_f32 v[10:11], v[88:89], v[88:89], v[10:11]
    v_pk_add_f32 v[12:13], v[12:13], v[88:89]
    v_lshlrev_b32 v90, 16, v43
    v_and_b32 v91, 0xffff0000, v43
    v_pk_fma_f32 v[14:15], v[90:91], v[90:91], v[14:15]
    v_pk_add_f32 v[16:17], v[16:17], v[90:91]
    s_waitcnt lgkmcnt(1)
    v_lshlrev_b32 v92, 16, v44
    v_and_b32 v93, 0xffff0000, v44
    v_pk_fma_f32 v[10:11], v[92:93], v[92:93], v[10:11]
    v_pk_add_f32 v[12:13], v[12:13], v[92:93]
    v_lshlrev_b32 v94, 16, v45
    v_and_b32 v95, 0xffff0000, v45
    v_pk_fma_f32 v[14:15], v[94:95], v[94:95], v[14:15]
    v_pk_add_f32 v[16:17], v[16:17], v[94:95]
    v_lshlrev_b32 v96, 16, v46
    v_and_b32 v97, 0xffff0000, v46
    v_pk_fma_f32 v[10:11], v[96:97], v[96:97], v[10:11]
    v_pk_add_f32 v[12:13], v[12:13], v[96:97]
    v_lshlrev_b32 v98, 16, v47
    v_and_b32 v99, 0xffff0000, v47
    v_pk_fma_f32 v[14:15], v[98:99], v[98:99], v[14:15]
    v_pk_add_f32 v[16:17], v[16:17], v[98:99]
    s_waitcnt lgkmcnt(0)
    v_lshlrev_b32 v100, 16, v48
    v_and_b32 v101, 0xffff0000, v48
    v_pk_fma_f32 v[10:11], v[100:101], v[100:101], v[10:11]
    v_pk_add_f32 v[12:13], v[12:13], v[100:101]
    v_lshlrev_b32 v102, 16, v49
    v_and_b32 v103, 0xffff0000, v49
    v_pk_fma_f32 v[14:15], v[102:103], v[102:103], v[14:15]
    v_pk_add_f32 v[16:17], v[16:17], v[102:103]
    v_lshlrev_b32 v104, 16, v50
    v_and_b32 v105, 0xffff0000, v50
    v_pk_fma_f32 v[10:11], v[104:105], v[104:105], v[10:11]
    v_pk_add_f32 v[12:13], v[12:13], v[104:105]
    v_lshlrev_b32 v106, 16, v51
    v_and_b32 v107, 0xffff0000, v51
    v_pk_fma_f32 v[14:15], v[106:107], v[106:107], v[14:15]
    v_pk_add_f32 v[16:17], v[16:17], v[106:107]
    v_pk_add_f32 v[10:11], v[10:11], v[14:15]
    v_pk_add_f32 v[12:13], v[12:13], v[16:17]
    v_add_f32 v15, v10, v11
    v_add_f32 v14, v12, v13
    v_mov_b32 v16, v14
    v_mov_b32 v17, v15
    s_nop 0
    v_permlane32_swap_b32 v14, v16
    v_permlane32_swap_b32 v15, v17
    v_pk_add_f32 v[14:15], v[14:15], v[16:17]
    ds_write_b64 v8, v[14:15]
    buffer_load_dwordx4 v6, s[12:15], s37 offen offset:1024 lds
    buffer_load_dwordx4 v6, s[12:15], s37 offen offset:2048 lds
    buffer_load_dwordx4 v6, s[12:15], s37 offen offset:3072 lds
    s_add_u32 m0, s39, 4096
    s_add_u32 s37, s37, 4096
    buffer_load_dwordx4 v6, s[12:15], s37 offen offset:0 lds
    buffer_load_dwordx4 v6, s[12:15], s37 offen offset:1024 lds
    buffer_load_dwordx4 v6, s[12:15], s37 offen offset:2048 lds
    s_mov_b32 m0, s32
    s_nop 0
    buffer_load_dwordx4 v244, s[24:27], s35 offen offset:0 lds
    buffer_load_dwordx4 v245, s[24:27], s35 offen offset:1024 lds
    s_mov_b32 s23, 200000
ls5:
    ds_read_b64 v[10:11], v9 offset:0
    ds_read_b64 v[12:13], v9 offset:256
    ds_read_b64 v[14:15], v9 offset:512
    ds_read_b64 v[16:17], v9 offset:768
    s_sub_u32 s23, s23, 1
    s_cmp_eq_u32 s23, 0
    s_waitcnt lgkmcnt(0)
    s_cbranch_scc1 ls_out5
    v_max3_u32 v20, v11, v13, v15
    v_max_u32 v20, v20, v17
    v_cmp_eq_u32 vcc, -1, v20
    s_cbranch_vccnz ls5
ls_out5:
    v_pk_add_f32 v[10:11], v[10:11], v[12:13]
    v_pk_add_f32 v[14:15], v[14:15], v[16:17]
    v_pk_add_f32 v[10:11], v[10:11], v[14:15]
    v_mul_f32 v12, 0xbb124925, v10
    v_mul_f32 v11, 0x3b124925, v11
    v_mov_b32 v13, v12
    v_fma_f32 v11, -v12, v12, v11
    v_max_f32 v11, 0, v11
    v_add_f32 v11, 0x3727c5ac, v11
    v_rsq_f32 v10, v11
    s_nop 0
    v_mul_f32 v10, 0x3e8b97f6, v10
    v_mov_b32 v11, v10
    buffer_load_dwordx4 v246, s[24:27], s35 offen offset:2048 lds
    buffer_load_dwordx4 v247, s[24:27], s35 offen offset:3072 lds
    s_add_u32 m0, m0, 4096
    s_add_u32 s35, s35, 4096
    buffer_load_dwordx4 v248, s[24:27], s35 offen offset:0 lds
    buffer_load_dwordx4 v249, s[24:27], s35 offen offset:1024 lds
    buffer_load_dwordx4 v250, s[24:27], s35 offen offset:2048 lds
    s_add_u32 m0, m0, 3072
    s_add_u32 s35, s35, 24576
    buffer_load_dwordx4 v244, s[24:27], s35 offen offset:0 lds
    buffer_load_dwordx4 v245, s[24:27], s35 offen offset:1024 lds
    buffer_load_dwordx4 v246, s[24:27], s35 offen offset:2048 lds
    buffer_load_dwordx4 v247, s[24:27], s35 offen offset:3072 lds
    s_add_u32 m0, m0, 4096
    s_add_u32 s35, s35, 4096
    buffer_load_dwordx4 v248, s[24:27], s35 offen offset:0 lds
    buffer_load_dwordx4 v249, s[24:27], s35 offen offset:1024 lds
    s_waitcnt vmcnt(9)
    ds_read_b64_tr_b16 v[208:209], v236 offset:0
    ds_read_b64_tr_b16 v[210:211], v236 offset:56
    ds_read_b64_tr_b16 v[196:197], v233 offset:0
    ds_read_b64_tr_b16 v[198:199], v233 offset:224
    ds_read_b64_tr_b16 v[200:201], v234 offset:0
    ds_read_b64_tr_b16 v[202:203], v234 offset:224
    ds_read_b64_tr_b16 v[204:205], v235 offset:0
    ds_read_b64_tr_b16 v[206:207], v235 offset:224
    ds_read_b64_tr_b16 v[192:193], v232 offset:0
    ds_read_b64_tr_b16 v[194:195], v232 offset:224
    v_pk_add_f32 v[52:53], v[52:53], v[12:13]
    v_pk_add_f32 v[54:55], v[54:55], v[12:13]
    v_pk_add_f32 v[56:57], v[56:57], v[12:13]
    v_pk_add_f32 v[58:59], v[58:59], v[12:13]
    v_cvt_pk_bf16_f32 v24, v52, v54
    v_cvt_pk_bf16_f32 v25, v56, v58
    v_cvt_pk_bf16_f32 v26, v53, v55
    v_cvt_pk_bf16_f32 v27, v57, v59
    s_waitcnt lgkmcnt(8)
    s_nop 0
    v_mfma_f32_32x32x16_bf16 v[176:191], v[208:211], v[24:27], 0
    buffer_load_dwordx4 v250, s[24:27], s35 offen offset:2048 lds
    s_waitcnt vmcnt(7)
    ds_read_b64_tr_b16 v[228:229], v236 offset:896
    ds_read_b64_tr_b16 v[230:231], v236 offset:952
    v_pk_add_f32 v[60:61], v[60:61], v[12:13]
    v_pk_add_f32 v[62:63], v[62:63], v[12:13]
    s_waitcnt lgkmcnt(8)
    v_mfma_f32_32x32x16_bf16 v[128:143], v[196:199], v[24:27], 0
    s_add_u32 m0, m0, 3072
    s_add_u32 s35, s35, 24576
    buffer_load_dwordx4 v244, s[24:27], s35 offen offset:0 lds
    ds_read_b64_tr_b16 v[216:217], v233 offset:3584
    ds_read_b64_tr_b16 v[218:219], v233 offset:3808
    v_pk_add_f32 v[64:65], v[64:65], v[12:13]
    v_pk_add_f32 v[66:67], v[66:67], v[12:13]
    s_waitcnt lgkmcnt(8)
    v_mfma_f32_32x32x16_bf16 v[144:159], v[200:203], v[24:27], 0
    buffer_load_dwordx4 v245, s[24:27], s35 offen offset:1024 lds
    ds_read_b64_tr_b16 v[220:221], v234 offset:3584
    ds_read_b64_tr_b16 v[222:223], v234 offset:3808
    v_cvt_pk_bf16_f32 v28, v60, v62
    v_cvt_pk_bf16_f32 v29, v64, v66
    s_waitcnt lgkmcnt(8)
    v_mfma_f32_32x32x16_bf16 v[160:175], v[204:207], v[24:27], 0
    buffer_load_dwordx4 v246, s[24:27], s35 offen offset:2048 lds
    ds_read_b64_tr_b16 v[224:225], v235 offset:3584
    ds_read_b64_tr_b16 v[226:227], v235 offset:3808
    v_cvt_pk_bf16_f32 v30, v61, v63
    v_cvt_pk_bf16_f32 v31, v65, v67
    s_waitcnt lgkmcnt(8)
    v_mfma_f32_32x32x16_bf16 v[112:127], v[192:195], v[24:27], 0
    buffer_load_dwordx4 v247, s[24:27], s35 offen offset:3072 lds
    ds_read_b64_tr_b16 v[212:213], v232 offset:3584
    ds_read_b64_tr_b16 v[214:215], v232 offset:3808
    s_waitcnt lgkmcnt(8)
    v_mfma_f32_32x32x16_bf16 v[176:191], v[228:231], v[28:31], v[176:191]
    s_add_u32 m0, m0, 4096
    s_add_u32 s35, s35, 4096
    buffer_load_dwordx4 v248, s[24:27], s35 offen offset:0 lds
    s_waitcnt vmcnt(8)
    ds_read_b64_tr_b16 v[208:209], v236 offset:1792
    ds_read_b64_tr_b16 v[210:211], v236 offset:1848
    v_pk_add_f32 v[68:69], v[68:69], v[12:13]
    v_pk_add_f32 v[70:71], v[70:71], v[12:13]
    s_waitcnt lgkmcnt(8)
    v_mfma_f32_32x32x16_bf16 v[128:143], v[216:219], v[28:31], v[128:143]
    buffer_load_dwordx4 v249, s[24:27], s35 offen offset:1024 lds
    ds_read_b64_tr_b16 v[196:197], v233 offset:7168
    ds_read_b64_tr_b16 v[198:199], v233 offset:7392
    v_pk_add_f32 v[72:73], v[72:73], v[12:13]
    v_pk_add_f32 v[74:75], v[74:75], v[12:13]
    s_waitcnt lgkmcnt(8)
    v_mfma_f32_32x32x16_bf16 v[144:159], v[220:223], v[28:31], v[144:159]
    buffer_load_dwordx4 v250, s[24:27], s35 offen offset:2048 lds
    ds_read_b64_tr_b16 v[200:201], v234 offset:7168
    ds_read_b64_tr_b16 v[202:203], v234 offset:7392
    v_cvt_pk_bf16_f32 v32, v68, v70
    v_cvt_pk_bf16_f32 v33, v72, v74
    s_waitcnt lgkmcnt(8)
    v_mfma_f32_32x32x16_bf16 v[160:175], v[224:227], v[28:31], v[160:175]
    s_add_u32 m0, m0, 3072
    s_add_u32 s35, s35, 24576
    buffer_load_dwordx4 v244, s[24:27], s35 offen offset:0 lds
    ds_read_b64_tr_b16 v[204:205], v235 offset:7168
    ds_read_b64_tr_b16 v[206:207], v235 offset:7392
    v_cvt_pk_bf16_f32 v34, v69, v71
    v_cvt_pk_bf16_f32 v35, v73, v75
    s_waitcnt lgkmcnt(8)
    v_mfma_f32_32x32x16_bf16 v[112:127], v[212:215], v[28:31], v[112:127]
    buffer_load_dwordx4 v245, s[24:27], s35 offen offset:1024 lds
    ds_read_b64_tr_b16 v[192:193], v232 offset:7168
    ds_read_b64_tr_b16 v[194:195], v232 offset:7392
    s_waitcnt lgkmcnt(8)
    v_mfma_f32_32x32x16_bf16 v[176:191], v[208:211], v[32:35], v[176:191]
    buffer_load_dwordx4 v246, s[24:27], s35 offen offset:2048 lds
    s_waitcnt vmcnt(10)
    ds_read_b64_tr_b16 v[228:229], v236 offset:2688
    ds_read_b64_tr_b16 v[230:231], v236 offset:2744
    v_pk_add_f32 v[76:77], v[76:77], v[12:13]
    v_pk_add_f32 v[78:79], v[78:79], v[12:13]
    s_waitcnt lgkmcnt(8)
    v_mfma_f32_32x32x16_bf16 v[128:143], v[196:199], v[32:35], v[128:143]
    s_mov_b32 exec_hi, 0
    buffer_load_dwordx4 v247, s[24:27], s35 offen offset:3072 lds
    s_mov_b32 exec_hi, -1
    ds_read_b64_tr_b16 v[216:217], v233 offset:10752
    ds_read_b64_tr_b16 v[218:219], v233 offset:10976
    v_pk_add_f32 v[80:81], v[80:81], v[12:13]
    v_pk_add_f32 v[82:83], v[82:83], v[12:13]
    s_waitcnt lgkmcnt(8)
    v_mfma_f32_32x32x16_bf16 v[144:159], v[200:203], v[32:35], v[144:159]
    ds_read_b64_tr_b16 v[220:221], v234 offset:10752
    ds_read_b64_tr_b16 v[222:223], v234 offset:10976
    v_cvt_pk_bf16_f32 v36, v76, v78
    v_cvt_pk_bf16_f32 v37, v80, v82
    s_waitcnt lgkmcnt(8)
    v_mfma_f32_32x32x16_bf16 v[160:175], v[204:207], v[32:35], v[160:175]
    ds_read_b64_tr_b16 v[224:225], v235 offset:10752
    ds_read_b64_tr_b16 v[226:227], v235 offset:10976
    v_cvt_pk_bf16_f32 v38, v77, v79
    v_cvt_pk_bf16_f32 v39, v81, v83
    s_waitcnt lgkmcnt(8)
    v_mfma_f32_32x32x16_bf16 v[112:127], v[192:195], v[32:35], v[112:127]
    ds_read_b64_tr_b16 v[212:213], v232 offset:10752
    ds_read_b64_tr_b16 v[214:215], v232 offset:10976
    s_waitcnt lgkmcnt(8)
    v_mfma_f32_32x32x16_bf16 v[176:191], v[228:231], v[36:39], v[176:191]
    s_waitcnt vmcnt(7)
    ds_read_b64_tr_b16 v[208:209], v236 offset:3584
    ds_read_b64_tr_b16 v[210:211], v236 offset:3640
    v_pk_add_f32 v[84:85], v[84:85], v[12:13]
    v_pk_add_f32 v[86:87], v[86:87], v[12:13]
    s_waitcnt lgkmcnt(8)
    v_mfma_f32_32x32x16_bf16 v[128:143], v[216:219], v[36:39], v[128:143]
    ds_read_b64_tr_b16 v[196:197], v233 offset:14336
    ds_read_b64_tr_b16 v[198:199], v233 offset:14560
    v_pk_add_f32 v[88:89], v[88:89], v[12:13]
    v_pk_add_f32 v[90:91], v[90:91], v[12:13]
    s_waitcnt lgkmcnt(8)
    v_mfma_f32_32x32x16_bf16 v[144:159], v[220:223], v[36:39], v[144:159]
    ds_read_b64_tr_b16 v[200:201], v234 offset:14336
    ds_read_b64_tr_b16 v[202:203], v234 offset:14560
    v_cvt_pk_bf16_f32 v40, v84, v86
    v_cvt_pk_bf16_f32 v41, v88, v90
    s_waitcnt lgkmcnt(8)
    v_mfma_f32_32x32x16_bf16 v[160:175], v[224:227], v[36:39], v[160:175]
    ds_read_b64_tr_b16 v[204:205], v235 offset:14336
    ds_read_b64_tr_b16 v[206:207], v235 offset:14560
    v_cvt_pk_bf16_f32 v42, v85, v87
    v_cvt_pk_bf16_f32 v43, v89, v91
    s_waitcnt lgkmcnt(8)
    v_mfma_f32_32x32x16_bf16 v[112:127], v[212:215], v[36:39], v[112:127]
    ds_read_b64_tr_b16 v[192:193], v232 offset:14336
    ds_read_b64_tr_b16 v[194:195], v232 offset:14560
    s_waitcnt lgkmcnt(8)
    v_mfma_f32_32x32x16_bf16 v[176:191], v[208:211], v[40:43], v[176:191]
    s_waitcnt vmcnt(4)
    ds_read_b64_tr_b16 v[228:229], v236 offset:4480
    ds_read_b64_tr_b16 v[230:231], v236 offset:4536
    v_pk_add_f32 v[92:93], v[92:93], v[12:13]
    v_pk_add_f32 v[94:95], v[94:95], v[12:13]
    s_waitcnt lgkmcnt(8)
    v_mfma_f32_32x32x16_bf16 v[128:143], v[196:199], v[40:43], v[128:143]
    ds_read_b64_tr_b16 v[216:217], v233 offset:17920
    ds_read_b64_tr_b16 v[218:219], v233 offset:18144
    v_pk_add_f32 v[96:97], v[96:97], v[12:13]
    v_pk_add_f32 v[98:99], v[98:99], v[12:13]
    s_waitcnt lgkmcnt(8)
    v_mfma_f32_32x32x16_bf16 v[144:159], v[200:203], v[40:43], v[144:159]
    ds_read_b64_tr_b16 v[220:221], v234 offset:17920
    ds_read_b64_tr_b16 v[222:223], v234 offset:18144
    v_cvt_pk_bf16_f32 v44, v92, v94
    v_cvt_pk_bf16_f32 v45, v96, v98
    s_waitcnt lgkmcnt(8)
    v_mfma_f32_32x32x16_bf16 v[160:175], v[204:207], v[40:43], v[160:175]
    ds_read_b64_tr_b16 v[224:225], v235 offset:17920
    ds_read_b64_tr_b16 v[226:227], v235 offset:18144
    v_cvt_pk_bf16_f32 v46, v93, v95
    v_cvt_pk_bf16_f32 v47, v97, v99
    s_waitcnt lgkmcnt(8)
    v_mfma_f32_32x32x16_bf16 v[112:127], v[192:195], v[40:43], v[112:127]
    ds_read_b64_tr_b16 v[212:213], v232 offset:17920
    ds_read_b64_tr_b16 v[214:215], v232 offset:18144
    s_waitcnt lgkmcnt(8)
    v_mfma_f32_32x32x16_bf16 v[176:191], v[228:231], v[44:47], v[176:191]
    s_waitcnt vmcnt(0)
    ds_read_b64_tr_b16 v[208:209], v236 offset:5376
    ds_read_b64_tr_b16 v[210:211], v236 offset:5432
    v_pk_add_f32 v[100:101], v[100:101], v[12:13]
    v_pk_add_f32 v[102:103], v[102:103], v[12:13]
    s_waitcnt lgkmcnt(8)
    v_mfma_f32_32x32x16_bf16 v[128:143], v[216:219], v[44:47], v[128:143]
    ds_read_b64_tr_b16 v[196:197], v233 offset:21504
    ds_read_b64_tr_b16 v[198:199], v233 offset:21728
    v_pk_add_f32 v[104:105], v[104:105], v[12:13]
    v_pk_add_f32 v[106:107], v[106:107], v[12:13]
    s_waitcnt lgkmcnt(8)
    v_mfma_f32_32x32x16_bf16 v[144:159], v[220:223], v[44:47], v[144:159]
    ds_read_b64_tr_b16 v[200:201], v234 offset:21504
    ds_read_b64_tr_b16 v[202:203], v234 offset:21728
    v_cvt_pk_bf16_f32 v48, v100, v102
    v_cvt_pk_bf16_f32 v49, v104, v106
    s_waitcnt lgkmcnt(8)
    v_mfma_f32_32x32x16_bf16 v[160:175], v[224:227], v[44:47], v[160:175]
    ds_read_b64_tr_b16 v[204:205], v235 offset:21504
    ds_read_b64_tr_b16 v[206:207], v235 offset:21728
    v_cvt_pk_bf16_f32 v50, v101, v103
    v_cvt_pk_bf16_f32 v51, v105, v107
    s_waitcnt lgkmcnt(8)
    v_mfma_f32_32x32x16_bf16 v[112:127], v[212:215], v[44:47], v[112:127]
    ds_read_b64_tr_b16 v[192:193], v232 offset:21504
    ds_read_b64_tr_b16 v[194:195], v232 offset:21728
    s_waitcnt lgkmcnt(8)
    v_mfma_f32_32x32x16_bf16 v[176:191], v[208:211], v[48:51], v[176:191]
    s_waitcnt lgkmcnt(6)
    v_mfma_f32_32x32x16_bf16 v[128:143], v[196:199], v[48:51], v[128:143]
    s_waitcnt lgkmcnt(4)
    v_mfma_f32_32x32x16_bf16 v[144:159], v[200:203], v[48:51], v[144:159]
    s_waitcnt lgkmcnt(2)
    v_mfma_f32_32x32x16_bf16 v[160:175], v[204:207], v[48:51], v[160:175]
    s_waitcnt lgkmcnt(0)
    v_mfma_f32_32x32x16_bf16 v[112:127], v[192:195], v[48:51], v[112:127]
    ds_write_b128 v237, v[176:179] offset:12288
    ds_write_b128 v237, v[180:183] offset:13312
    ds_write_b128 v237, v[184:187] offset:14336
    ds_write_b128 v237, v[188:191] offset:15360
    ds_write_b128 v237, v[128:131] offset:0
    ds_write_b128 v237, v[132:135] offset:1024
    ds_write_b128 v237, v[136:139] offset:2048
    ds_write_b128 v237, v[140:143] offset:3072
    ds_write_b128 v237, v[144:147] offset:4096
    ds_write_b128 v237, v[148:151] offset:5120
    ds_write_b128 v237, v[152:155] offset:6144
    ds_write_b128 v237, v[156:159] offset:7168
    ds_write_b128 v237, v[160:163] offset:8192
    ds_write_b128 v237, v[164:167] offset:9216
    ds_write_b128 v237, v[168:171] offset:10240
    ds_write_b128 v237, v[172:175] offset:11264
    s_branch pq_qr
pq_q2:
    s_mov_b32 s43, 0
    v_mov_b32 v23, 1
    v_bfe_u32 v12, v2, 2, 2
    v_and_b32 v13, 3, v2
    v_bfe_u32 v14, v2, 4, 1
    v_lshlrev_b32 v12, 1, v12
    v_lshl_add_u32 v15, v4, 3, v12
    v_and_b32 v16, 1, v13
    v_lshrrev_b32 v17, 1, v13
    v_lshl_add_u32 v20, v16, 1, v17
    v_lshl_add_u32 v20, v14, 2, v20
    v_lshlrev_b32 v20, 3, v20
    v_mul_u32_u24 v22, 224, v15
    v_add3_u32 v22, v22, v20, s32
    s_xor_b32 s38, s3, 0
    s_mul_i32 s42, s38, 25088
    s_mul_i32 s38, s38, 56
    v_add_u32 v232, s38, v22
    v_add_u32 v237, s42, v6
    s_xor_b32 s38, s3, 1
    s_mul_i32 s42, s38, 25088
    s_mul_i32 s38, s38, 56
    v_add_u32 v233, s38, v22
    v_add_u32 v238, s42, v6
    s_xor_b32 s38, s3, 2
    s_mul_i32 s42, s38, 25088
    s_mul_i32 s38, s38, 56
    v_add_u32 v234, s38, v22
    v_add_u32 v239, s42, v6
    s_xor_b32 s38, s3, 3
    s_mul_i32 s42, s38, 25088
    s_mul_i32 s38, s38, 56
    v_add_u32 v235, s38, v22
    v_add_u32 v240, s42, v6
    v_lshl_add_u32 v17, v14, 1, v17
    v_lshl_add_u32 v17, v16, 2, v17
    v_lshlrev_b32 v20, 3, v17
    v_mul_u32_u24 v15, 56, v15
    v_add3_u32 v236, v15, v20, s39
    s_waitcnt vmcnt(0)
    ds_write_b32 v19, v23 offset:24
    ds_read_b128 v[24:27], v7 offset:0
    ds_read_b128 v[28:31], v7 offset:32
    ds_read_b128 v[32:35], v7 offset:64
    ds_read_b128 v[36:39], v7 offset:96
    ds_read_b128 v[40:43], v7 offset:128
    ds_read_b128 v[44:47], v7 offset:160
    ds_read_b128 v[48:51], v7 offset:192
    s_waitcnt lgkmcnt(6)
    s_mov_b32 m0, s39
    s_nop 0
    buffer_load_dwordx4 v6, s[12:15], s37 offen offset:0 lds
    v_lshlrev_b32 v52, 16, v24
    v_and_b32 v53, 0xffff0000, v24
    v_pk_mul_f32 v[10:11], v[52:53], v[52:53]
    v_pk_add_f32 v[12:13], v[52:53], 0
    v_lshlrev_b32 v54, 16, v25
    v_and_b32 v55, 0xffff0000, v25
    v_pk_mul_f32 v[14:15], v[54:55], v[54:55]
    v_pk_add_f32 v[16:17], v[54:55], 0
    v_lshlrev_b32 v56, 16, v26
    v_and_b32 v57, 0xffff0000, v26
    v_pk_fma_f32 v[10:11], v[56:57], v[56:57], v[10:11]
    v_pk_add_f32 v[12:13], v[12:13], v[56:57]
    v_lshlrev_b32 v58, 16, v27
    v_and_b32 v59, 0xffff0000, v27
    v_pk_fma_f32 v[14:15], v[58:59], v[58:59], v[14:15]
    v_pk_add_f32 v[16:17], v[16:17], v[58:59]
    s_waitcnt lgkmcnt(5)
    v_lshlrev_b32 v60, 16, v28
    v_and_b32 v61, 0xffff0000, v28
    v_pk_fma_f32 v[10:11], v[60:61], v[60:61], v[10:11]
    v_pk_add_f32 v[12:13], v[12:13], v[60:61]
    v_lshlrev_b32 v62, 16, v29
    v_and_b32 v63, 0xffff0000, v29
    v_pk_fma_f32 v[14:15], v[62:63], v[62:63], v[14:15]
    v_pk_add_f32 v[16:17], v[16:17], v[62:63]
    v_lshlrev_b32 v64, 16, v30
    v_and_b32 v65, 0xffff0000, v30
    v_pk_fma_f32 v[10:11], v[64:65], v[64:65], v[10:11]
    v_pk_add_f32 v[12:13], v[12:13], v[64:65]
    v_lshlrev_b32 v66, 16, v31
    v_and_b32 v67, 0xffff0000, v31
    v_pk_fma_f32 v[14:15], v[66:67], v[66:67], v[14:15]
    v_pk_add_f32 v[16:17], v[16:17], v[66:67]
    s_waitcnt lgkmcnt(4)
    v_lshlrev_b32 v68, 16, v32
    v_and_b32 v69, 0xffff0000, v32
    v_pk_fma_f32 v[10:11], v[68:69], v[68:69], v[10:11]
    v_pk_add_f32 v[12:13], v[12:13], v[68:69]
    v_lshlrev_b32 v70, 16, v33
    v_and_b32 v71, 0xffff0000, v33
    v_pk_fma_f32 v[14:15], v[70:71], v[70:71], v[14:15]
    v_pk_add_f32 v[16:17], v[16:17], v[70:71]
    v_lshlrev_b32 v72, 16, v34
    v_and_b32 v73, 0xffff0000, v34
    v_pk_fma_f32 v[10:11], v[72:73], v[72:73], v[10:11]
    v_pk_add_f32 v[12:13], v[12:13], v[72:73]
    v_lshlrev_b32 v74, 16, v35
    v_and_b32 v75, 0xffff0000, v35
    v_pk_fma_f32 v[14:15], v[74:75], v[74:75], v[14:15]
    v_pk_add_f32 v[16:17], v[16:17], v[74:75]
    s_waitcnt lgkmcnt(3)
    v_lshlrev_b32 v76, 16, v36
    v_and_b32 v77, 0xffff0000, v36
    v_pk_fma_f32 v[10:11], v[76:77], v[76:77], v[10:11]
    v_pk_add_f32 v[12:13], v[12:13], v[76:77]
    v_lshlrev_b32 v78, 16, v37
    v_and_b32 v79, 0xffff0000, v37
    v_pk_fma_f32 v[14:15], v[78:79], v[78:79], v[14:15]
    v_pk_add_f32 v[16:17], v[16:17], v[78:79]
    v_lshlrev_b32 v80, 16, v38
    v_and_b32 v81, 0xffff0000, v38
    v_pk_fma_f32 v[10:11], v[80:81], v[80:81], v[10:11]
    v_pk_add_f32 v[12:13], v[12:13], v[80:81]
    v_lshlrev_b32 v82, 16, v39
    v_and_b32 v83, 0xffff0000, v39
    v_pk_fma_f32 v[14:15], v[82:83], v[82:83], v[14:15]
    v_pk_add_f32 v[16:17], v[16:17], v[82:83]
    s_waitcnt lgkmcnt(2)
    v_lshlrev_b32 v84, 16, v40
    v_and_b32 v85, 0xffff0000, v40
    v_pk_fma_f32 v[10:11], v[84:85], v[84:85], v[10:11]
    v_pk_add_f32 v[12:13], v[12:13], v[84:85]
    v_lshlrev_b32 v86, 16, v41
    v_and_b32 v87, 0xffff0000, v41
    v_pk_fma_f32 v[14:15], v[86:87], v[86:87], v[14:15]
    v_pk_add_f32 v[16:17], v[16:17], v[86:87]
    v_lshlrev_b32 v88, 16, v42
    v_and_b32 v89, 0xffff0000, v42
    v_pk_fma_f32 v[10:11], v[88:89], v[88:89], v[10:11]
    v_pk_add_f32 v[12:13], v[12:13], v[88:89]
    v_lshlrev_b32 v90, 16, v43
    v_and_b32 v91, 0xffff0000, v43
    v_pk_fma_f32 v[14:15], v[90:91], v[90:91], v[14:15]
    v_pk_add_f32 v[16:17], v[16:17], v[90:91]
    s_waitcnt lgkmcnt(1)
    v_lshlrev_b32 v92, 16, v44
    v_and_b32 v93, 0xffff0000, v44
    v_pk_fma_f32 v[10:11], v[92:93], v[92:93], v[10:11]
    v_pk_add_f32 v[12:13], v[12:13], v[92:93]
    v_lshlrev_b32 v94, 16, v45
    v_and_b32 v95, 0xffff0000, v45
    v_pk_fma_f32 v[14:15], v[94:95], v[94:95], v[14:15]
    v_pk_add_f32 v[16:17], v[16:17], v[94:95]
    v_lshlrev_b32 v96, 16, v46
    v_and_b32 v97, 0xffff0000, v46
    v_pk_fma_f32 v[10:11], v[96:97], v[96:97], v[10:11]
    v_pk_add_f32 v[12:13], v[12:13], v[96:97]
    v_lshlrev_b32 v98, 16, v47
    v_and_b32 v99, 0xffff0000, v47
    v_pk_fma_f32 v[14:15], v[98:99], v[98:99], v[14:15]
    v_pk_add_f32 v[16:17], v[16:17], v[98:99]
    s_waitcnt lgkmcnt(0)
    v_lshlrev_b32 v100, 16, v48
    v_and_b32 v101, 0xffff0000, v48
    v_pk_fma_f32 v[10:11], v[100:101], v[100:101], v[10:11]
    v_pk_add_f32 v[12:13], v[12:13], v[100:101]
    v_lshlrev_b32 v102, 16, v49
    v_and_b32 v103, 0xffff0000, v49
    v_pk_fma_f32 v[14:15], v[102:103], v[102:103], v[14:15]
    v_pk_add_f32 v[16:17], v[16:17], v[102:103]
    v_lshlrev_b32 v104, 16, v50
    v_and_b32 v105, 0xffff0000, v50
    v_pk_fma_f32 v[10:11], v[104:105], v[104:105], v[10:11]
    v_pk_add_f32 v[12:13], v[12:13], v[104:105]
    v_lshlrev_b32 v106, 16, v51
    v_and_b32 v107, 0xffff0000, v51
    v_pk_fma_f32 v[14:15], v[106:107], v[106:107], v[14:15]
    v_pk_add_f32 v[16:17], v[16:17], v[106:107]
    v_pk_add_f32 v[10:11], v[10:11], v[14:15]
    v_pk_add_f32 v[12:13], v[12:13], v[16:17]
    v_add_f32 v15, v10, v11
    v_add_f32 v14, v12, v13
    v_mov_b32 v16, v14
    v_mov_b32 v17, v15
    s_nop 0
    v_permlane32_swap_b32 v14, v16
    v_permlane32_swap_b32 v15, v17
    v_pk_add_f32 v[14:15], v[14:15], v[16:17]
    ds_write_b64 v8, v[14:15]
    buffer_load_dwordx4 v6, s[12:15], s37 offen offset:1024 lds
    buffer_load_dwordx4 v6, s[12:15], s37 offen offset:2048 lds
    buffer_load_dwordx4 v6, s[12:15], s37 offen offset:3072 lds
    s_add_u32 m0, s39, 4096
    s_add_u32 s37, s37, 4096
    buffer_load_dwordx4 v6, s[12:15], s37 offen offset:0 lds
    buffer_load_dwordx4 v6, s[12:15], s37 offen offset:1024 lds
    buffer_load_dwordx4 v6, s[12:15], s37 offen offset:2048 lds
    s_mov_b32 m0, s32
    s_nop 0
    buffer_load_dwordx4 v244, s[24:27], s35 offen offset:0 lds
    buffer_load_dwordx4 v245, s[24:27], s35 offen offset:1024 lds
    s_mov_b32 s23, 200000
ls6:
    ds_read_b64 v[10:11], v9 offset:0
    ds_read_b64 v[12:13], v9 offset:256
    ds_read_b64 v[14:15], v9 offset:512
    ds_read_b64 v[16:17], v9 offset:768
    s_sub_u32 s23, s23, 1
    s_cmp_eq_u32 s23, 0
    s_waitcnt lgkmcnt(0)
    s_cbranch_scc1 ls_out6
    v_max3_u32 v20, v11, v13, v15
    v_max_u32 v20, v20, v17
    v_cmp_eq_u32 vcc, -1, v20
    s_cbranch_vccnz ls6
ls_out6:
    v_pk_add_f32 v[10:11], v[10:11], v[12:13]
    v_pk_add_f32 v[14:15], v[14:15], v[16:17]
    v_pk_add_f32 v[10:11], v[10:11], v[14:15]
    v_mul_f32 v12, 0xbb124925, v10
    v_mul_f32 v11, 0x3b124925, v11
    v_mov_b32 v13, v12
    v_fma_f32 v11, -v12, v12, v11
    v_max_f32 v11, 0, v11
    v_add_f32 v11, 0x3727c5ac, v11
    v_rsq_f32 v10, v11
    s_nop 0
    v_mul_f32 v10, 0x3e8b97f6, v10
    v_mov_b32 v11, v10
    buffer_load_dwordx4 v246, s[24:27], s35 offen offset:2048 lds
    buffer_load_dwordx4 v247, s[24:27], s35 offen offset:3072 lds
    s_add_u32 m0, m0, 4096
    s_add_u32 s35, s35, 4096
    buffer_load_dwordx4 v248, s[24:27], s35 offen offset:0 lds
    buffer_load_dwordx4 v249, s[24:27], s35 offen offset:1024 lds
    buffer_load_dwordx4 v250, s[24:27], s35 offen offset:2048 lds
    s_add_u32 m0, m0, 3072
    s_add_u32 s35, s35, 24576
    buffer_load_dwordx4 v244, s[24:27], s35 offen offset:0 lds
    buffer_load_dwordx4 v245, s[24:27], s35 offen offset:1024 lds
    buffer_load_dwordx4 v246, s[24:27], s35 offen offset:2048 lds
    buffer_load_dwordx4 v247, s[24:27], s35 offen offset:3072 lds
    s_add_u32 m0, m0, 4096
    s_add_u32 s35, s35, 4096
    buffer_load_dwordx4 v248, s[24:27], s35 offen offset:0 lds
    buffer_load_dwordx4 v249, s[24:27], s35 offen offset:1024 lds
    s_waitcnt vmcnt(9)
    ds_read_b64_tr_b16 v[208:209], v236 offset:0
    ds_read_b64_tr_b16 v[210:211], v236 offset:56
    ds_read_b64_tr_b16 v[196:197], v233 offset:0
    ds_read_b64_tr_b16 v[198:199], v233 offset:224
    ds_read_b64_tr_b16 v[200:201], v234 offset:0
    ds_read_b64_tr_b16 v[202:203], v234 offset:224
    ds_read_b64_tr_b16 v[204:205], v235 offset:0
    ds_read_b64_tr_b16 v[206:207], v235 offset:224
    ds_read_b64_tr_b16 v[192:193], v232 offset:0
    ds_read_b64_tr_b16 v[194:195], v232 offset:224
    v_pk_add_f32 v[52:53], v[52:53], v[12:13]
    v_pk_add_f32 v[54:55], v[54:55], v[12:13]
    v_pk_add_f32 v[56:57], v[56:57], v[12:13]
    v_pk_add_f32 v[58:59], v[58:59], v[12:13]
    v_cvt_pk_bf16_f32 v24, v52, v54
    v_cvt_pk_bf16_f32 v25, v56, v58
    v_cvt_pk_bf16_f32 v26, v53, v55
    v_cvt_pk_bf16_f32 v27, v57, v59
    s_waitcnt lgkmcnt(8)
    s_nop 0
    v_mfma_f32_32x32x16_bf16 v[176:191], v[24:27], v[208:211], 0
    buffer_load_dwordx4 v250, s[24:27], s35 offen offset:2048 lds
    s_waitcnt vmcnt(7)
    ds_read_b64_tr_b16 v[228:229], v236 offset:896
    ds_read_b64_tr_b16 v[230:231], v236 offset:952
    v_pk_add_f32 v[60:61], v[60:61], v[12:13]
    v_pk_add_f32 v[62:63], v[62:63], v[12:13]
    s_waitcnt lgkmcnt(8)
    v_mfma_f32_32x32x16_bf16 v[128:143], v[196:199], v[24:27], 0
    s_add_u32 m0, m0, 3072
    s_add_u32 s35, s35, 24576
    buffer_load_dwordx4 v244, s[24:27], s35 offen offset:0 lds
    ds_read_b64_tr_b16 v[216:217], v233 offset:3584
    ds_read_b64_tr_b16 v[218:219], v233 offset:3808
    v_pk_add_f32 v[64:65], v[64:65], v[12:13]
    v_pk_add_f32 v[66:67], v[66:67], v[12:13]
    s_waitcnt lgkmcnt(8)
    v_mfma_f32_32x32x16_bf16 v[144:159], v[200:203], v[24:27], 0
    buffer_load_dwordx4 v245, s[24:27], s35 offen offset:1024 lds
    ds_read_b64_tr_b16 v[220:221], v234 offset:3584
    ds_read_b64_tr_b16 v[222:223], v234 offset:3808
    v_cvt_pk_bf16_f32 v28, v60, v62
    v_cvt_pk_bf16_f32 v29, v64, v66
    s_waitcnt lgkmcnt(8)
    v_mfma_f32_32x32x16_bf16 v[160:175], v[204:207], v[24:27], 0
    buffer_load_dwordx4 v246, s[24:27], s35 offen offset:2048 lds
    ds_read_b64_tr_b16 v[224:225], v235 offset:3584
    ds_read_b64_tr_b16 v[226:227], v235 offset:3808
    v_cvt_pk_bf16_f32 v30, v61, v63
    v_cvt_pk_bf16_f32 v31, v65, v67
    s_waitcnt lgkmcnt(8)
    v_mfma_f32_32x32x16_bf16 v[112:127], v[192:195], v[24:27], 0
    buffer_load_dwordx4 v247, s[24:27], s35 offen offset:3072 lds
    ds_read_b64_tr_b16 v[212:213], v232 offset:3584
    ds_read_b64_tr_b16 v[214:215], v232 offset:3808
    s_waitcnt lgkmcnt(8)
    v_mfma_f32_32x32x16_bf16 v[176:191], v[28:31], v[228:231], v[176:191]
    s_add_u32 m0, m0, 4096
    s_add_u32 s35, s35, 4096
    buffer_load_dwordx4 v248, s[24:27], s35 offen offset:0 lds
    s_waitcnt vmcnt(8)
    ds_read_b64_tr_b16 v[208:209], v236 offset:1792
    ds_read_b64_tr_b16 v[210:211], v236 offset:1848
    v_pk_add_f32 v[68:69], v[68:69], v[12:13]
    v_pk_add_f32 v[70:71], v[70:71], v[12:13]
    s_waitcnt lgkmcnt(8)
    v_mfma_f32_32x32x16_bf16 v[128:143], v[216:219], v[28:31], v[128:143]
    buffer_load_dwordx4 v249, s[24:27], s35 offen offset:1024 lds
    ds_read_b64_tr_b16 v[196:197], v233 offset:7168
    ds_read_b64_tr_b16 v[198:199], v233 offset:7392
    v_pk_add_f32 v[72:73], v[72:73], v[12:13]
    v_pk_add_f32 v[74:75], v[74:75], v[12:13]
    s_waitcnt lgkmcnt(8)
    v_mfma_f32_32x32x16_bf16 v[144:159], v[220:223], v[28:31], v[144:159]
    buffer_load_dwordx4 v250, s[24:27], s35 offen offset:2048 lds
    ds_read_b64_tr_b16 v[200:201], v234 offset:7168
    ds_read_b64_tr_b16 v[202:203], v234 offset:7392
    v_cvt_pk_bf16_f32 v32, v68, v70
    v_cvt_pk_bf16_f32 v33, v72, v74
    s_waitcnt lgkmcnt(8)
    v_mfma_f32_32x32x16_bf16 v[160:175], v[224:227], v[28:31], v[160:175]
    s_add_u32 m0, m0, 3072
    s_add_u32 s35, s35, 24576
    buffer_load_dwordx4 v244, s[24:27], s35 offen offset:0 lds
    ds_read_b64_tr_b16 v[204:205], v235 offset:7168
    ds_read_b64_tr_b16 v[206:207], v235 offset:7392
    v_cvt_pk_bf16_f32 v34, v69, v71
    v_cvt_pk_bf16_f32 v35, v73, v75
    s_waitcnt lgkmcnt(8)
    v_mfma_f32_32x32x16_bf16 v[112:127], v[212:215], v[28:31], v[112:127]
    buffer_load_dwordx4 v245, s[24:27], s35 offen offset:1024 lds
    ds_read_b64_tr_b16 v[192:193], v232 offset:7168
    ds_read_b64_tr_b16 v[194:195], v232 offset:7392
    s_waitcnt lgkmcnt(8)
    v_mfma_f32_32x32x16_bf16 v[176:191], v[32:35], v[208:211], v[176:191]
    buffer_load_dwordx4 v246, s[24:27], s35 offen offset:2048 lds
    s_waitcnt vmcnt(10)
    ds_read_b64_tr_b16 v[228:229], v236 offset:2688
    ds_read_b64_tr_b16 v[230:231], v236 offset:2744
    v_pk_add_f32 v[76:77], v[76:77], v[12:13]
    v_pk_add_f32 v[78:79], v[78:79], v[12:13]
    s_waitcnt lgkmcnt(8)
    v_mfma_f32_32x32x16_bf16 v[128:143], v[196:199], v[32:35], v[128:143]
    s_mov_b32 exec_hi, 0
    buffer_load_dwordx4 v247, s[24:27], s35 offen offset:3072 lds
    s_mov_b32 exec_hi, -1
    ds_read_b64_tr_b16 v[216:217], v233 offset:10752
    ds_read_b64_tr_b16 v[218:219], v233 offset:10976
    v_pk_add_f32 v[80:81], v[80:81], v[12:13]
    v_pk_add_f32 v[82:83], v[82:83], v[12:13]
    s_waitcnt lgkmcnt(8)
    v_mfma_f32_32x32x16_bf16 v[144:159], v[200:203], v[32:35], v[144:159]
    ds_read_b64_tr_b16 v[220:221], v234 offset:10752
    ds_read_b64_tr_b16 v[222:223], v234 offset:10976
    v_cvt_pk_bf16_f32 v36, v76, v78
    v_cvt_pk_bf16_f32 v37, v80, v82
    s_waitcnt lgkmcnt(8)
    v_mfma_f32_32x32x16_bf16 v[160:175], v[204:207], v[32:35], v[160:175]
    ds_read_b64_tr_b16 v[224:225], v235 offset:10752
    ds_read_b64_tr_b16 v[226:227], v235 offset:10976
    v_cvt_pk_bf16_f32 v38, v77, v79
    v_cvt_pk_bf16_f32 v39, v81, v83
    s_waitcnt lgkmcnt(8)
    v_mfma_f32_32x32x16_bf16 v[112:127], v[192:195], v[32:35], v[112:127]
    ds_read_b64_tr_b16 v[212:213], v232 offset:10752
    ds_read_b64_tr_b16 v[214:215], v232 offset:10976
    s_waitcnt lgkmcnt(8)
    v_mfma_f32_32x32x16_bf16 v[176:191], v[36:39], v[228:231], v[176:191]
    s_waitcnt vmcnt(7)
    ds_read_b64_tr_b16 v[208:209], v236 offset:3584
    ds_read_b64_tr_b16 v[210:211], v236 offset:3640
    v_pk_add_f32 v[84:85], v[84:85], v[12:13]
    v_pk_add_f32 v[86:87], v[86:87], v[12:13]
    s_waitcnt lgkmcnt(8)
    v_mfma_f32_32x32x16_bf16 v[128:143], v[216:219], v[36:39], v[128:143]
    ds_read_b64_tr_b16 v[196:197], v233 offset:14336
    ds_read_b64_tr_b16 v[198:199], v233 offset:14560
    v_pk_add_f32 v[88:89], v[88:89], v[12:13]
    v_pk_add_f32 v[90:91], v[90:91], v[12:13]
    s_waitcnt lgkmcnt(8)
    v_mfma_f32_32x32x16_bf16 v[144:159], v[220:223], v[36:39], v[144:159]
    ds_read_b64_tr_b16 v[200:201], v234 offset:14336
    ds_read_b64_tr_b16 v[202:203], v234 offset:14560
    v_cvt_pk_bf16_f32 v40, v84, v86
    v_cvt_pk_bf16_f32 v41, v88, v90
    s_waitcnt lgkmcnt(8)
    v_mfma_f32_32x32x16_bf16 v[160:175], v[224:227], v[36:39], v[160:175]
    ds_read_b64_tr_b16 v[204:205], v235 offset:14336
    ds_read_b64_tr_b16 v[206:207], v235 offset:14560
    v_cvt_pk_bf16_f32 v42, v85, v87
    v_cvt_pk_bf16_f32 v43, v89, v91
    s_waitcnt lgkmcnt(8)
    v_mfma_f32_32x32x16_bf16 v[112:127], v[212:215], v[36:39], v[112:127]
    ds_read_b64_tr_b16 v[192:193], v232 offset:14336
    ds_read_b64_tr_b16 v[194:195], v232 offset:14560
    s_waitcnt lgkmcnt(8)
    v_mfma_f32_32x32x16_bf16 v[176:191], v[40:43], v[208:211], v[176:191]
    s_waitcnt vmcnt(4)
    ds_read_b64_tr_b16 v[228:229], v236 offset:4480
    ds_read_b64_tr_b16 v[230:231], v236 offset:4536
    v_pk_add_f32 v[92:93], v[92:93], v[12:13]
    v_pk_add_f32 v[94:95], v[94:95], v[12:13]
    s_waitcnt lgkmcnt(8)
    v_mfma_f32_32x32x16_bf16 v[128:143], v[196:199], v[40:43], v[128:143]
    ds_read_b64_tr_b16 v[216:217], v233 offset:17920
    ds_read_b64_tr_b16 v[218:219], v233 offset:18144
    v_pk_add_f32 v[96:97], v[96:97], v[12:13]
    v_pk_add_f32 v[98:99], v[98:99], v[12:13]
    s_waitcnt lgkmcnt(8)
    v_mfma_f32_32x32x16_bf16 v[144:159], v[200:203], v[40:43], v[144:159]
    ds_read_b64_tr_b16 v[220:221], v234 offset:17920
    ds_read_b64_tr_b16 v[222:223], v234 offset:18144
    v_cvt_pk_bf16_f32 v44, v92, v94
    v_cvt_pk_bf16_f32 v45, v96, v98
    s_waitcnt lgkmcnt(8)
    v_mfma_f32_32x32x16_bf16 v[160:175], v[204:207], v[40:43], v[160:175]
    ds_read_b64_tr_b16 v[224:225], v235 offset:17920
    ds_read_b64_tr_b16 v[226:227], v235 offset:18144
    v_cvt_pk_bf16_f32 v46, v93, v95
    v_cvt_pk_bf16_f32 v47, v97, v99
    s_waitcnt lgkmcnt(8)
    v_mfma_f32_32x32x16_bf16 v[112:127], v[192:195], v[40:43], v[112:127]
    ds_read_b64_tr_b16 v[212:213], v232 offset:17920
    ds_read_b64_tr_b16 v[214:215], v232 offset:18144
    s_waitcnt lgkmcnt(8)
    v_mfma_f32_32x32x16_bf16 v[176:191], v[44:47], v[228:231], v[176:191]
    s_waitcnt vmcnt(0)
    ds_read_b64_tr_b16 v[208:209], v236 offset:5376
    ds_read_b64_tr_b16 v[210:211], v236 offset:5432
    v_pk_add_f32 v[100:101], v[100:101], v[12:13]
    v_pk_add_f32 v[102:103], v[102:103], v[12:13]
    s_waitcnt lgkmcnt(8)
    v_mfma_f32_32x32x16_bf16 v[128:143], v[216:219], v[44:47], v[128:143]
    ds_read_b64_tr_b16 v[196:197], v233 offset:21504
    ds_read_b64_tr_b16 v[198:199], v233 offset:21728
    v_pk_add_f32 v[104:105], v[104:105], v[12:13]
    v_pk_add_f32 v[106:107], v[106:107], v[12:13]
    s_waitcnt lgkmcnt(8)
    v_mfma_f32_32x32x16_bf16 v[144:159], v[220:223], v[44:47], v[144:159]
    ds_read_b64_tr_b16 v[200:201], v234 offset:21504
    ds_read_b64_tr_b16 v[202:203], v234 offset:21728
    v_cvt_pk_bf16_f32 v48, v100, v102
    v_cvt_pk_bf16_f32 v49, v104, v106
    s_waitcnt lgkmcnt(8)
    v_mfma_f32_32x32x16_bf16 v[160:175], v[224:227], v[44:47], v[160:175]
    ds_read_b64_tr_b16 v[204:205], v235 offset:21504
    ds_read_b64_tr_b16 v[206:207], v235 offset:21728
    v_cvt_pk_bf16_f32 v50, v101, v103
    v_cvt_pk_bf16_f32 v51, v105, v107
    s_waitcnt lgkmcnt(8)
    v_mfma_f32_32x32x16_bf16 v[112:127], v[212:215], v[44:47], v[112:127]
    ds_read_b64_tr_b16 v[192:193], v232 offset:21504
    ds_read_b64_tr_b16 v[194:195], v232 offset:21728
    s_waitcnt lgkmcnt(8)
    v_mfma_f32_32x32x16_bf16 v[176:191], v[48:51], v[208:211], v[176:191]
    s_waitcnt lgkmcnt(6)
    v_mfma_f32_32x32x16_bf16 v[128:143], v[196:199], v[48:51], v[128:143]
    s_waitcnt lgkmcnt(4)
    v_mfma_f32_32x32x16_bf16 v[144:159], v[200:203], v[48:51], v[144:159]
    s_waitcnt lgkmcnt(2)
    v_mfma_f32_32x32x16_bf16 v[160:175], v[204:207], v[48:51], v[160:175]
    s_waitcnt lgkmcnt(0)
    v_mfma_f32_32x32x16_bf16 v[112:127], v[192:195], v[48:51], v[112:127]
    ds_write_b128 v237, v[176:179] offset:12288
    ds_write_b128 v237, v[180:183] offset:13312
    ds_write_b128 v237, v[184:187] offset:14336
    ds_write_b128 v237, v[188:191] offset:15360
    ds_write_b128 v237, v[128:131] offset:0
    ds_write_b128 v237, v[132:135] offset:1024
    ds_write_b128 v237, v[136:139] offset:2048
    ds_write_b128 v237, v[140:143] offset:3072
    ds_write_b128 v237, v[144:147] offset:4096
    ds_write_b128 v237, v[148:151] offset:5120
    ds_write_b128 v237, v[152:155] offset:6144
    ds_write_b128 v237, v[156:159] offset:7168
    ds_write_b128 v237, v[160:163] offset:8192
    ds_write_b128 v237, v[164:167] offset:9216
    ds_write_b128 v237, v[168:171] offset:10240
    ds_write_b128 v237, v[172:175] offset:11264
pq_qr:
    v_mov_b32 v12, 1
    ds_write_b32 v5, v12
    s_lshl_b32 s36, s33, 15
    s_lshl_b32 s38, s34, 13
    s_add_u32 s36, s36, s38
    s_lshl_b32 s38, s3, 11
    s_add_u32 s36, s36, s38
    s_add_u32 s36, s36, 6291456
    s_mov_b32 s23, 200000
ls7:
    ds_read_b128 v[20:23], v19
    s_sub_u32 s23, s23, 1
    s_cmp_eq_u32 s23, 0
    s_waitcnt lgkmcnt(0)
    s_cbranch_scc1 ls_out7
    v_and_b32 v20, v20, v21
    v_and_b32 v22, v22, v23
    v_and_b32 v20, v20, v22
    v_cmp_ne_u32 vcc, 1, v20
    s_cbranch_vccnz ls7
ls_out7:
    ds_read_b128 v[128:131], v238 offset:0
    ds_read_b128 v[132:135], v238 offset:1024
    ds_read_b128 v[136:139], v238 offset:2048
    ds_read_b128 v[140:143], v238 offset:3072
    ds_read_b128 v[144:147], v239 offset:4096
    ds_read_b128 v[148:151], v239 offset:5120
    ds_read_b128 v[152:155], v239 offset:6144
    ds_read_b128 v[156:159], v239 offset:7168
    ds_read_b128 v[160:163], v240 offset:8192
    ds_read_b128 v[164:167], v240 offset:9216
    ds_read_b128 v[168:171], v240 offset:10240
    ds_read_b128 v[172:175], v240 offset:11264
    s_waitcnt lgkmcnt(8)
    v_pk_add_f32 v[112:113], v[112:113], v[128:129]
    v_pk_add_f32 v[114:115], v[114:115], v[130:131]
    v_pk_add_f32 v[116:117], v[116:117], v[132:133]
    v_pk_add_f32 v[118:119], v[118:119], v[134:135]
    v_pk_add_f32 v[120:121], v[120:121], v[136:137]
    v_pk_add_f32 v[122:123], v[122:123], v[138:139]
    v_pk_add_f32 v[124:125], v[124:125], v[140:141]
    v_pk_add_f32 v[126:127], v[126:127], v[142:143]
    s_waitcnt lgkmcnt(4)
    v_pk_add_f32 v[112:113], v[112:113], v[144:145]
    v_pk_add_f32 v[114:115], v[114:115], v[146:147]
    v_pk_add_f32 v[116:117], v[116:117], v[148:149]
    v_pk_add_f32 v[118:119], v[118:119], v[150:151]
    v_pk_add_f32 v[120:121], v[120:121], v[152:153]
    v_pk_add_f32 v[122:123], v[122:123], v[154:155]
    v_pk_add_f32 v[124:125], v[124:125], v[156:157]
    v_pk_add_f32 v[126:127], v[126:127], v[158:159]
    s_waitcnt lgkmcnt(0)
    v_pk_add_f32 v[112:113], v[112:113], v[160:161]
    v_pk_add_f32 v[114:115], v[114:115], v[162:163]
    v_pk_add_f32 v[116:117], v[116:117], v[164:165]
    v_pk_add_f32 v[118:119], v[118:119], v[166:167]
    v_pk_add_f32 v[120:121], v[120:121], v[168:169]
    v_pk_add_f32 v[122:123], v[122:123], v[170:171]
    v_pk_add_f32 v[124:125], v[124:125], v[172:173]
    v_pk_add_f32 v[126:127], v[126:127], v[174:175]
    v_pk_mul_f32 v[112:113], v[112:113], v[10:11]
    v_pk_mul_f32 v[114:115], v[114:115], v[10:11]
    v_pk_mul_f32 v[116:117], v[116:117], v[10:11]
    v_pk_mul_f32 v[118:119], v[118:119], v[10:11]
    v_pk_mul_f32 v[120:121], v[120:121], v[10:11]
    v_pk_mul_f32 v[122:123], v[122:123], v[10:11]
    v_pk_mul_f32 v[124:125], v[124:125], v[10:11]
    v_pk_mul_f32 v[126:127], v[126:127], v[10:11]
    v_cvt_pk_bf16_f32 v24, v112, v113
    v_cvt_pk_bf16_f32 v25, v114, v115
    v_cvt_pk_bf16_f32 v26, v116, v117
    v_cvt_pk_bf16_f32 v27, v118, v119
    v_cvt_pk_bf16_f32 v28, v120, v121
    v_cvt_pk_bf16_f32 v29, v122, v123
    v_cvt_pk_bf16_f32 v30, v124, v125
    v_cvt_pk_bf16_f32 v31, v126, v127
    buffer_store_dwordx4 v[24:27], v6, s[28:31], s36 offen
    s_mov_b32 exec_lo, 0
    v_mov_b32 v30, 0
    v_mov_b32 v31, 0
    s_mov_b32 exec_lo, -1
    v_mov_b32 v12, 0
    v_mov_b32 v13, 0
    v_dot2_f32_bf16 v12, v24, v24, v12
    v_dot2_f32_bf16 v13, v25, v25, v13
    v_dot2_f32_bf16 v12, v26, v26, v12
    v_dot2_f32_bf16 v13, v27, v27, v13
    v_dot2_f32_bf16 v12, v28, v28, v12
    v_dot2_f32_bf16 v13, v29, v29, v13
    v_dot2_f32_bf16 v12, v30, v30, v12
    v_dot2_f32_bf16 v13, v31, v31, v13
    s_nop 2
    v_add_f32 v12, v12, v13
    v_mov_b32 v13, v12
    s_nop 1
    v_permlane32_swap_b32 v12, v13
    v_add_f32 v12, v12, v13
    v_sqrt_f32 v12, v12
    s_nop 0
    v_mul_f32 v12, 0x3f8147ae, v12
    s_mov_b32 exec_lo, 0
    v_cvt_pk_bf16_f32 v30, v12, 0
    s_mov_b32 exec_lo, -1
    buffer_store_dwordx4 v[28:31], v6, s[28:31], s36 offen offset:1024
    s_endpgm
.globl main0_kernel
.p2align 8
.type main0_kernel,@function
main0_kernel:
    s_cmp_ge_u32 s2, 256
    s_cbranch_scc1 main_end
    s_load_dwordx2 s[6:7], s[0:1], 88
    s_load_dwordx2 s[4:5], s[0:1], 72
    s_mov_b32 s39, -1
    s_mov_b32 s20, 6291456
    v_lshrrev_b32 v1, 6, v0
    v_and_b32 v2, 63, v0
    v_lshlrev_b32 v6, 4, v2
    v_readfirstlane_b32 s3, v1
    s_and_b32 s16, s2, 7
    s_lshr_b32 s17, s2, 3
    s_lshl_b32 s18, s16, 3
    s_lshr_b32 s42, s17, 2
    s_add_u32 s18, s18, s42
    s_and_b32 s19, s17, 3
    s_mov_b32 s38, 0
    s_mov_b32 s10, 268435456
    s_mov_b32 s11, 0x20000
    s_mov_b32 s14, 1835008
    s_mov_b32 s15, 0x20000
    s_mul_i32 s26, s3, 7168
    v_and_b32 v3, 31, v0
    v_bfe_u32 v4, v0, 5, 1
    s_getreg_b32 s37, hwreg(HW_REG_XCC_ID)
    s_and_b32 s37, s37, 15
    s_add_u32 s37, s37, 1
    s_lshl_b32 s42, s16, 5
    s_add_u32 s42, s42, s17
    s_lshl_b32 s36, s42, 7
    s_add_u32 s36, s36, 41959424
    v_mov_b32 v1, s37
    v_mov_b32 v2, 0
    s_add_u32 s21, s20, 2621440
    s_lshl_b32 s24, s18, 12
    s_add_u32 s24, s24, 42205184
    s_mul_i32 s28, s18, 28672
    s_add_u32 s28, s28, s26
    s_add_u32 s28, s28, s21
    s_add_u32 s29, s28, 4096
    s_waitcnt lgkmcnt(0)
    s_mov_b32 s8, s6
    s_and_b32 s9, s7, 0xffff
    s_mov_b32 s12, s4
    s_and_b32 s13, s5, 0xffff
    s_mul_i32 s0, s16, 7168
    s_add_u32 s0, s0, 41943040
    s_cmp_eq_u32 s3, 0
    s_cselect_b32 exec_lo, 1, 0
    s_mov_b32 exec_hi, 0
    buffer_store_dword v1, v2, s[8:11], s36 offen sc1
    s_mov_b64 exec, -1
    s_mov_b32 s42, 8650752
    s_buffer_load_dwordx2 s[4:5], s[8:11], s42
    s_lshl_b32 s23, s18, 15
    s_lshl_b32 s42, s19, 13
    s_add_u32 s23, s23, s42
    s_add_u32 s23, s23, s20
    s_xor_b32 s42, s3, 3
    s_lshl_b32 s42, s42, 11
    s_add_u32 s42, s42, s23
    buffer_load_dwordx4 v[16:19], v6, s[8:11], s42 offen offset:0
    buffer_load_dwordx4 v[20:23], v6, s[8:11], s42 offen offset:1024
    s_xor_b32 s42, s3, 2
    s_lshl_b32 s42, s42, 11
    s_add_u32 s42, s42, s23
    buffer_load_dwordx4 v[24:27], v6, s[8:11], s42 offen offset:0
    buffer_load_dwordx4 v[28:31], v6, s[8:11], s42 offen offset:1024
    s_xor_b32 s42, s3, 1
    s_lshl_b32 s42, s42, 11
    s_add_u32 s42, s42, s23
    buffer_load_dwordx4 v[32:35], v6, s[8:11], s42 offen offset:0
    buffer_load_dwordx4 v[36:39], v6, s[8:11], s42 offen offset:1024
    s_xor_b32 s42, s3, 0
    s_lshl_b32 s42, s42, 11
    s_add_u32 s42, s42, s23
    buffer_load_dwordx4 v[40:43], v6, s[8:11], s42 offen offset:0
    buffer_load_dwordx4 v[44:47], v6, s[8:11], s42 offen offset:1024
    s_branch l0_go
att_go:
    v_mov_b32 v234, 0
    s_mov_b32 exec_lo, 0
    v_lshlrev_b32 v12, 16, v22
    v_lshlrev_b32 v13, 16, v30
    v_lshlrev_b32 v14, 16, v38
    v_lshlrev_b32 v15, 16, v46
    v_max3_f32 v234, v12, v13, v14
    v_max_f32 v234, v234, v15
    v_mul_f32 v12, s22, v12
    v_mul_f32 v13, s22, v13
    v_mul_f32 v14, s22, v14
    v_mul_f32 v15, s22, v15
    v_cvt_pk_bf16_f32 v22, -v12, 0
    v_cvt_pk_bf16_f32 v30, -v13, 0
    v_cvt_pk_bf16_f32 v38, -v14, 0
    v_cvt_pk_bf16_f32 v46, -v15, 0
    s_mov_b32 exec_lo, -1
attn_main:
    s_or_b64 exec, s[44:45], 1
    buffer_load_dword v232, v8, s[8:11], 0 offen sc1
    s_mov_b64 exec, -1
    s_and_b32 s42, s17, 15
    s_mul_i32 s25, s42, 200704
    s_add_u32 s25, s25, s26
    s_add_u32 s25, s25, 1048576
    s_waitcnt vmcnt(7)
    v_mfma_f32_32x32x16_bf16 v[112:127], v[160:163], v[16:19], 0
    v_mfma_f32_32x32x16_bf16 v[112:127], v[164:167], v[20:23], v[112:127]
    s_waitcnt vmcnt(5)
    v_mfma_f32_32x32x16_bf16 v[128:143], v[160:163], v[24:27], 0
    s_add_u32 m0, s26, 0
    s_nop 2
    v_exp_f32 v112, v112
    v_exp_f32 v113, v113
    v_exp_f32 v114, v114
    v_exp_f32 v115, v115
    v_cvt_pk_bf16_f32 v144, v112, v113
    v_cvt_pk_bf16_f32 v145, v114, v115
    v_mfma_f32_32x32x16_bf16 v[128:143], v[164:167], v[28:31], v[128:143]
    v_exp_f32 v116, v116
    v_exp_f32 v117, v117
    v_exp_f32 v118, v118
    v_exp_f32 v119, v119
    v_cvt_pk_bf16_f32 v146, v116, v117
    v_cvt_pk_bf16_f32 v147, v118, v119
    v_exp_f32 v120, v120
    v_exp_f32 v121, v121
    v_exp_f32 v122, v122
    v_exp_f32 v123, v123
    v_cvt_pk_bf16_f32 v148, v120, v121
    v_cvt_pk_bf16_f32 v149, v122, v123
    v_mfma_f32_32x32x16_bf16 v[48:63], v[168:171], v[144:147], 0
    v_exp_f32 v124, v124
    v_exp_f32 v125, v125
    v_exp_f32 v126, v126
    v_exp_f32 v127, v127
    v_cvt_pk_bf16_f32 v150, v124, v125
    v_cvt_pk_bf16_f32 v151, v126, v127
    v_mfma_f32_32x32x16_bf16 v[112:127], v[160:163], v[32:35], 0
    s_add_u32 s31, s31, 0x8000
    v_exp_f32 v128, v128
    v_exp_f32 v129, v129
    v_exp_f32 v130, v130
    v_exp_f32 v131, v131
    v_cvt_pk_bf16_f32 v152, v128, v129
    v_cvt_pk_bf16_f32 v153, v130, v131
    v_mfma_f32_32x32x16_bf16 v[112:127], v[164:167], v[36:39], v[112:127]
    s_and_b32 s31, s31, 0x3ffff
    v_exp_f32 v132, v132
    v_exp_f32 v133, v133
    v_exp_f32 v134, v134
    v_exp_f32 v135, v135
    v_cvt_pk_bf16_f32 v154, v132, v133
    v_cvt_pk_bf16_f32 v155, v134, v135
    v_mfma_f32_32x32x16_bf16 v[48:63], v[172:175], v[148:151], v[48:63]
    v_exp_f32 v136, v136
    v_exp_f32 v137, v137
    v_exp_f32 v138, v138
    v_exp_f32 v139, v139
    v_cvt_pk_bf16_f32 v156, v136, v137
    v_cvt_pk_bf16_f32 v157, v138, v139
    v_mfma_f32_32x32x16_bf16 v[64:79], v[168:171], v[152:155], 0
    v_exp_f32 v140, v140
    v_exp_f32 v141, v141
    v_exp_f32 v142, v142
    v_exp_f32 v143, v143
    v_cvt_pk_bf16_f32 v158, v140, v141
    v_cvt_pk_bf16_f32 v159, v142, v143
    v_mfma_f32_32x32x16_bf16 v[128:143], v[160:163], v[40:43], 0
    s_waitcnt vmcnt(1)
    v_exp_f32 v112, v112
    v_exp_f32 v113, v113
    v_exp_f32 v114, v114
    v_exp_f32 v115, v115
    v_cvt_pk_bf16_f32 v144, v112, v113
    v_cvt_pk_bf16_f32 v145, v114, v115
    v_mfma_f32_32x32x16_bf16 v[128:143], v[164:167], v[44:47], v[128:143]
    s_waitcnt vmcnt(0)
    v_exp_f32 v116, v116
    v_exp_f32 v117, v117
    v_exp_f32 v118, v118
    v_exp_f32 v119, v119
    v_cmp_eq_u32 s[44:45], 0, v232
    v_cvt_pk_bf16_f32 v146, v116, v117
    v_cvt_pk_bf16_f32 v147, v118, v119
    v_mfma_f32_32x32x16_bf16 v[64:79], v[172:175], v[156:159], v[64:79]
    s_and_b32 s42, s44, 0xff00
    s_cbranch_scc1 pk_slow8
pk_back8:
    v_exp_f32 v120, v120
    v_exp_f32 v121, v121
    v_exp_f32 v122, v122
    v_exp_f32 v123, v123
    v_cvt_pk_bf16_f32 v148, v120, v121
    v_cvt_pk_bf16_f32 v149, v122, v123
    v_mfma_f32_32x32x16_bf16 v[80:95], v[168:171], v[144:147], 0
    s_add_u32 s23, s31, s28
    v_exp_f32 v124, v124
    v_exp_f32 v125, v125
    v_exp_f32 v126, v126
    v_exp_f32 v127, v127
    v_cvt_pk_bf16_f32 v150, v124, v125
    v_cvt_pk_bf16_f32 v151, v126, v127
    v_mfma_f32_32x32x16_bf16 v[112:127], v[176:179], v[16:19], 0
    buffer_load_dwordx4 v[192:195], v6, s[8:11], s23 offen offset:0
    buffer_load_dwordx4 v[196:199], v6, s[8:11], s23 offen offset:1024
    buffer_load_dwordx4 v[200:203], v6, s[8:11], s23 offen offset:2048
    buffer_load_dwordx4 v[204:207], v6, s[8:11], s23 offen offset:3072
    s_or_b64 exec, s[44:45], 1
    buffer_load_dword v232, v8, s[8:11], 0 offen sc1
    s_mov_b64 exec, -1
    v_exp_f32 v128, v128
    v_exp_f32 v129, v129
    v_exp_f32 v130, v130
    v_exp_f32 v131, v131
    v_cvt_pk_bf16_f32 v152, v128, v129
    v_cvt_pk_bf16_f32 v153, v130, v131
    v_mfma_f32_32x32x16_bf16 v[112:127], v[180:183], v[20:23], v[112:127]
    s_add_u32 s23, s23, 4096
    v_exp_f32 v132, v132
    v_exp_f32 v133, v133
    v_exp_f32 v134, v134
    v_exp_f32 v135, v135
    v_cvt_pk_bf16_f32 v154, v132, v133
    v_cvt_pk_bf16_f32 v155, v134, v135
    v_mfma_f32_32x32x16_bf16 v[80:95], v[172:175], v[148:151], v[80:95]
    buffer_load_dwordx4 v6, s[8:11], s25 offen offset:0 lds
    v_exp_f32 v136, v136
    v_exp_f32 v137, v137
    v_exp_f32 v138, v138
    v_exp_f32 v139, v139
    v_cvt_pk_bf16_f32 v156, v136, v137
    v_cvt_pk_bf16_f32 v157, v138, v139
    v_mfma_f32_32x32x16_bf16 v[96:111], v[168:171], v[152:155], 0
    s_xor_b32 s27, s19, 0
    v_exp_f32 v140, v140
    v_exp_f32 v141, v141
    v_exp_f32 v142, v142
    v_exp_f32 v143, v143
    v_cvt_pk_bf16_f32 v158, v140, v141
    v_cvt_pk_bf16_f32 v159, v142, v143
    v_mfma_f32_32x32x16_bf16 v[128:143], v[176:179], v[24:27], 0
    buffer_load_dwordx4 v[208:211], v6, s[8:11], s23 offen offset:0
    buffer_load_dwordx4 v[212:215], v6, s[8:11], s23 offen offset:1024
    v_exp_f32 v112, v112
    v_exp_f32 v113, v113
    v_exp_f32 v114, v114
    v_exp_f32 v115, v115
    v_cvt_pk_bf16_f32 v144, v112, v113
    v_cvt_pk_bf16_f32 v145, v114, v115
    v_mfma_f32_32x32x16_bf16 v[128:143], v[180:183], v[28:31], v[128:143]
    s_lshl_b32 s27, s27, 13
    v_exp_f32 v116, v116
    v_exp_f32 v117, v117
    v_exp_f32 v118, v118
    v_exp_f32 v119, v119
    v_cvt_pk_bf16_f32 v146, v116, v117
    v_cvt_pk_bf16_f32 v147, v118, v119
    v_mfma_f32_32x32x16_bf16 v[96:111], v[172:175], v[156:159], v[96:111]
    s_add_u32 s27, s27, s24
    v_exp_f32 v120, v120
    v_exp_f32 v121, v121
    v_exp_f32 v122, v122
    v_exp_f32 v123, v123
    v_cvt_pk_bf16_f32 v148, v120, v121
    v_cvt_pk_bf16_f32 v149, v122, v123
    v_mfma_f32_32x32x16_bf16 v[48:63], v[184:187], v[144:147], v[48:63]
    buffer_load_dwordx4 a[0:3], v6, s[8:11], s27 offen offset:0
    v_exp_f32 v124, v124
    v_exp_f32 v125, v125
    v_exp_f32 v126, v126
    v_exp_f32 v127, v127
    v_cvt_pk_bf16_f32 v150, v124, v125
    v_cvt_pk_bf16_f32 v151, v126, v127
    v_mfma_f32_32x32x16_bf16 v[112:127], v[176:179], v[32:35], 0
    buffer_load_dwordx4 v[216:219], v6, s[8:11], s23 offen offset:2048
    buffer_load_dwordx4 v[220:223], v6, s[8:11], s23 offen offset:3072
    v_exp_f32 v128, v128
    v_exp_f32 v129, v129
    v_exp_f32 v130, v130
    v_exp_f32 v131, v131
    v_cvt_pk_bf16_f32 v152, v128, v129
    v_cvt_pk_bf16_f32 v153, v130, v131
    v_mfma_f32_32x32x16_bf16 v[112:127], v[180:183], v[36:39], v[112:127]
    s_add_u32 s33, s35, 0
    v_exp_f32 v132, v132
    v_exp_f32 v133, v133
    v_exp_f32 v134, v134
    v_exp_f32 v135, v135
    v_cvt_pk_bf16_f32 v154, v132, v133
    v_cvt_pk_bf16_f32 v155, v134, v135
    v_mfma_f32_32x32x16_bf16 v[48:63], v[188:191], v[148:151], v[48:63]
    buffer_load_dwordx4 a[64:67], v238, s[8:11], s33 offen
    buffer_load_dwordx4 v6, s[8:11], s25 offen offset:1024 lds
    v_exp_f32 v136, v136
    v_exp_f32 v137, v137
    v_exp_f32 v138, v138
    v_exp_f32 v139, v139
    v_cvt_pk_bf16_f32 v156, v136, v137
    v_cvt_pk_bf16_f32 v157, v138, v139
    v_mfma_f32_32x32x16_bf16 v[64:79], v[184:187], v[152:155], v[64:79]
    buffer_load_dwordx4 a[4:7], v6, s[8:11], s27 offen offset:1024
    v_exp_f32 v140, v140
    v_exp_f32 v141, v141
    v_exp_f32 v142, v142
    v_exp_f32 v143, v143
    v_cvt_pk_bf16_f32 v158, v140, v141
    v_cvt_pk_bf16_f32 v159, v142, v143
    v_mfma_f32_32x32x16_bf16 v[128:143], v[176:179], v[40:43], 0
    s_waitcnt vmcnt(10)
    v_exp_f32 v112, v112
    v_exp_f32 v113, v113
    v_exp_f32 v114, v114
    v_exp_f32 v115, v115
    v_cvt_pk_bf16_f32 v144, v112, v113
    v_cvt_pk_bf16_f32 v145, v114, v115
    v_mfma_f32_32x32x16_bf16 v[128:143], v[180:183], v[44:47], v[128:143]
    s_add_u32 s31, s31, 0x8000
    v_exp_f32 v116, v116
    v_exp_f32 v117, v117
    v_exp_f32 v118, v118
    v_exp_f32 v119, v119
    v_cvt_pk_bf16_f32 v146, v116, v117
    v_cvt_pk_bf16_f32 v147, v118, v119
    v_mfma_f32_32x32x16_bf16 v[64:79], v[188:191], v[156:159], v[64:79]
    s_and_b32 s31, s31, 0x3ffff
    v_exp_f32 v120, v120
    v_exp_f32 v121, v121
    v_exp_f32 v122, v122
    v_exp_f32 v123, v123
    v_cvt_pk_bf16_f32 v148, v120, v121
    v_cvt_pk_bf16_f32 v149, v122, v123
    v_mfma_f32_32x32x16_bf16 v[80:95], v[184:187], v[144:147], v[80:95]
    buffer_load_dwordx4 v6, s[8:11], s25 offen offset:2048 lds
    v_exp_f32 v124, v124
    v_exp_f32 v125, v125
    v_exp_f32 v126, v126
    v_exp_f32 v127, v127
    v_cvt_pk_bf16_f32 v150, v124, v125
    v_cvt_pk_bf16_f32 v151, v126, v127
    v_mfma_f32_32x32x16_bf16 v[112:127], v[192:195], v[16:19], 0
    s_waitcnt vmcnt(10)
    v_exp_f32 v128, v128
    v_exp_f32 v129, v129
    v_exp_f32 v130, v130
    v_exp_f32 v131, v131
    v_cmp_eq_u32 s[44:45], 0, v232
    v_cvt_pk_bf16_f32 v152, v128, v129
    v_cvt_pk_bf16_f32 v153, v130, v131
    v_mfma_f32_32x32x16_bf16 v[112:127], v[196:199], v[20:23], v[112:127]
    s_and_b32 s42, s44, 0xff0000
    s_cbranch_scc1 pk_slow9
pk_back9:
    v_exp_f32 v132, v132
    v_exp_f32 v133, v133
    v_exp_f32 v134, v134
    v_exp_f32 v135, v135
    v_cvt_pk_bf16_f32 v154, v132, v133
    v_cvt_pk_bf16_f32 v155, v134, v135
    v_mfma_f32_32x32x16_bf16 v[80:95], v[188:191], v[148:151], v[80:95]
    s_add_u32 s23, s31, s28
    v_exp_f32 v136, v136
    v_exp_f32 v137, v137
    v_exp_f32 v138, v138
    v_exp_f32 v139, v139
    v_cvt_pk_bf16_f32 v156, v136, v137
    v_cvt_pk_bf16_f32 v157, v138, v139
    v_mfma_f32_32x32x16_bf16 v[96:111], v[184:187], v[152:155], v[96:111]
    buffer_load_dwordx4 a[68:71], v239, s[8:11], s33 offen
    buffer_load_dwordx4 v6, s[8:11], s25 offen offset:3072 lds
    v_exp_f32 v140, v140
    v_exp_f32 v141, v141
    v_exp_f32 v142, v142
    v_exp_f32 v143, v143
    v_cvt_pk_bf16_f32 v158, v140, v141
    v_cvt_pk_bf16_f32 v159, v142, v143
    v_mfma_f32_32x32x16_bf16 v[128:143], v[192:195], v[24:27], 0
    buffer_load_dwordx4 v[160:163], v6, s[8:11], s23 offen offset:0
    buffer_load_dwordx4 v[164:167], v6, s[8:11], s23 offen offset:1024
    s_or_b64 exec, s[44:45], 1
    buffer_load_dword v232, v8, s[8:11], 0 offen sc1
    s_mov_b64 exec, -1
    v_exp_f32 v112, v112
    v_exp_f32 v113, v113
    v_exp_f32 v114, v114
    v_exp_f32 v115, v115
    v_cvt_pk_bf16_f32 v144, v112, v113
    v_cvt_pk_bf16_f32 v145, v114, v115
    v_mfma_f32_32x32x16_bf16 v[128:143], v[196:199], v[28:31], v[128:143]
    v_exp_f32 v116, v116
    v_exp_f32 v117, v117
    v_exp_f32 v118, v118
    v_exp_f32 v119, v119
    v_cvt_pk_bf16_f32 v146, v116, v117
    v_cvt_pk_bf16_f32 v147, v118, v119
    v_mfma_f32_32x32x16_bf16 v[96:111], v[188:191], v[156:159], v[96:111]
    buffer_load_dwordx4 a[8:11], v6, s[8:11], s27 offen offset:2048
    v_exp_f32 v120, v120
    v_exp_f32 v121, v121
    v_exp_f32 v122, v122
    v_exp_f32 v123, v123
    v_cvt_pk_bf16_f32 v148, v120, v121
    v_cvt_pk_bf16_f32 v149, v122, v123
    v_mfma_f32_32x32x16_bf16 v[48:63], v[200:203], v[144:147], v[48:63]
    s_add_u32 s33, s35, 2048
    v_exp_f32 v124, v124
    v_exp_f32 v125, v125
    v_exp_f32 v126, v126
    v_exp_f32 v127, v127
    v_cvt_pk_bf16_f32 v150, v124, v125
    v_cvt_pk_bf16_f32 v151, v126, v127
    v_mfma_f32_32x32x16_bf16 v[112:127], v[192:195], v[32:35], 0
    buffer_load_dwordx4 v[168:171], v6, s[8:11], s23 offen offset:2048
    buffer_load_dwordx4 v[172:175], v6, s[8:11], s23 offen offset:3072
    v_exp_f32 v128, v128
    v_exp_f32 v129, v129
    v_exp_f32 v130, v130
    v_exp_f32 v131, v131
    v_cvt_pk_bf16_f32 v152, v128, v129
    v_cvt_pk_bf16_f32 v153, v130, v131
    v_mfma_f32_32x32x16_bf16 v[112:127], v[196:199], v[36:39], v[112:127]
    s_add_u32 s23, s23, 4096
    v_exp_f32 v132, v132
    v_exp_f32 v133, v133
    v_exp_f32 v134, v134
    v_exp_f32 v135, v135
    v_cvt_pk_bf16_f32 v154, v132, v133
    v_cvt_pk_bf16_f32 v155, v134, v135
    v_mfma_f32_32x32x16_bf16 v[48:63], v[204:207], v[148:151], v[48:63]
    buffer_load_dwordx4 a[72:75], v238, s[8:11], s33 offen
    v_exp_f32 v136, v136
    v_exp_f32 v137, v137
    v_exp_f32 v138, v138
    v_exp_f32 v139, v139
    v_cvt_pk_bf16_f32 v156, v136, v137
    v_cvt_pk_bf16_f32 v157, v138, v139
    v_mfma_f32_32x32x16_bf16 v[64:79], v[200:203], v[152:155], v[64:79]
    s_add_u32 s25, s25, 4096
    v_exp_f32 v140, v140
    v_exp_f32 v141, v141
    v_exp_f32 v142, v142
    v_exp_f32 v143, v143
    v_cvt_pk_bf16_f32 v158, v140, v141
    v_cvt_pk_bf16_f32 v159, v142, v143
    v_mfma_f32_32x32x16_bf16 v[128:143], v[192:195], v[40:43], 0
    buffer_load_dwordx4 v[176:179], v6, s[8:11], s23 offen offset:0
    buffer_load_dwordx4 v[180:183], v6, s[8:11], s23 offen offset:1024
    v_exp_f32 v112, v112
    v_exp_f32 v113, v113
    v_exp_f32 v114, v114
    v_exp_f32 v115, v115
    v_cvt_pk_bf16_f32 v144, v112, v113
    v_cvt_pk_bf16_f32 v145, v114, v115
    v_mfma_f32_32x32x16_bf16 v[128:143], v[196:199], v[44:47], v[128:143]
    s_waitcnt vmcnt(15)
    v_exp_f32 v116, v116
    v_exp_f32 v117, v117
    v_exp_f32 v118, v118
    v_exp_f32 v119, v119
    v_cvt_pk_bf16_f32 v146, v116, v117
    v_cvt_pk_bf16_f32 v147, v118, v119
    v_mfma_f32_32x32x16_bf16 v[64:79], v[204:207], v[156:159], v[64:79]
    s_add_u32 s31, s31, 0x8000
    v_exp_f32 v120, v120
    v_exp_f32 v121, v121
    v_exp_f32 v122, v122
    v_exp_f32 v123, v123
    v_cvt_pk_bf16_f32 v148, v120, v121
    v_cvt_pk_bf16_f32 v149, v122, v123
    v_mfma_f32_32x32x16_bf16 v[80:95], v[200:203], v[144:147], v[80:95]
    s_and_b32 s31, s31, 0x3ffff
    v_exp_f32 v124, v124
    v_exp_f32 v125, v125
    v_exp_f32 v126, v126
    v_exp_f32 v127, v127
    v_cvt_pk_bf16_f32 v150, v124, v125
    v_cvt_pk_bf16_f32 v151, v126, v127
    v_mfma_f32_32x32x16_bf16 v[112:127], v[208:211], v[16:19], 0
    buffer_load_dwordx4 v[184:187], v6, s[8:11], s23 offen offset:2048
    buffer_load_dwordx4 v[188:191], v6, s[8:11], s23 offen offset:3072
    v_exp_f32 v128, v128
    v_exp_f32 v129, v129
    v_exp_f32 v130, v130
    v_exp_f32 v131, v131
    v_cvt_pk_bf16_f32 v152, v128, v129
    v_cvt_pk_bf16_f32 v153, v130, v131
    v_mfma_f32_32x32x16_bf16 v[112:127], v[212:215], v[20:23], v[112:127]
    s_waitcnt vmcnt(8)
    v_exp_f32 v132, v132
    v_exp_f32 v133, v133
    v_exp_f32 v134, v134
    v_exp_f32 v135, v135
    v_cmp_eq_u32 s[44:45], 0, v232
    v_cvt_pk_bf16_f32 v154, v132, v133
    v_cvt_pk_bf16_f32 v155, v134, v135
    v_mfma_f32_32x32x16_bf16 v[80:95], v[204:207], v[148:151], v[80:95]
    s_and_b32 s42, s44, 0xff000000
    s_cbranch_scc1 pk_slow10
pk_back10:
    v_exp_f32 v136, v136
    v_exp_f32 v137, v137
    v_exp_f32 v138, v138
    v_exp_f32 v139, v139
    v_cvt_pk_bf16_f32 v156, v136, v137
    v_cvt_pk_bf16_f32 v157, v138, v139
    v_mfma_f32_32x32x16_bf16 v[96:111], v[200:203], v[152:155], v[96:111]
    s_add_u32 s23, s31, s28
    v_exp_f32 v140, v140
    v_exp_f32 v141, v141
    v_exp_f32 v142, v142
    v_exp_f32 v143, v143
    v_cvt_pk_bf16_f32 v158, v140, v141
    v_cvt_pk_bf16_f32 v159, v142, v143
    v_mfma_f32_32x32x16_bf16 v[128:143], v[208:211], v[24:27], 0
    buffer_load_dwordx4 v[192:195], v6, s[8:11], s23 offen offset:0
    s_or_b64 exec, s[44:45], 1
    buffer_load_dword v232, v8, s[8:11], 0 offen sc1
    s_mov_b64 exec, -1
    v_exp_f32 v112, v112
    v_exp_f32 v113, v113
    v_exp_f32 v114, v114
    v_exp_f32 v115, v115
    v_cvt_pk_bf16_f32 v144, v112, v113
    v_cvt_pk_bf16_f32 v145, v114, v115
    v_mfma_f32_32x32x16_bf16 v[128:143], v[212:215], v[28:31], v[128:143]
    s_add_u32 m0, s26, 4096
    v_exp_f32 v116, v116
    v_exp_f32 v117, v117
    v_exp_f32 v118, v118
    v_exp_f32 v119, v119
    v_cvt_pk_bf16_f32 v146, v116, v117
    v_cvt_pk_bf16_f32 v147, v118, v119
    v_mfma_f32_32x32x16_bf16 v[96:111], v[204:207], v[156:159], v[96:111]
    buffer_load_dwordx4 v6, s[8:11], s25 offen offset:0 lds
    buffer_load_dwordx4 a[12:15], v6, s[8:11], s27 offen offset:3072
    v_exp_f32 v120, v120
    v_exp_f32 v121, v121
    v_exp_f32 v122, v122
    v_exp_f32 v123, v123
    v_cvt_pk_bf16_f32 v148, v120, v121
    v_cvt_pk_bf16_f32 v149, v122, v123
    v_mfma_f32_32x32x16_bf16 v[48:63], v[216:219], v[144:147], v[48:63]
    buffer_load_dwordx4 v6, s[8:11], s25 offen offset:1024 lds
    buffer_load_dwordx4 a[76:79], v239, s[8:11], s33 offen
    v_exp_f32 v124, v124
    v_exp_f32 v125, v125
    v_exp_f32 v126, v126
    v_exp_f32 v127, v127
    v_cvt_pk_bf16_f32 v150, v124, v125
    v_cvt_pk_bf16_f32 v151, v126, v127
    v_mfma_f32_32x32x16_bf16 v[112:127], v[208:211], v[32:35], 0
    buffer_load_dwordx4 v[196:199], v6, s[8:11], s23 offen offset:1024
    v_exp_f32 v128, v128
    v_exp_f32 v129, v129
    v_exp_f32 v130, v130
    v_exp_f32 v131, v131
    v_cvt_pk_bf16_f32 v152, v128, v129
    v_cvt_pk_bf16_f32 v153, v130, v131
    v_mfma_f32_32x32x16_bf16 v[112:127], v[212:215], v[36:39], v[112:127]
    s_add_u32 s27, s27, 4096
    v_exp_f32 v132, v132
    v_exp_f32 v133, v133
    v_exp_f32 v134, v134
    v_exp_f32 v135, v135
    v_cvt_pk_bf16_f32 v154, v132, v133
    v_cvt_pk_bf16_f32 v155, v134, v135
    v_mfma_f32_32x32x16_bf16 v[48:63], v[220:223], v[148:151], v[48:63]
    buffer_load_dwordx4 a[16:19], v6, s[8:11], s27 offen offset:0
    v_exp_f32 v136, v136
    v_exp_f32 v137, v137
    v_exp_f32 v138, v138
    v_exp_f32 v139, v139
    v_cvt_pk_bf16_f32 v156, v136, v137
    v_cvt_pk_bf16_f32 v157, v138, v139
    v_mfma_f32_32x32x16_bf16 v[64:79], v[216:219], v[152:155], v[64:79]
    v_exp_f32 v140, v140
    v_exp_f32 v141, v141
    v_exp_f32 v142, v142
    v_exp_f32 v143, v143
    v_cvt_pk_bf16_f32 v158, v140, v141
    v_cvt_pk_bf16_f32 v159, v142, v143
    v_mfma_f32_32x32x16_bf16 v[128:143], v[208:211], v[40:43], 0
    buffer_load_dwordx4 v[200:203], v6, s[8:11], s23 offen offset:2048
    buffer_load_dwordx4 v6, s[8:11], s25 offen offset:2048 lds
    v_exp_f32 v112, v112
    v_exp_f32 v113, v113
    v_exp_f32 v114, v114
    v_exp_f32 v115, v115
    v_cvt_pk_bf16_f32 v144, v112, v113
    v_cvt_pk_bf16_f32 v145, v114, v115
    v_mfma_f32_32x32x16_bf16 v[128:143], v[212:215], v[44:47], v[128:143]
    s_waitcnt vmcnt(15)
    v_exp_f32 v116, v116
    v_exp_f32 v117, v117
    v_exp_f32 v118, v118
    v_exp_f32 v119, v119
    v_cvt_pk_bf16_f32 v146, v116, v117
    v_cvt_pk_bf16_f32 v147, v118, v119
    v_mfma_f32_32x32x16_bf16 v[64:79], v[220:223], v[156:159], v[64:79]
    s_add_u32 s25, s25, 24576
    v_exp_f32 v120, v120
    v_exp_f32 v121, v121
    v_exp_f32 v122, v122
    v_exp_f32 v123, v123
    v_cvt_pk_bf16_f32 v148, v120, v121
    v_cvt_pk_bf16_f32 v149, v122, v123
    v_mfma_f32_32x32x16_bf16 v[80:95], v[216:219], v[144:147], v[80:95]
    s_add_u32 m0, s26, 28672
    v_exp_f32 v124, v124
    v_exp_f32 v125, v125
    v_exp_f32 v126, v126
    v_exp_f32 v127, v127
    v_cvt_pk_bf16_f32 v150, v124, v125
    v_cvt_pk_bf16_f32 v151, v126, v127
    v_mfma_f32_32x32x16_bf16 v[112:127], v[160:163], v[16:19], 0
    buffer_load_dwordx4 v[204:207], v6, s[8:11], s23 offen offset:3072
    buffer_load_dwordx4 v6, s[8:11], s25 offen offset:0 lds
    v_exp_f32 v128, v128
    v_exp_f32 v129, v129
    v_exp_f32 v130, v130
    v_exp_f32 v131, v131
    v_cvt_pk_bf16_f32 v152, v128, v129
    v_cvt_pk_bf16_f32 v153, v130, v131
    v_mfma_f32_32x32x16_bf16 v[112:127], v[164:167], v[20:23], v[112:127]
    s_add_u32 s23, s23, 4096
    v_exp_f32 v132, v132
    v_exp_f32 v133, v133
    v_exp_f32 v134, v134
    v_exp_f32 v135, v135
    v_cvt_pk_bf16_f32 v154, v132, v133
    v_cvt_pk_bf16_f32 v155, v134, v135
    v_mfma_f32_32x32x16_bf16 v[80:95], v[220:223], v[148:151], v[80:95]
    buffer_load_dwordx4 a[20:23], v6, s[8:11], s27 offen offset:1024
    v_exp_f32 v136, v136
    v_exp_f32 v137, v137
    v_exp_f32 v138, v138
    v_exp_f32 v139, v139
    v_cvt_pk_bf16_f32 v156, v136, v137
    v_cvt_pk_bf16_f32 v157, v138, v139
    v_mfma_f32_32x32x16_bf16 v[96:111], v[216:219], v[152:155], v[96:111]
    s_add_u32 s33, s35, 4096
    v_exp_f32 v140, v140
    v_exp_f32 v141, v141
    v_exp_f32 v142, v142
    v_exp_f32 v143, v143
    v_cvt_pk_bf16_f32 v158, v140, v141
    v_cvt_pk_bf16_f32 v159, v142, v143
    v_mfma_f32_32x32x16_bf16 v[128:143], v[160:163], v[24:27], 0
    buffer_load_dwordx4 v[208:211], v6, s[8:11], s23 offen offset:0
    v_exp_f32 v112, v112
    v_exp_f32 v113, v113
    v_exp_f32 v114, v114
    v_exp_f32 v115, v115
    v_cvt_pk_bf16_f32 v144, v112, v113
    v_cvt_pk_bf16_f32 v145, v114, v115
    v_mfma_f32_32x32x16_bf16 v[128:143], v[164:167], v[28:31], v[128:143]
    v_exp_f32 v116, v116
    v_exp_f32 v117, v117
    v_exp_f32 v118, v118
    v_exp_f32 v119, v119
    v_cvt_pk_bf16_f32 v146, v116, v117
    v_cvt_pk_bf16_f32 v147, v118, v119
    v_mfma_f32_32x32x16_bf16 v[96:111], v[220:223], v[156:159], v[96:111]
    buffer_load_dwordx4 a[80:83], v238, s[8:11], s33 offen
    v_exp_f32 v120, v120
    v_exp_f32 v121, v121
    v_exp_f32 v122, v122
    v_exp_f32 v123, v123
    v_cvt_pk_bf16_f32 v148, v120, v121
    v_cvt_pk_bf16_f32 v149, v122, v123
    v_mfma_f32_32x32x16_bf16 v[48:63], v[168:171], v[144:147], v[48:63]
    v_exp_f32 v124, v124
    v_exp_f32 v125, v125
    v_exp_f32 v126, v126
    v_exp_f32 v127, v127
    v_cvt_pk_bf16_f32 v150, v124, v125
    v_cvt_pk_bf16_f32 v151, v126, v127
    v_mfma_f32_32x32x16_bf16 v[112:127], v[160:163], v[32:35], 0
    buffer_load_dwordx4 v[212:215], v6, s[8:11], s23 offen offset:1024
    v_exp_f32 v128, v128
    v_exp_f32 v129, v129
    v_exp_f32 v130, v130
    v_exp_f32 v131, v131
    v_cvt_pk_bf16_f32 v152, v128, v129
    v_cvt_pk_bf16_f32 v153, v130, v131
    v_mfma_f32_32x32x16_bf16 v[112:127], v[164:167], v[36:39], v[112:127]
    buffer_load_dwordx4 v6, s[8:11], s25 offen offset:1024 lds
    v_exp_f32 v132, v132
    v_exp_f32 v133, v133
    v_exp_f32 v134, v134
    v_exp_f32 v135, v135
    v_cvt_pk_bf16_f32 v154, v132, v133
    v_cvt_pk_bf16_f32 v155, v134, v135
    v_mfma_f32_32x32x16_bf16 v[48:63], v[172:175], v[148:151], v[48:63]
    v_exp_f32 v136, v136
    v_exp_f32 v137, v137
    v_exp_f32 v138, v138
    v_exp_f32 v139, v139
    v_cvt_pk_bf16_f32 v156, v136, v137
    v_cvt_pk_bf16_f32 v157, v138, v139
    v_mfma_f32_32x32x16_bf16 v[64:79], v[168:171], v[152:155], v[64:79]
    v_exp_f32 v140, v140
    v_exp_f32 v141, v141
    v_exp_f32 v142, v142
    v_exp_f32 v143, v143
    v_cvt_pk_bf16_f32 v158, v140, v141
    v_cvt_pk_bf16_f32 v159, v142, v143
    v_mfma_f32_32x32x16_bf16 v[128:143], v[160:163], v[40:43], 0
    buffer_load_dwordx4 v[216:219], v6, s[8:11], s23 offen offset:2048
    buffer_load_dwordx4 a[24:27], v6, s[8:11], s27 offen offset:2048
    v_exp_f32 v112, v112
    v_exp_f32 v113, v113
    v_exp_f32 v114, v114
    v_exp_f32 v115, v115
    v_cvt_pk_bf16_f32 v144, v112, v113
    v_cvt_pk_bf16_f32 v145, v114, v115
    v_mfma_f32_32x32x16_bf16 v[128:143], v[164:167], v[44:47], v[128:143]
    s_waitcnt vmcnt(19)
    v_exp_f32 v116, v116
    v_exp_f32 v117, v117
    v_exp_f32 v118, v118
    v_exp_f32 v119, v119
    v_cvt_pk_bf16_f32 v146, v116, v117
    v_cvt_pk_bf16_f32 v147, v118, v119
    v_mfma_f32_32x32x16_bf16 v[64:79], v[172:175], v[156:159], v[64:79]
    s_add_u32 s31, s31, 0x8000
    v_exp_f32 v120, v120
    v_exp_f32 v121, v121
    v_exp_f32 v122, v122
    v_exp_f32 v123, v123
    v_cvt_pk_bf16_f32 v148, v120, v121
    v_cvt_pk_bf16_f32 v149, v122, v123
    v_mfma_f32_32x32x16_bf16 v[80:95], v[168:171], v[144:147], v[80:95]
    s_and_b32 s31, s31, 0x3ffff
    v_exp_f32 v124, v124
    v_exp_f32 v125, v125
    v_exp_f32 v126, v126
    v_exp_f32 v127, v127
    v_cvt_pk_bf16_f32 v150, v124, v125
    v_cvt_pk_bf16_f32 v151, v126, v127
    v_mfma_f32_32x32x16_bf16 v[112:127], v[176:179], v[16:19], 0
    buffer_load_dwordx4 v[220:223], v6, s[8:11], s23 offen offset:3072
    buffer_load_dwordx4 v6, s[8:11], s25 offen offset:2048 lds
    v_exp_f32 v128, v128
    v_exp_f32 v129, v129
    v_exp_f32 v130, v130
    v_exp_f32 v131, v131
    v_cvt_pk_bf16_f32 v152, v128, v129
    v_cvt_pk_bf16_f32 v153, v130, v131
    v_mfma_f32_32x32x16_bf16 v[112:127], v[180:183], v[20:23], v[112:127]
    s_waitcnt vmcnt(19)
    v_exp_f32 v132, v132
    v_exp_f32 v133, v133
    v_exp_f32 v134, v134
    v_exp_f32 v135, v135
    v_cmp_eq_u32 s[44:45], 0, v232
    v_cvt_pk_bf16_f32 v154, v132, v133
    v_cvt_pk_bf16_f32 v155, v134, v135
    v_mfma_f32_32x32x16_bf16 v[80:95], v[172:175], v[148:151], v[80:95]
    s_and_b32 s42, s45, 0xff
    s_cbranch_scc1 pk_slow11
pk_back11:
    v_exp_f32 v136, v136
    v_exp_f32 v137, v137
    v_exp_f32 v138, v138
    v_exp_f32 v139, v139
    v_cvt_pk_bf16_f32 v156, v136, v137
    v_cvt_pk_bf16_f32 v157, v138, v139
    v_mfma_f32_32x32x16_bf16 v[96:111], v[168:171], v[152:155], v[96:111]
    s_add_u32 s23, s31, s28
    v_exp_f32 v140, v140
    v_exp_f32 v141, v141
    v_exp_f32 v142, v142
    v_exp_f32 v143, v143
    v_cvt_pk_bf16_f32 v158, v140, v141
    v_cvt_pk_bf16_f32 v159, v142, v143
    v_mfma_f32_32x32x16_bf16 v[128:143], v[176:179], v[24:27], 0
    buffer_load_dwordx4 v[160:163], v6, s[8:11], s23 offen offset:0
    s_or_b64 exec, s[44:45], 1
    buffer_load_dword v232, v8, s[8:11], 0 offen sc1
    s_mov_b64 exec, -1
    v_exp_f32 v112, v112
    v_exp_f32 v113, v113
    v_exp_f32 v114, v114
    v_exp_f32 v115, v115
    v_cvt_pk_bf16_f32 v144, v112, v113
    v_cvt_pk_bf16_f32 v145, v114, v115
    v_mfma_f32_32x32x16_bf16 v[128:143], v[180:183], v[28:31], v[128:143]
    buffer_load_dwordx4 a[84:87], v239, s[8:11], s33 offen
    v_exp_f32 v116, v116
    v_exp_f32 v117, v117
    v_exp_f32 v118, v118
    v_exp_f32 v119, v119
    v_cvt_pk_bf16_f32 v146, v116, v117
    v_cvt_pk_bf16_f32 v147, v118, v119
    v_mfma_f32_32x32x16_bf16 v[96:111], v[172:175], v[156:159], v[96:111]
    buffer_load_dwordx4 v6, s[8:11], s25 offen offset:3072 lds
    v_exp_f32 v120, v120
    v_exp_f32 v121, v121
    v_exp_f32 v122, v122
    v_exp_f32 v123, v123
    v_cvt_pk_bf16_f32 v148, v120, v121
    v_cvt_pk_bf16_f32 v149, v122, v123
    v_mfma_f32_32x32x16_bf16 v[48:63], v[184:187], v[144:147], v[48:63]
    v_exp_f32 v124, v124
    v_exp_f32 v125, v125
    v_exp_f32 v126, v126
    v_exp_f32 v127, v127
    v_cvt_pk_bf16_f32 v150, v124, v125
    v_cvt_pk_bf16_f32 v151, v126, v127
    v_mfma_f32_32x32x16_bf16 v[112:127], v[176:179], v[32:35], 0
    buffer_load_dwordx4 v[164:167], v6, s[8:11], s23 offen offset:1024
    v_exp_f32 v128, v128
    v_exp_f32 v129, v129
    v_exp_f32 v130, v130
    v_exp_f32 v131, v131
    v_cvt_pk_bf16_f32 v152, v128, v129
    v_cvt_pk_bf16_f32 v153, v130, v131
    v_mfma_f32_32x32x16_bf16 v[112:127], v[180:183], v[36:39], v[112:127]
    buffer_load_dwordx4 a[28:31], v6, s[8:11], s27 offen offset:3072
    v_exp_f32 v132, v132
    v_exp_f32 v133, v133
    v_exp_f32 v134, v134
    v_exp_f32 v135, v135
    v_cvt_pk_bf16_f32 v154, v132, v133
    v_cvt_pk_bf16_f32 v155, v134, v135
    v_mfma_f32_32x32x16_bf16 v[48:63], v[188:191], v[148:151], v[48:63]
    s_add_u32 s33, s35, 14336
    v_exp_f32 v136, v136
    v_exp_f32 v137, v137
    v_exp_f32 v138, v138
    v_exp_f32 v139, v139
    v_cvt_pk_bf16_f32 v156, v136, v137
    v_cvt_pk_bf16_f32 v157, v138, v139
    v_mfma_f32_32x32x16_bf16 v[64:79], v[184:187], v[152:155], v[64:79]
    v_exp_f32 v140, v140
    v_exp_f32 v141, v141
    v_exp_f32 v142, v142
    v_exp_f32 v143, v143
    v_cvt_pk_bf16_f32 v158, v140, v141
    v_cvt_pk_bf16_f32 v159, v142, v143
    v_mfma_f32_32x32x16_bf16 v[128:143], v[176:179], v[40:43], 0
    buffer_load_dwordx4 v[168:171], v6, s[8:11], s23 offen offset:2048
    buffer_load_dwordx4 a[88:91], v238, s[8:11], s33 offen
    v_exp_f32 v112, v112
    v_exp_f32 v113, v113
    v_exp_f32 v114, v114
    v_exp_f32 v115, v115
    v_cvt_pk_bf16_f32 v144, v112, v113
    v_cvt_pk_bf16_f32 v145, v114, v115
    v_mfma_f32_32x32x16_bf16 v[128:143], v[180:183], v[44:47], v[128:143]
    s_waitcnt vmcnt(18)
    v_exp_f32 v116, v116
    v_exp_f32 v117, v117
    v_exp_f32 v118, v118
    v_exp_f32 v119, v119
    v_cvt_pk_bf16_f32 v146, v116, v117
    v_cvt_pk_bf16_f32 v147, v118, v119
    v_mfma_f32_32x32x16_bf16 v[64:79], v[188:191], v[156:159], v[64:79]
    s_add_u32 s25, s25, 4096
    v_exp_f32 v120, v120
    v_exp_f32 v121, v121
    v_exp_f32 v122, v122
    v_exp_f32 v123, v123
    v_cvt_pk_bf16_f32 v148, v120, v121
    v_cvt_pk_bf16_f32 v149, v122, v123
    v_mfma_f32_32x32x16_bf16 v[80:95], v[184:187], v[144:147], v[80:95]
    s_add_u32 m0, s26, 32768
    v_exp_f32 v124, v124
    v_exp_f32 v125, v125
    v_exp_f32 v126, v126
    v_exp_f32 v127, v127
    v_cvt_pk_bf16_f32 v150, v124, v125
    v_cvt_pk_bf16_f32 v151, v126, v127
    v_mfma_f32_32x32x16_bf16 v[112:127], v[192:195], v[16:19], 0
    buffer_load_dwordx4 v[172:175], v6, s[8:11], s23 offen offset:3072
    buffer_load_dwordx4 v6, s[8:11], s25 offen offset:0 lds
    v_exp_f32 v128, v128
    v_exp_f32 v129, v129
    v_exp_f32 v130, v130
    v_exp_f32 v131, v131
    v_cvt_pk_bf16_f32 v152, v128, v129
    v_cvt_pk_bf16_f32 v153, v130, v131
    v_mfma_f32_32x32x16_bf16 v[112:127], v[196:199], v[20:23], v[112:127]
    s_add_u32 s23, s23, 4096
    v_exp_f32 v132, v132
    v_exp_f32 v133, v133
    v_exp_f32 v134, v134
    v_exp_f32 v135, v135
    v_cvt_pk_bf16_f32 v154, v132, v133
    v_cvt_pk_bf16_f32 v155, v134, v135
    v_mfma_f32_32x32x16_bf16 v[80:95], v[188:191], v[148:151], v[80:95]
    s_xor_b32 s27, s19, 1
    v_exp_f32 v136, v136
    v_exp_f32 v137, v137
    v_exp_f32 v138, v138
    v_exp_f32 v139, v139
    v_cvt_pk_bf16_f32 v156, v136, v137
    v_cvt_pk_bf16_f32 v157, v138, v139
    v_mfma_f32_32x32x16_bf16 v[96:111], v[184:187], v[152:155], v[96:111]
    s_lshl_b32 s27, s27, 13
    v_exp_f32 v140, v140
    v_exp_f32 v141, v141
    v_exp_f32 v142, v142
    v_exp_f32 v143, v143
    v_cvt_pk_bf16_f32 v158, v140, v141
    v_cvt_pk_bf16_f32 v159, v142, v143
    v_mfma_f32_32x32x16_bf16 v[128:143], v[192:195], v[24:27], 0
    buffer_load_dwordx4 v[176:179], v6, s[8:11], s23 offen offset:0
    v_exp_f32 v112, v112
    v_exp_f32 v113, v113
    v_exp_f32 v114, v114
    v_exp_f32 v115, v115
    v_cvt_pk_bf16_f32 v144, v112, v113
    v_cvt_pk_bf16_f32 v145, v114, v115
    v_mfma_f32_32x32x16_bf16 v[128:143], v[196:199], v[28:31], v[128:143]
    s_add_u32 s27, s27, s24
    v_exp_f32 v116, v116
    v_exp_f32 v117, v117
    v_exp_f32 v118, v118
    v_exp_f32 v119, v119
    v_cvt_pk_bf16_f32 v146, v116, v117
    v_cvt_pk_bf16_f32 v147, v118, v119
    v_mfma_f32_32x32x16_bf16 v[96:111], v[188:191], v[156:159], v[96:111]
    buffer_load_dwordx4 a[32:35], v6, s[8:11], s27 offen offset:0
    buffer_load_dwordx4 v6, s[8:11], s25 offen offset:1024 lds
    v_exp_f32 v120, v120
    v_exp_f32 v121, v121
    v_exp_f32 v122, v122
    v_exp_f32 v123, v123
    v_cvt_pk_bf16_f32 v148, v120, v121
    v_cvt_pk_bf16_f32 v149, v122, v123
    v_mfma_f32_32x32x16_bf16 v[48:63], v[200:203], v[144:147], v[48:63]
    v_exp_f32 v124, v124
    v_exp_f32 v125, v125
    v_exp_f32 v126, v126
    v_exp_f32 v127, v127
    v_cvt_pk_bf16_f32 v150, v124, v125
    v_cvt_pk_bf16_f32 v151, v126, v127
    v_mfma_f32_32x32x16_bf16 v[112:127], v[192:195], v[32:35], 0
    buffer_load_dwordx4 v[180:183], v6, s[8:11], s23 offen offset:1024
    v_exp_f32 v128, v128
    v_exp_f32 v129, v129
    v_exp_f32 v130, v130
    v_exp_f32 v131, v131
    v_cvt_pk_bf16_f32 v152, v128, v129
    v_cvt_pk_bf16_f32 v153, v130, v131
    v_mfma_f32_32x32x16_bf16 v[112:127], v[196:199], v[36:39], v[112:127]
    buffer_load_dwordx4 a[92:95], v239, s[8:11], s33 offen
    v_exp_f32 v132, v132
    v_exp_f32 v133, v133
    v_exp_f32 v134, v134
    v_exp_f32 v135, v135
    v_cvt_pk_bf16_f32 v154, v132, v133
    v_cvt_pk_bf16_f32 v155, v134, v135
    v_mfma_f32_32x32x16_bf16 v[48:63], v[204:207], v[148:151], v[48:63]
    v_exp_f32 v136, v136
    v_exp_f32 v137, v137
    v_exp_f32 v138, v138
    v_exp_f32 v139, v139
    v_cvt_pk_bf16_f32 v156, v136, v137
    v_cvt_pk_bf16_f32 v157, v138, v139
    v_mfma_f32_32x32x16_bf16 v[64:79], v[200:203], v[152:155], v[64:79]
    v_exp_f32 v140, v140
    v_exp_f32 v141, v141
    v_exp_f32 v142, v142
    v_exp_f32 v143, v143
    v_cvt_pk_bf16_f32 v158, v140, v141
    v_cvt_pk_bf16_f32 v159, v142, v143
    v_mfma_f32_32x32x16_bf16 v[128:143], v[192:195], v[40:43], 0
    buffer_load_dwordx4 v[184:187], v6, s[8:11], s23 offen offset:2048
    buffer_load_dwordx4 a[36:39], v6, s[8:11], s27 offen offset:1024
    v_exp_f32 v112, v112
    v_exp_f32 v113, v113
    v_exp_f32 v114, v114
    v_exp_f32 v115, v115
    v_cvt_pk_bf16_f32 v144, v112, v113
    v_cvt_pk_bf16_f32 v145, v114, v115
    v_mfma_f32_32x32x16_bf16 v[128:143], v[196:199], v[44:47], v[128:143]
    s_waitcnt vmcnt(18)
    v_exp_f32 v116, v116
    v_exp_f32 v117, v117
    v_exp_f32 v118, v118
    v_exp_f32 v119, v119
    v_cvt_pk_bf16_f32 v146, v116, v117
    v_cvt_pk_bf16_f32 v147, v118, v119
    v_mfma_f32_32x32x16_bf16 v[64:79], v[204:207], v[156:159], v[64:79]
    s_add_u32 s31, s31, 0x8000
    v_exp_f32 v120, v120
    v_exp_f32 v121, v121
    v_exp_f32 v122, v122
    v_exp_f32 v123, v123
    v_cvt_pk_bf16_f32 v148, v120, v121
    v_cvt_pk_bf16_f32 v149, v122, v123
    v_mfma_f32_32x32x16_bf16 v[80:95], v[200:203], v[144:147], v[80:95]
    s_and_b32 s31, s31, 0x3ffff
    v_exp_f32 v124, v124
    v_exp_f32 v125, v125
    v_exp_f32 v126, v126
    v_exp_f32 v127, v127
    v_cvt_pk_bf16_f32 v150, v124, v125
    v_cvt_pk_bf16_f32 v151, v126, v127
    v_mfma_f32_32x32x16_bf16 v[112:127], v[208:211], v[16:19], 0
    buffer_load_dwordx4 v[188:191], v6, s[8:11], s23 offen offset:3072
    buffer_load_dwordx4 v6, s[8:11], s25 offen offset:2048 lds
    v_exp_f32 v128, v128
    v_exp_f32 v129, v129
    v_exp_f32 v130, v130
    v_exp_f32 v131, v131
    v_cvt_pk_bf16_f32 v152, v128, v129
    v_cvt_pk_bf16_f32 v153, v130, v131
    v_mfma_f32_32x32x16_bf16 v[112:127], v[212:215], v[20:23], v[112:127]
    s_waitcnt vmcnt(17)
    v_exp_f32 v132, v132
    v_exp_f32 v133, v133
    v_exp_f32 v134, v134
    v_exp_f32 v135, v135
    v_cmp_eq_u32 s[44:45], 0, v232
    v_cvt_pk_bf16_f32 v154, v132, v133
    v_cvt_pk_bf16_f32 v155, v134, v135
    v_mfma_f32_32x32x16_bf16 v[80:95], v[204:207], v[148:151], v[80:95]
    s_and_b32 s42, s45, 0xff00
    s_cbranch_scc1 pk_slow12
pk_back12:
    v_exp_f32 v136, v136
    v_exp_f32 v137, v137
    v_exp_f32 v138, v138
    v_exp_f32 v139, v139
    v_cvt_pk_bf16_f32 v156, v136, v137
    v_cvt_pk_bf16_f32 v157, v138, v139
    v_mfma_f32_32x32x16_bf16 v[96:111], v[200:203], v[152:155], v[96:111]
    s_add_u32 s23, s31, s28
    v_exp_f32 v140, v140
    v_exp_f32 v141, v141
    v_exp_f32 v142, v142
    v_exp_f32 v143, v143
    v_cvt_pk_bf16_f32 v158, v140, v141
    v_cvt_pk_bf16_f32 v159, v142, v143
    v_mfma_f32_32x32x16_bf16 v[128:143], v[208:211], v[24:27], 0
    buffer_load_dwordx4 v[192:195], v6, s[8:11], s23 offen offset:0
    s_or_b64 exec, s[44:45], 1
    buffer_load_dword v232, v8, s[8:11], 0 offen sc1
    s_mov_b64 exec, -1
    v_exp_f32 v112, v112
    v_exp_f32 v113, v113
    v_exp_f32 v114, v114
    v_exp_f32 v115, v115
    v_cvt_pk_bf16_f32 v144, v112, v113
    v_cvt_pk_bf16_f32 v145, v114, v115
    v_mfma_f32_32x32x16_bf16 v[128:143], v[212:215], v[28:31], v[128:143]
    s_add_u32 s25, s25, 24576
    v_exp_f32 v116, v116
    v_exp_f32 v117, v117
    v_exp_f32 v118, v118
    v_exp_f32 v119, v119
    v_cvt_pk_bf16_f32 v146, v116, v117
    v_cvt_pk_bf16_f32 v147, v118, v119
    v_mfma_f32_32x32x16_bf16 v[96:111], v[204:207], v[156:159], v[96:111]
    s_add_u32 m0, s26, 57344
    v_exp_f32 v120, v120
    v_exp_f32 v121, v121
    v_exp_f32 v122, v122
    v_exp_f32 v123, v123
    v_cvt_pk_bf16_f32 v148, v120, v121
    v_cvt_pk_bf16_f32 v149, v122, v123
    v_mfma_f32_32x32x16_bf16 v[48:63], v[216:219], v[144:147], v[48:63]
    buffer_load_dwordx4 v6, s[8:11], s25 offen offset:0 lds
    buffer_load_dwordx4 a[40:43], v6, s[8:11], s27 offen offset:2048
    v_exp_f32 v124, v124
    v_exp_f32 v125, v125
    v_exp_f32 v126, v126
    v_exp_f32 v127, v127
    v_cvt_pk_bf16_f32 v150, v124, v125
    v_cvt_pk_bf16_f32 v151, v126, v127
    v_mfma_f32_32x32x16_bf16 v[112:127], v[208:211], v[32:35], 0
    buffer_load_dwordx4 v[196:199], v6, s[8:11], s23 offen offset:1024
    v_exp_f32 v128, v128
    v_exp_f32 v129, v129
    v_exp_f32 v130, v130
    v_exp_f32 v131, v131
    v_cvt_pk_bf16_f32 v152, v128, v129
    v_cvt_pk_bf16_f32 v153, v130, v131
    v_mfma_f32_32x32x16_bf16 v[112:127], v[212:215], v[36:39], v[112:127]
    s_add_u32 s33, s35, 16384
    v_exp_f32 v132, v132
    v_exp_f32 v133, v133
    v_exp_f32 v134, v134
    v_exp_f32 v135, v135
    v_cvt_pk_bf16_f32 v154, v132, v133
    v_cvt_pk_bf16_f32 v155, v134, v135
    v_mfma_f32_32x32x16_bf16 v[48:63], v[220:223], v[148:151], v[48:63]
    buffer_load_dwordx4 a[96:99], v238, s[8:11], s33 offen
    v_exp_f32 v136, v136
    v_exp_f32 v137, v137
    v_exp_f32 v138, v138
    v_exp_f32 v139, v139
    v_cvt_pk_bf16_f32 v156, v136, v137
    v_cvt_pk_bf16_f32 v157, v138, v139
    v_mfma_f32_32x32x16_bf16 v[64:79], v[216:219], v[152:155], v[64:79]
    v_exp_f32 v140, v140
    v_exp_f32 v141, v141
    v_exp_f32 v142, v142
    v_exp_f32 v143, v143
    v_cvt_pk_bf16_f32 v158, v140, v141
    v_cvt_pk_bf16_f32 v159, v142, v143
    v_mfma_f32_32x32x16_bf16 v[128:143], v[208:211], v[40:43], 0
    buffer_load_dwordx4 v[200:203], v6, s[8:11], s23 offen offset:2048
    buffer_load_dwordx4 v6, s[8:11], s25 offen offset:1024 lds
    v_exp_f32 v112, v112
    v_exp_f32 v113, v113
    v_exp_f32 v114, v114
    v_exp_f32 v115, v115
    v_cvt_pk_bf16_f32 v144, v112, v113
    v_cvt_pk_bf16_f32 v145, v114, v115
    v_mfma_f32_32x32x16_bf16 v[128:143], v[212:215], v[44:47], v[128:143]
    s_waitcnt vmcnt(18)
    v_exp_f32 v116, v116
    v_exp_f32 v117, v117
    v_exp_f32 v118, v118
    v_exp_f32 v119, v119
    v_cvt_pk_bf16_f32 v146, v116, v117
    v_cvt_pk_bf16_f32 v147, v118, v119
    v_mfma_f32_32x32x16_bf16 v[64:79], v[220:223], v[156:159], v[64:79]
    v_exp_f32 v120, v120
    v_exp_f32 v121, v121
    v_exp_f32 v122, v122
    v_exp_f32 v123, v123
    v_cvt_pk_bf16_f32 v148, v120, v121
    v_cvt_pk_bf16_f32 v149, v122, v123
    v_mfma_f32_32x32x16_bf16 v[80:95], v[216:219], v[144:147], v[80:95]
    buffer_load_dwordx4 a[44:47], v6, s[8:11], s27 offen offset:3072
    v_exp_f32 v124, v124
    v_exp_f32 v125, v125
    v_exp_f32 v126, v126
    v_exp_f32 v127, v127
    v_cvt_pk_bf16_f32 v150, v124, v125
    v_cvt_pk_bf16_f32 v151, v126, v127
    v_mfma_f32_32x32x16_bf16 v[112:127], v[160:163], v[16:19], 0
    buffer_load_dwordx4 v[204:207], v6, s[8:11], s23 offen offset:3072
    v_exp_f32 v128, v128
    v_exp_f32 v129, v129
    v_exp_f32 v130, v130
    v_exp_f32 v131, v131
    v_cvt_pk_bf16_f32 v152, v128, v129
    v_cvt_pk_bf16_f32 v153, v130, v131
    v_mfma_f32_32x32x16_bf16 v[112:127], v[164:167], v[20:23], v[112:127]
    s_add_u32 s23, s23, 4096
    v_exp_f32 v132, v132
    v_exp_f32 v133, v133
    v_exp_f32 v134, v134
    v_exp_f32 v135, v135
    v_cvt_pk_bf16_f32 v154, v132, v133
    v_cvt_pk_bf16_f32 v155, v134, v135
    v_mfma_f32_32x32x16_bf16 v[80:95], v[220:223], v[148:151], v[80:95]
    buffer_load_dwordx4 v6, s[8:11], s25 offen offset:2048 lds
    v_exp_f32 v136, v136
    v_exp_f32 v137, v137
    v_exp_f32 v138, v138
    v_exp_f32 v139, v139
    v_cvt_pk_bf16_f32 v156, v136, v137
    v_cvt_pk_bf16_f32 v157, v138, v139
    v_mfma_f32_32x32x16_bf16 v[96:111], v[216:219], v[152:155], v[96:111]
    v_exp_f32 v140, v140
    v_exp_f32 v141, v141
    v_exp_f32 v142, v142
    v_exp_f32 v143, v143
    v_cvt_pk_bf16_f32 v158, v140, v141
    v_cvt_pk_bf16_f32 v159, v142, v143
    v_mfma_f32_32x32x16_bf16 v[128:143], v[160:163], v[24:27], 0
    buffer_load_dwordx4 v[208:211], v6, s[8:11], s23 offen offset:0
    v_exp_f32 v112, v112
    v_exp_f32 v113, v113
    v_exp_f32 v114, v114
    v_exp_f32 v115, v115
    v_cvt_pk_bf16_f32 v144, v112, v113
    v_cvt_pk_bf16_f32 v145, v114, v115
    v_mfma_f32_32x32x16_bf16 v[128:143], v[164:167], v[28:31], v[128:143]
    buffer_load_dwordx4 a[100:103], v239, s[8:11], s33 offen
    v_exp_f32 v116, v116
    v_exp_f32 v117, v117
    v_exp_f32 v118, v118
    v_exp_f32 v119, v119
    v_cvt_pk_bf16_f32 v146, v116, v117
    v_cvt_pk_bf16_f32 v147, v118, v119
    v_mfma_f32_32x32x16_bf16 v[96:111], v[220:223], v[156:159], v[96:111]
    v_exp_f32 v120, v120
    v_exp_f32 v121, v121
    v_exp_f32 v122, v122
    v_exp_f32 v123, v123
    v_cvt_pk_bf16_f32 v148, v120, v121
    v_cvt_pk_bf16_f32 v149, v122, v123
    v_mfma_f32_32x32x16_bf16 v[48:63], v[168:171], v[144:147], v[48:63]
    v_exp_f32 v124, v124
    v_exp_f32 v125, v125
    v_exp_f32 v126, v126
    v_exp_f32 v127, v127
    v_cvt_pk_bf16_f32 v150, v124, v125
    v_cvt_pk_bf16_f32 v151, v126, v127
    v_mfma_f32_32x32x16_bf16 v[112:127], v[160:163], v[32:35], 0
    buffer_load_dwordx4 v[212:215], v6, s[8:11], s23 offen offset:1024
    buffer_load_dwordx4 v6, s[8:11], s25 offen offset:3072 lds
    v_exp_f32 v128, v128
    v_exp_f32 v129, v129
    v_exp_f32 v130, v130
    v_exp_f32 v131, v131
    v_cvt_pk_bf16_f32 v152, v128, v129
    v_cvt_pk_bf16_f32 v153, v130, v131
    v_mfma_f32_32x32x16_bf16 v[112:127], v[164:167], v[36:39], v[112:127]
    s_add_u32 s27, s27, 4096
    v_exp_f32 v132, v132
    v_exp_f32 v133, v133
    v_exp_f32 v134, v134
    v_exp_f32 v135, v135
    v_cvt_pk_bf16_f32 v154, v132, v133
    v_cvt_pk_bf16_f32 v155, v134, v135
    v_mfma_f32_32x32x16_bf16 v[48:63], v[172:175], v[148:151], v[48:63]
    v_exp_f32 v136, v136
    v_exp_f32 v137, v137
    v_exp_f32 v138, v138
    v_exp_f32 v139, v139
    v_cvt_pk_bf16_f32 v156, v136, v137
    v_cvt_pk_bf16_f32 v157, v138, v139
    v_mfma_f32_32x32x16_bf16 v[64:79], v[168:171], v[152:155], v[64:79]
    v_exp_f32 v140, v140
    v_exp_f32 v141, v141
    v_exp_f32 v142, v142
    v_exp_f32 v143, v143
    v_cvt_pk_bf16_f32 v158, v140, v141
    v_cvt_pk_bf16_f32 v159, v142, v143
    v_mfma_f32_32x32x16_bf16 v[128:143], v[160:163], v[40:43], 0
    buffer_load_dwordx4 v[216:219], v6, s[8:11], s23 offen offset:2048
    buffer_load_dwordx4 a[48:51], v6, s[8:11], s27 offen offset:0
    v_exp_f32 v112, v112
    v_exp_f32 v113, v113
    v_exp_f32 v114, v114
    v_exp_f32 v115, v115
    v_cvt_pk_bf16_f32 v144, v112, v113
    v_cvt_pk_bf16_f32 v145, v114, v115
    v_mfma_f32_32x32x16_bf16 v[128:143], v[164:167], v[44:47], v[128:143]
    s_waitcnt vmcnt(18)
    v_exp_f32 v116, v116
    v_exp_f32 v117, v117
    v_exp_f32 v118, v118
    v_exp_f32 v119, v119
    v_cvt_pk_bf16_f32 v146, v116, v117
    v_cvt_pk_bf16_f32 v147, v118, v119
    v_mfma_f32_32x32x16_bf16 v[64:79], v[172:175], v[156:159], v[64:79]
    s_add_u32 s31, s31, 0x8000
    v_exp_f32 v120, v120
    v_exp_f32 v121, v121
    v_exp_f32 v122, v122
    v_exp_f32 v123, v123
    v_cvt_pk_bf16_f32 v148, v120, v121
    v_cvt_pk_bf16_f32 v149, v122, v123
    v_mfma_f32_32x32x16_bf16 v[80:95], v[168:171], v[144:147], v[80:95]
    s_and_b32 s31, s31, 0x3ffff
    v_exp_f32 v124, v124
    v_exp_f32 v125, v125
    v_exp_f32 v126, v126
    v_exp_f32 v127, v127
    v_cvt_pk_bf16_f32 v150, v124, v125
    v_cvt_pk_bf16_f32 v151, v126, v127
    v_mfma_f32_32x32x16_bf16 v[112:127], v[176:179], v[16:19], 0
    buffer_load_dwordx4 v[220:223], v6, s[8:11], s23 offen offset:3072
    v_exp_f32 v128, v128
    v_exp_f32 v129, v129
    v_exp_f32 v130, v130
    v_exp_f32 v131, v131
    v_cvt_pk_bf16_f32 v152, v128, v129
    v_cvt_pk_bf16_f32 v153, v130, v131
    v_mfma_f32_32x32x16_bf16 v[112:127], v[180:183], v[20:23], v[112:127]
    s_waitcnt vmcnt(16)
    v_exp_f32 v132, v132
    v_exp_f32 v133, v133
    v_exp_f32 v134, v134
    v_exp_f32 v135, v135
    v_cmp_eq_u32 s[44:45], 0, v232
    v_cvt_pk_bf16_f32 v154, v132, v133
    v_cvt_pk_bf16_f32 v155, v134, v135
    v_mfma_f32_32x32x16_bf16 v[80:95], v[172:175], v[148:151], v[80:95]
    s_and_b32 s42, s45, 0xff0000
    s_cbranch_scc1 pk_slow13
pk_back13:
    v_exp_f32 v136, v136
    v_exp_f32 v137, v137
    v_exp_f32 v138, v138
    v_exp_f32 v139, v139
    v_cvt_pk_bf16_f32 v156, v136, v137
    v_cvt_pk_bf16_f32 v157, v138, v139
    v_mfma_f32_32x32x16_bf16 v[96:111], v[168:171], v[152:155], v[96:111]
    s_add_u32 s23, s31, s28
    v_exp_f32 v140, v140
    v_exp_f32 v141, v141
    v_exp_f32 v142, v142
    v_exp_f32 v143, v143
    v_cvt_pk_bf16_f32 v158, v140, v141
    v_cvt_pk_bf16_f32 v159, v142, v143
    v_mfma_f32_32x32x16_bf16 v[128:143], v[176:179], v[24:27], 0
    buffer_load_dwordx4 v[160:163], v6, s[8:11], s23 offen offset:0
    s_or_b64 exec, s[44:45], 1
    buffer_load_dword v232, v8, s[8:11], 0 offen sc1
    s_mov_b64 exec, -1
    v_exp_f32 v112, v112
    v_exp_f32 v113, v113
    v_exp_f32 v114, v114
    v_exp_f32 v115, v115
    v_cvt_pk_bf16_f32 v144, v112, v113
    v_cvt_pk_bf16_f32 v145, v114, v115
    v_mfma_f32_32x32x16_bf16 v[128:143], v[180:183], v[28:31], v[128:143]
    s_add_u32 s33, s35, 18432
    v_exp_f32 v116, v116
    v_exp_f32 v117, v117
    v_exp_f32 v118, v118
    v_exp_f32 v119, v119
    v_cvt_pk_bf16_f32 v146, v116, v117
    v_cvt_pk_bf16_f32 v147, v118, v119
    v_mfma_f32_32x32x16_bf16 v[96:111], v[172:175], v[156:159], v[96:111]
    buffer_load_dwordx4 a[104:107], v238, s[8:11], s33 offen
    v_exp_f32 v120, v120
    v_exp_f32 v121, v121
    v_exp_f32 v122, v122
    v_exp_f32 v123, v123
    v_cvt_pk_bf16_f32 v148, v120, v121
    v_cvt_pk_bf16_f32 v149, v122, v123
    v_mfma_f32_32x32x16_bf16 v[48:63], v[184:187], v[144:147], v[48:63]
    s_add_u32 s25, s25, 4096
    v_exp_f32 v124, v124
    v_exp_f32 v125, v125
    v_exp_f32 v126, v126
    v_exp_f32 v127, v127
    v_cvt_pk_bf16_f32 v150, v124, v125
    v_cvt_pk_bf16_f32 v151, v126, v127
    v_mfma_f32_32x32x16_bf16 v[112:127], v[176:179], v[32:35], 0
    buffer_load_dwordx4 v[164:167], v6, s[8:11], s23 offen offset:1024
    v_exp_f32 v128, v128
    v_exp_f32 v129, v129
    v_exp_f32 v130, v130
    v_exp_f32 v131, v131
    v_cvt_pk_bf16_f32 v152, v128, v129
    v_cvt_pk_bf16_f32 v153, v130, v131
    v_mfma_f32_32x32x16_bf16 v[112:127], v[180:183], v[36:39], v[112:127]
    s_add_u32 m0, s26, 61440
    v_exp_f32 v132, v132
    v_exp_f32 v133, v133
    v_exp_f32 v134, v134
    v_exp_f32 v135, v135
    v_cvt_pk_bf16_f32 v154, v132, v133
    v_cvt_pk_bf16_f32 v155, v134, v135
    v_mfma_f32_32x32x16_bf16 v[48:63], v[188:191], v[148:151], v[48:63]
    buffer_load_dwordx4 v6, s[8:11], s25 offen offset:0 lds
    buffer_load_dwordx4 a[52:55], v6, s[8:11], s27 offen offset:1024
    v_exp_f32 v136, v136
    v_exp_f32 v137, v137
    v_exp_f32 v138, v138
    v_exp_f32 v139, v139
    v_cvt_pk_bf16_f32 v156, v136, v137
    v_cvt_pk_bf16_f32 v157, v138, v139
    v_mfma_f32_32x32x16_bf16 v[64:79], v[184:187], v[152:155], v[64:79]
    s_add_u32 s41, s34, s21
    v_exp_f32 v140, v140
    v_exp_f32 v141, v141
    v_exp_f32 v142, v142
    v_exp_f32 v143, v143
    v_cvt_pk_bf16_f32 v158, v140, v141
    v_cvt_pk_bf16_f32 v159, v142, v143
    v_mfma_f32_32x32x16_bf16 v[128:143], v[176:179], v[40:43], 0
    buffer_load_dwordx4 v[168:171], v6, s[8:11], s23 offen offset:2048
    buffer_load_dwordx4 v[224:227], v6, s[8:11], s41 offen offset:0 sc1
    v_exp_f32 v112, v112
    v_exp_f32 v113, v113
    v_exp_f32 v114, v114
    v_exp_f32 v115, v115
    v_cvt_pk_bf16_f32 v144, v112, v113
    v_cvt_pk_bf16_f32 v145, v114, v115
    v_mfma_f32_32x32x16_bf16 v[128:143], v[180:183], v[44:47], v[128:143]
    s_waitcnt vmcnt(16)
    v_exp_f32 v116, v116
    v_exp_f32 v117, v117
    v_exp_f32 v118, v118
    v_exp_f32 v119, v119
    v_cvt_pk_bf16_f32 v146, v116, v117
    v_cvt_pk_bf16_f32 v147, v118, v119
    v_mfma_f32_32x32x16_bf16 v[64:79], v[188:191], v[156:159], v[64:79]
    buffer_load_dwordx4 v[228:231], v6, s[8:11], s41 offen offset:1024 sc1
    buffer_load_dword v9, v9, s[8:11], s36 offen sc1
    v_exp_f32 v120, v120
    v_exp_f32 v121, v121
    v_exp_f32 v122, v122
    v_exp_f32 v123, v123
    v_cvt_pk_bf16_f32 v148, v120, v121
    v_cvt_pk_bf16_f32 v149, v122, v123
    v_mfma_f32_32x32x16_bf16 v[80:95], v[184:187], v[144:147], v[80:95]
    buffer_load_dword v233, v5, s[8:11], 0 offen
    v_exp_f32 v124, v124
    v_exp_f32 v125, v125
    v_exp_f32 v126, v126
    v_exp_f32 v127, v127
    v_cvt_pk_bf16_f32 v150, v124, v125
    v_cvt_pk_bf16_f32 v151, v126, v127
    v_mfma_f32_32x32x16_bf16 v[112:127], v[192:195], v[16:19], 0
    buffer_load_dwordx4 v[172:175], v6, s[8:11], s23 offen offset:3072
    v_exp_f32 v128, v128
    v_exp_f32 v129, v129
    v_exp_f32 v130, v130
    v_exp_f32 v131, v131
    v_cvt_pk_bf16_f32 v152, v128, v129
    v_cvt_pk_bf16_f32 v153, v130, v131
    v_mfma_f32_32x32x16_bf16 v[112:127], v[196:199], v[20:23], v[112:127]
    s_add_u32 s23, s23, 4096
    v_exp_f32 v132, v132
    v_exp_f32 v133, v133
    v_exp_f32 v134, v134
    v_exp_f32 v135, v135
    v_cvt_pk_bf16_f32 v154, v132, v133
    v_cvt_pk_bf16_f32 v155, v134, v135
    v_mfma_f32_32x32x16_bf16 v[80:95], v[188:191], v[148:151], v[80:95]
    buffer_load_dwordx4 v6, s[8:11], s25 offen offset:1024 lds
    v_exp_f32 v136, v136
    v_exp_f32 v137, v137
    v_exp_f32 v138, v138
    v_exp_f32 v139, v139
    v_cvt_pk_bf16_f32 v156, v136, v137
    v_cvt_pk_bf16_f32 v157, v138, v139
    v_mfma_f32_32x32x16_bf16 v[96:111], v[184:187], v[152:155], v[96:111]
    v_exp_f32 v140, v140
    v_exp_f32 v141, v141
    v_exp_f32 v142, v142
    v_exp_f32 v143, v143
    v_cvt_pk_bf16_f32 v158, v140, v141
    v_cvt_pk_bf16_f32 v159, v142, v143
    v_mfma_f32_32x32x16_bf16 v[128:143], v[192:195], v[24:27], 0
    buffer_load_dwordx4 v[176:179], v6, s[8:11], s23 offen offset:0
    v_exp_f32 v112, v112
    v_exp_f32 v113, v113
    v_exp_f32 v114, v114
    v_exp_f32 v115, v115
    v_cvt_pk_bf16_f32 v144, v112, v113
    v_cvt_pk_bf16_f32 v145, v114, v115
    v_mfma_f32_32x32x16_bf16 v[128:143], v[196:199], v[28:31], v[128:143]
    buffer_load_dwordx4 a[108:111], v239, s[8:11], s33 offen
    v_exp_f32 v116, v116
    v_exp_f32 v117, v117
    v_exp_f32 v118, v118
    v_exp_f32 v119, v119
    v_cvt_pk_bf16_f32 v146, v116, v117
    v_cvt_pk_bf16_f32 v147, v118, v119
    v_mfma_f32_32x32x16_bf16 v[96:111], v[188:191], v[156:159], v[96:111]
    v_exp_f32 v120, v120
    v_exp_f32 v121, v121
    v_exp_f32 v122, v122
    v_exp_f32 v123, v123
    v_cvt_pk_bf16_f32 v148, v120, v121
    v_cvt_pk_bf16_f32 v149, v122, v123
    v_mfma_f32_32x32x16_bf16 v[48:63], v[200:203], v[144:147], v[48:63]
    v_exp_f32 v124, v124
    v_exp_f32 v125, v125
    v_exp_f32 v126, v126
    v_exp_f32 v127, v127
    v_cvt_pk_bf16_f32 v150, v124, v125
    v_cvt_pk_bf16_f32 v151, v126, v127
    v_mfma_f32_32x32x16_bf16 v[112:127], v[192:195], v[32:35], 0
    buffer_load_dwordx4 v[180:183], v6, s[8:11], s23 offen offset:1024
    buffer_load_dwordx4 a[56:59], v6, s[8:11], s27 offen offset:2048
    v_exp_f32 v128, v128
    v_exp_f32 v129, v129
    v_exp_f32 v130, v130
    v_exp_f32 v131, v131
    v_cvt_pk_bf16_f32 v152, v128, v129
    v_cvt_pk_bf16_f32 v153, v130, v131
    v_mfma_f32_32x32x16_bf16 v[112:127], v[196:199], v[36:39], v[112:127]
    v_exp_f32 v132, v132
    v_exp_f32 v133, v133
    v_exp_f32 v134, v134
    v_exp_f32 v135, v135
    v_cvt_pk_bf16_f32 v154, v132, v133
    v_cvt_pk_bf16_f32 v155, v134, v135
    v_mfma_f32_32x32x16_bf16 v[48:63], v[204:207], v[148:151], v[48:63]
    v_exp_f32 v136, v136
    v_exp_f32 v137, v137
    v_exp_f32 v138, v138
    v_exp_f32 v139, v139
    v_cvt_pk_bf16_f32 v156, v136, v137
    v_cvt_pk_bf16_f32 v157, v138, v139
    v_mfma_f32_32x32x16_bf16 v[64:79], v[200:203], v[152:155], v[64:79]
    buffer_load_dwordx4 v6, s[8:11], s25 offen offset:2048 lds
    v_exp_f32 v140, v140
    v_exp_f32 v141, v141
    v_exp_f32 v142, v142
    v_exp_f32 v143, v143
    v_cvt_pk_bf16_f32 v158, v140, v141
    v_cvt_pk_bf16_f32 v159, v142, v143
    v_mfma_f32_32x32x16_bf16 v[128:143], v[192:195], v[40:43], 0
    buffer_load_dwordx4 v[184:187], v6, s[8:11], s23 offen offset:2048
    v_exp_f32 v112, v112
    v_exp_f32 v113, v113
    v_exp_f32 v114, v114
    v_exp_f32 v115, v115
    v_cvt_pk_bf16_f32 v144, v112, v113
    v_cvt_pk_bf16_f32 v145, v114, v115
    v_mfma_f32_32x32x16_bf16 v[128:143], v[196:199], v[44:47], v[128:143]
    s_waitcnt vmcnt(19)
    v_exp_f32 v116, v116
    v_exp_f32 v117, v117
    v_exp_f32 v118, v118
    v_exp_f32 v119, v119
    v_cvt_pk_bf16_f32 v146, v116, v117
    v_cvt_pk_bf16_f32 v147, v118, v119
    v_mfma_f32_32x32x16_bf16 v[64:79], v[204:207], v[156:159], v[64:79]
    s_add_u32 s31, s31, 0x8000
    v_exp_f32 v120, v120
    v_exp_f32 v121, v121
    v_exp_f32 v122, v122
    v_exp_f32 v123, v123
    v_cvt_pk_bf16_f32 v148, v120, v121
    v_cvt_pk_bf16_f32 v149, v122, v123
    v_mfma_f32_32x32x16_bf16 v[80:95], v[200:203], v[144:147], v[80:95]
    s_and_b32 s31, s31, 0x3ffff
    v_exp_f32 v124, v124
    v_exp_f32 v125, v125
    v_exp_f32 v126, v126
    v_exp_f32 v127, v127
    v_cvt_pk_bf16_f32 v150, v124, v125
    v_cvt_pk_bf16_f32 v151, v126, v127
    v_mfma_f32_32x32x16_bf16 v[112:127], v[208:211], v[16:19], 0
    buffer_load_dwordx4 v[188:191], v6, s[8:11], s23 offen offset:3072
    v_exp_f32 v128, v128
    v_exp_f32 v129, v129
    v_exp_f32 v130, v130
    v_exp_f32 v131, v131
    v_cvt_pk_bf16_f32 v152, v128, v129
    v_cvt_pk_bf16_f32 v153, v130, v131
    v_mfma_f32_32x32x16_bf16 v[112:127], v[212:215], v[20:23], v[112:127]
    s_waitcnt vmcnt(18)
    v_exp_f32 v132, v132
    v_exp_f32 v133, v133
    v_exp_f32 v134, v134
    v_exp_f32 v135, v135
    v_cmp_eq_u32 s[44:45], 0, v232
    v_cvt_pk_bf16_f32 v154, v132, v133
    v_cvt_pk_bf16_f32 v155, v134, v135
    v_mfma_f32_32x32x16_bf16 v[80:95], v[204:207], v[148:151], v[80:95]
    s_and_b32 s42, s45, 0xff000000
    s_cbranch_scc1 pk_slow14
pk_back14:
    v_exp_f32 v136, v136
    v_exp_f32 v137, v137
    v_exp_f32 v138, v138
    v_exp_f32 v139, v139
    v_cvt_pk_bf16_f32 v156, v136, v137
    v_cvt_pk_bf16_f32 v157, v138, v139
    v_mfma_f32_32x32x16_bf16 v[96:111], v[200:203], v[152:155], v[96:111]
    s_add_u32 s23, s31, s28
    v_exp_f32 v140, v140
    v_exp_f32 v141, v141
    v_exp_f32 v142, v142
    v_exp_f32 v143, v143
    v_cvt_pk_bf16_f32 v158, v140, v141
    v_cvt_pk_bf16_f32 v159, v142, v143
    v_mfma_f32_32x32x16_bf16 v[128:143], v[208:211], v[24:27], 0
    buffer_load_dwordx4 v[192:195], v6, s[8:11], s23 offen offset:0
    v_exp_f32 v112, v112
    v_exp_f32 v113, v113
    v_exp_f32 v114, v114
    v_exp_f32 v115, v115
    v_cvt_pk_bf16_f32 v144, v112, v113
    v_cvt_pk_bf16_f32 v145, v114, v115
    v_mfma_f32_32x32x16_bf16 v[128:143], v[212:215], v[28:31], v[128:143]
    s_add_u32 s25, s25, 24576
    v_exp_f32 v116, v116
    v_exp_f32 v117, v117
    v_exp_f32 v118, v118
    v_exp_f32 v119, v119
    v_cvt_pk_bf16_f32 v146, v116, v117
    v_cvt_pk_bf16_f32 v147, v118, v119
    v_mfma_f32_32x32x16_bf16 v[96:111], v[204:207], v[156:159], v[96:111]
    s_add_u32 m0, s26, 86016
    v_exp_f32 v120, v120
    v_exp_f32 v121, v121
    v_exp_f32 v122, v122
    v_exp_f32 v123, v123
    v_cvt_pk_bf16_f32 v148, v120, v121
    v_cvt_pk_bf16_f32 v149, v122, v123
    v_mfma_f32_32x32x16_bf16 v[48:63], v[216:219], v[144:147], v[48:63]
    buffer_load_dwordx4 v6, s[8:11], s25 offen offset:0 lds
    buffer_load_dwordx4 a[60:63], v6, s[8:11], s27 offen offset:3072
    v_exp_f32 v124, v124
    v_exp_f32 v125, v125
    v_exp_f32 v126, v126
    v_exp_f32 v127, v127
    v_cvt_pk_bf16_f32 v150, v124, v125
    v_cvt_pk_bf16_f32 v151, v126, v127
    v_mfma_f32_32x32x16_bf16 v[112:127], v[208:211], v[32:35], 0
    buffer_load_dwordx4 v[196:199], v6, s[8:11], s23 offen offset:1024
    buffer_load_dword v232, v7, s[8:11], s40 offen sc1
    v_exp_f32 v128, v128
    v_exp_f32 v129, v129
    v_exp_f32 v130, v130
    v_exp_f32 v131, v131
    v_cvt_pk_bf16_f32 v152, v128, v129
    v_cvt_pk_bf16_f32 v153, v130, v131
    v_mfma_f32_32x32x16_bf16 v[112:127], v[212:215], v[36:39], v[112:127]
    s_lshl_b32 s41, s16, 10
    v_exp_f32 v132, v132
    v_exp_f32 v133, v133
    v_exp_f32 v134, v134
    v_exp_f32 v135, v135
    v_cvt_pk_bf16_f32 v154, v132, v133
    v_cvt_pk_bf16_f32 v155, v134, v135
    v_mfma_f32_32x32x16_bf16 v[48:63], v[220:223], v[148:151], v[48:63]
    s_add_u32 s41, s41, s0
    v_exp_f32 v136, v136
    v_exp_f32 v137, v137
    v_exp_f32 v138, v138
    v_exp_f32 v139, v139
    v_cvt_pk_bf16_f32 v156, v136, v137
    v_cvt_pk_bf16_f32 v157, v138, v139
    v_mfma_f32_32x32x16_bf16 v[64:79], v[216:219], v[152:155], v[64:79]
    buffer_load_dword v233, v10, s[8:11], s41 offen
    v_exp_f32 v140, v140
    v_exp_f32 v141, v141
    v_exp_f32 v142, v142
    v_exp_f32 v143, v143
    v_cvt_pk_bf16_f32 v158, v140, v141
    v_cvt_pk_bf16_f32 v159, v142, v143
    v_mfma_f32_32x32x16_bf16 v[128:143], v[208:211], v[40:43], 0
    buffer_load_dwordx4 v[200:203], v6, s[8:11], s23 offen offset:2048
    v_exp_f32 v112, v112
    v_exp_f32 v113, v113
    v_exp_f32 v114, v114
    v_exp_f32 v115, v115
    v_cvt_pk_bf16_f32 v144, v112, v113
    v_cvt_pk_bf16_f32 v145, v114, v115
    v_mfma_f32_32x32x16_bf16 v[128:143], v[212:215], v[44:47], v[128:143]
    s_waitcnt vmcnt(15)
    v_exp_f32 v116, v116
    v_exp_f32 v117, v117
    v_exp_f32 v118, v118
    v_exp_f32 v119, v119
    v_cvt_pk_bf16_f32 v146, v116, v117
    v_cvt_pk_bf16_f32 v147, v118, v119
    v_mfma_f32_32x32x16_bf16 v[64:79], v[220:223], v[156:159], v[64:79]
    s_add_u32 s33, s35, 28672
    v_exp_f32 v120, v120
    v_exp_f32 v121, v121
    v_exp_f32 v122, v122
    v_exp_f32 v123, v123
    v_cvt_pk_bf16_f32 v148, v120, v121
    v_cvt_pk_bf16_f32 v149, v122, v123
    v_mfma_f32_32x32x16_bf16 v[80:95], v[216:219], v[144:147], v[80:95]
    buffer_load_dwordx4 a[112:115], v238, s[8:11], s33 offen
    buffer_load_dwordx4 v6, s[8:11], s25 offen offset:1024 lds
    v_exp_f32 v124, v124
    v_exp_f32 v125, v125
    v_exp_f32 v126, v126
    v_exp_f32 v127, v127
    v_cvt_pk_bf16_f32 v150, v124, v125
    v_cvt_pk_bf16_f32 v151, v126, v127
    v_mfma_f32_32x32x16_bf16 v[112:127], v[160:163], v[16:19], 0
    buffer_load_dwordx4 v[204:207], v6, s[8:11], s23 offen offset:3072
    v_exp_f32 v128, v128
    v_exp_f32 v129, v129
    v_exp_f32 v130, v130
    v_exp_f32 v131, v131
    v_cvt_pk_bf16_f32 v152, v128, v129
    v_cvt_pk_bf16_f32 v153, v130, v131
    v_mfma_f32_32x32x16_bf16 v[112:127], v[164:167], v[20:23], v[112:127]
    s_add_u32 s23, s23, 4096
    v_exp_f32 v132, v132
    v_exp_f32 v133, v133
    v_exp_f32 v134, v134
    v_exp_f32 v135, v135
    v_cvt_pk_bf16_f32 v154, v132, v133
    v_cvt_pk_bf16_f32 v155, v134, v135
    v_mfma_f32_32x32x16_bf16 v[80:95], v[220:223], v[148:151], v[80:95]
    s_xor_b32 s27, s19, 2
    v_exp_f32 v136, v136
    v_exp_f32 v137, v137
    v_exp_f32 v138, v138
    v_exp_f32 v139, v139
    v_cvt_pk_bf16_f32 v156, v136, v137
    v_cvt_pk_bf16_f32 v157, v138, v139
    v_mfma_f32_32x32x16_bf16 v[96:111], v[216:219], v[152:155], v[96:111]
    s_lshl_b32 s27, s27, 13
    v_exp_f32 v140, v140
    v_exp_f32 v141, v141
    v_exp_f32 v142, v142
    v_exp_f32 v143, v143
    v_cvt_pk_bf16_f32 v158, v140, v141
    v_cvt_pk_bf16_f32 v159, v142, v143
    v_mfma_f32_32x32x16_bf16 v[128:143], v[160:163], v[24:27], 0
    buffer_load_dwordx4 v[208:211], v6, s[8:11], s23 offen offset:0
    v_exp_f32 v112, v112
    v_exp_f32 v113, v113
    v_exp_f32 v114, v114
    v_exp_f32 v115, v115
    v_cvt_pk_bf16_f32 v144, v112, v113
    v_cvt_pk_bf16_f32 v145, v114, v115
    v_mfma_f32_32x32x16_bf16 v[128:143], v[164:167], v[28:31], v[128:143]
    s_xor_b32 s30, s19, 2
    v_exp_f32 v116, v116
    v_exp_f32 v117, v117
    v_exp_f32 v118, v118
    v_exp_f32 v119, v119
    v_cvt_pk_bf16_f32 v146, v116, v117
    v_cvt_pk_bf16_f32 v147, v118, v119
    v_mfma_f32_32x32x16_bf16 v[96:111], v[220:223], v[156:159], v[96:111]
    s_lshl_b32 s30, s30, 13
    v_exp_f32 v120, v120
    v_exp_f32 v121, v121
    v_exp_f32 v122, v122
    v_exp_f32 v123, v123
    v_cvt_pk_bf16_f32 v148, v120, v121
    v_cvt_pk_bf16_f32 v149, v122, v123
    v_mfma_f32_32x32x16_bf16 v[48:63], v[168:171], v[144:147], v[48:63]
    s_add_u32 s30, s30, s24
    v_exp_f32 v124, v124
    v_exp_f32 v125, v125
    v_exp_f32 v126, v126
    v_exp_f32 v127, v127
    v_cvt_pk_bf16_f32 v150, v124, v125
    v_cvt_pk_bf16_f32 v151, v126, v127
    v_mfma_f32_32x32x16_bf16 v[112:127], v[160:163], v[32:35], 0
    buffer_load_dwordx4 v[212:215], v6, s[8:11], s23 offen offset:1024
    v_exp_f32 v128, v128
    v_exp_f32 v129, v129
    v_exp_f32 v130, v130
    v_exp_f32 v131, v131
    v_cvt_pk_bf16_f32 v152, v128, v129
    v_cvt_pk_bf16_f32 v153, v130, v131
    v_mfma_f32_32x32x16_bf16 v[112:127], v[164:167], v[36:39], v[112:127]
    s_add_u32 s30, s30, 4096
    v_exp_f32 v132, v132
    v_exp_f32 v133, v133
    v_exp_f32 v134, v134
    v_exp_f32 v135, v135
    v_cvt_pk_bf16_f32 v154, v132, v133
    v_cvt_pk_bf16_f32 v155, v134, v135
    v_mfma_f32_32x32x16_bf16 v[48:63], v[172:175], v[148:151], v[48:63]
    s_add_u32 s27, s27, s24
    v_exp_f32 v136, v136
    v_exp_f32 v137, v137
    v_exp_f32 v138, v138
    v_exp_f32 v139, v139
    v_cvt_pk_bf16_f32 v156, v136, v137
    v_cvt_pk_bf16_f32 v157, v138, v139
    v_mfma_f32_32x32x16_bf16 v[64:79], v[168:171], v[152:155], v[64:79]
    buffer_load_dwordx4 v[240:243], v6, s[8:11], s27 offen offset:0
    buffer_load_dwordx4 v6, s[8:11], s25 offen offset:2048 lds
    v_exp_f32 v140, v140
    v_exp_f32 v141, v141
    v_exp_f32 v142, v142
    v_exp_f32 v143, v143
    v_cvt_pk_bf16_f32 v158, v140, v141
    v_cvt_pk_bf16_f32 v159, v142, v143
    v_mfma_f32_32x32x16_bf16 v[128:143], v[160:163], v[40:43], 0
    buffer_load_dwordx4 v[216:219], v6, s[8:11], s23 offen offset:2048
    buffer_load_dwordx4 a[116:119], v239, s[8:11], s33 offen
    v_exp_f32 v112, v112
    v_exp_f32 v113, v113
    v_exp_f32 v114, v114
    v_exp_f32 v115, v115
    v_cvt_pk_bf16_f32 v144, v112, v113
    v_cvt_pk_bf16_f32 v145, v114, v115
    v_mfma_f32_32x32x16_bf16 v[128:143], v[164:167], v[44:47], v[128:143]
    s_waitcnt vmcnt(16)
    v_exp_f32 v116, v116
    v_exp_f32 v117, v117
    v_exp_f32 v118, v118
    v_exp_f32 v119, v119
    v_cvt_pk_bf16_f32 v146, v116, v117
    v_cvt_pk_bf16_f32 v147, v118, v119
    v_mfma_f32_32x32x16_bf16 v[64:79], v[172:175], v[156:159], v[64:79]
    buffer_load_dwordx4 v6, s[8:11], s25 offen offset:3072 lds
    buffer_load_dwordx4 v[244:247], v6, s[8:11], s27 offen offset:1024
    v_exp_f32 v120, v120
    v_exp_f32 v121, v121
    v_exp_f32 v122, v122
    v_exp_f32 v123, v123
    v_cvt_pk_bf16_f32 v148, v120, v121
    v_cvt_pk_bf16_f32 v149, v122, v123
    v_mfma_f32_32x32x16_bf16 v[80:95], v[168:171], v[144:147], v[80:95]
    s_add_u32 s33, s35, 30720
    v_exp_f32 v124, v124
    v_exp_f32 v125, v125
    v_exp_f32 v126, v126
    v_exp_f32 v127, v127
    v_cvt_pk_bf16_f32 v150, v124, v125
    v_cvt_pk_bf16_f32 v151, v126, v127
    v_mfma_f32_32x32x16_bf16 v[112:127], v[176:179], v[16:19], 0
    buffer_load_dwordx4 v[220:223], v6, s[8:11], s23 offen offset:3072
    buffer_load_dwordx4 a[120:123], v238, s[8:11], s33 offen
    v_exp_f32 v128, v128
    v_exp_f32 v129, v129
    v_exp_f32 v130, v130
    v_exp_f32 v131, v131
    v_cvt_pk_bf16_f32 v152, v128, v129
    v_cvt_pk_bf16_f32 v153, v130, v131
    v_mfma_f32_32x32x16_bf16 v[112:127], v[180:183], v[20:23], v[112:127]
    s_add_u32 s25, s25, 4096
    v_exp_f32 v132, v132
    v_exp_f32 v133, v133
    v_exp_f32 v134, v134
    v_exp_f32 v135, v135
    v_cvt_pk_bf16_f32 v154, v132, v133
    v_cvt_pk_bf16_f32 v155, v134, v135
    v_mfma_f32_32x32x16_bf16 v[80:95], v[172:175], v[148:151], v[80:95]
    s_add_u32 m0, s26, 90112
    v_exp_f32 v136, v136
    v_exp_f32 v137, v137
    v_exp_f32 v138, v138
    v_exp_f32 v139, v139
    v_cvt_pk_bf16_f32 v156, v136, v137
    v_cvt_pk_bf16_f32 v157, v138, v139
    v_mfma_f32_32x32x16_bf16 v[96:111], v[168:171], v[152:155], v[96:111]
    buffer_load_dwordx4 v6, s[8:11], s25 offen offset:0 lds
    v_exp_f32 v140, v140
    v_exp_f32 v141, v141
    v_exp_f32 v142, v142
    v_exp_f32 v143, v143
    v_cvt_pk_bf16_f32 v158, v140, v141
    v_cvt_pk_bf16_f32 v159, v142, v143
    v_mfma_f32_32x32x16_bf16 v[128:143], v[176:179], v[24:27], 0
    buffer_load_dwordx4 v[160:163], v6, s[8:11], s30 offen offset:0
    v_exp_f32 v112, v112
    v_exp_f32 v113, v113
    v_exp_f32 v114, v114
    v_exp_f32 v115, v115
    v_cvt_pk_bf16_f32 v144, v112, v113
    v_cvt_pk_bf16_f32 v145, v114, v115
    v_mfma_f32_32x32x16_bf16 v[128:143], v[180:183], v[28:31], v[128:143]
    s_waitcnt vmcnt(17)
    v_exp_f32 v116, v116
    v_exp_f32 v117, v117
    v_exp_f32 v118, v118
    v_exp_f32 v119, v119
    v_cmp_eq_u32 vcc, 0, v232
    v_cvt_pk_bf16_f32 v146, v116, v117
    v_cvt_pk_bf16_f32 v147, v118, v119
    v_mfma_f32_32x32x16_bf16 v[96:111], v[172:175], v[156:159], v[96:111]
    s_cbranch_vccnz fc_slow15
fc_back15:
    v_exp_f32 v120, v120
    v_exp_f32 v121, v121
    v_exp_f32 v122, v122
    v_exp_f32 v123, v123
    v_max_u32_dpp v232, v232, v232 row_shr:1 row_mask:0xf bank_mask:0xf
    v_cvt_pk_bf16_f32 v148, v120, v121
    v_cvt_pk_bf16_f32 v149, v122, v123
    v_mfma_f32_32x32x16_bf16 v[48:63], v[184:187], v[144:147], v[48:63]
    buffer_load_dwordx4 v[248:251], v6, s[8:11], s27 offen offset:2048
    v_exp_f32 v124, v124
    v_exp_f32 v125, v125
    v_exp_f32 v126, v126
    v_exp_f32 v127, v127
    v_max_u32_dpp v232, v232, v232 row_shr:2 row_mask:0xf bank_mask:0xf
    v_cvt_pk_bf16_f32 v150, v124, v125
    v_cvt_pk_bf16_f32 v151, v126, v127
    v_mfma_f32_32x32x16_bf16 v[112:127], v[176:179], v[32:35], 0
    buffer_load_dwordx4 v[164:167], v6, s[8:11], s30 offen offset:1024
    buffer_load_dwordx4 v6, s[8:11], s25 offen offset:1024 lds
    v_exp_f32 v128, v128
    v_exp_f32 v129, v129
    v_exp_f32 v130, v130
    v_exp_f32 v131, v131
    v_max_u32_dpp v232, v232, v232 row_shr:4 row_mask:0xf bank_mask:0xf
    v_cvt_pk_bf16_f32 v152, v128, v129
    v_cvt_pk_bf16_f32 v153, v130, v131
    v_mfma_f32_32x32x16_bf16 v[112:127], v[180:183], v[36:39], v[112:127]
    v_exp_f32 v132, v132
    v_exp_f32 v133, v133
    v_exp_f32 v134, v134
    v_exp_f32 v135, v135
    v_max_u32_dpp v232, v232, v232 row_shr:8 row_mask:0xf bank_mask:0xf
    v_cvt_pk_bf16_f32 v154, v132, v133
    v_cvt_pk_bf16_f32 v155, v134, v135
    v_mfma_f32_32x32x16_bf16 v[48:63], v[188:191], v[148:151], v[48:63]
    v_exp_f32 v136, v136
    v_exp_f32 v137, v137
    v_exp_f32 v138, v138
    v_exp_f32 v139, v139
    v_readlane_b32 s42, v232, 15
    v_cvt_pk_bf16_f32 v156, v136, v137
    v_cvt_pk_bf16_f32 v157, v138, v139
    v_mfma_f32_32x32x16_bf16 v[64:79], v[184:187], v[152:155], v[64:79]
    buffer_load_dwordx4 a[124:127], v239, s[8:11], s33 offen
    v_exp_f32 v140, v140
    v_exp_f32 v141, v141
    v_exp_f32 v142, v142
    v_exp_f32 v143, v143
    v_readlane_b32 s43, v232, 31
    v_cvt_pk_bf16_f32 v158, v140, v141
    v_cvt_pk_bf16_f32 v159, v142, v143
    v_mfma_f32_32x32x16_bf16 v[128:143], v[176:179], v[40:43], 0
    buffer_load_dwordx4 v[168:171], v6, s[8:11], s30 offen offset:2048
    v_exp_f32 v112, v112
    v_exp_f32 v113, v113
    v_exp_f32 v114, v114
    v_exp_f32 v115, v115
    v_cvt_pk_bf16_f32 v144, v112, v113
    v_cvt_pk_bf16_f32 v145, v114, v115
    v_mfma_f32_32x32x16_bf16 v[128:143], v[180:183], v[44:47], v[128:143]
    s_waitcnt vmcnt(17)
    v_exp_f32 v116, v116
    v_exp_f32 v117, v117
    v_exp_f32 v118, v118
    v_exp_f32 v119, v119
    v_readlane_b32 s44, v232, 47
    v_cvt_pk_bf16_f32 v146, v116, v117
    v_cvt_pk_bf16_f32 v147, v118, v119
    v_mfma_f32_32x32x16_bf16 v[64:79], v[188:191], v[156:159], v[64:79]
    buffer_load_dwordx4 v[252:255], v6, s[8:11], s27 offen offset:3072
    v_exp_f32 v120, v120
    v_exp_f32 v121, v121
    v_exp_f32 v122, v122
    v_exp_f32 v123, v123
    v_readlane_b32 s45, v232, 63
    v_cvt_pk_bf16_f32 v148, v120, v121
    v_cvt_pk_bf16_f32 v149, v122, v123
    v_mfma_f32_32x32x16_bf16 v[80:95], v[184:187], v[144:147], v[80:95]
    s_max_u32 s42, s42, s43
    v_exp_f32 v124, v124
    v_exp_f32 v125, v125
    v_exp_f32 v126, v126
    v_exp_f32 v127, v127
    v_cvt_pk_bf16_f32 v150, v124, v125
    v_cvt_pk_bf16_f32 v151, v126, v127
    v_mfma_f32_32x32x16_bf16 v[112:127], v[192:195], v[16:19], 0
    buffer_load_dwordx4 v[172:175], v6, s[8:11], s30 offen offset:3072
    v_exp_f32 v128, v128
    v_exp_f32 v129, v129
    v_exp_f32 v130, v130
    v_exp_f32 v131, v131
    v_cvt_pk_bf16_f32 v152, v128, v129
    v_cvt_pk_bf16_f32 v153, v130, v131
    v_mfma_f32_32x32x16_bf16 v[112:127], v[196:199], v[20:23], v[112:127]
    s_xor_b32 s30, s19, 3
    v_exp_f32 v132, v132
    v_exp_f32 v133, v133
    v_exp_f32 v134, v134
    v_exp_f32 v135, v135
    v_cvt_pk_bf16_f32 v154, v132, v133
    v_cvt_pk_bf16_f32 v155, v134, v135
    v_mfma_f32_32x32x16_bf16 v[80:95], v[188:191], v[148:151], v[80:95]
    s_lshl_b32 s30, s30, 13
    v_exp_f32 v136, v136
    v_exp_f32 v137, v137
    v_exp_f32 v138, v138
    v_exp_f32 v139, v139
    v_cvt_pk_bf16_f32 v156, v136, v137
    v_cvt_pk_bf16_f32 v157, v138, v139
    v_mfma_f32_32x32x16_bf16 v[96:111], v[184:187], v[152:155], v[96:111]
    s_add_u32 s30, s30, s24
    v_exp_f32 v140, v140
    v_exp_f32 v141, v141
    v_exp_f32 v142, v142
    v_exp_f32 v143, v143
    v_cvt_pk_bf16_f32 v158, v140, v141
    v_cvt_pk_bf16_f32 v159, v142, v143
    v_mfma_f32_32x32x16_bf16 v[128:143], v[192:195], v[24:27], 0
    buffer_load_dwordx4 v[176:179], v6, s[8:11], s30 offen offset:0
    buffer_load_dwordx4 v6, s[8:11], s25 offen offset:2048 lds
    v_exp_f32 v112, v112
    v_exp_f32 v113, v113
    v_exp_f32 v114, v114
    v_exp_f32 v115, v115
    v_cvt_pk_bf16_f32 v144, v112, v113
    v_cvt_pk_bf16_f32 v145, v114, v115
    v_mfma_f32_32x32x16_bf16 v[128:143], v[196:199], v[28:31], v[128:143]
    s_max_u32 s44, s44, s45
    v_exp_f32 v116, v116
    v_exp_f32 v117, v117
    v_exp_f32 v118, v118
    v_exp_f32 v119, v119
    v_cvt_pk_bf16_f32 v146, v116, v117
    v_cvt_pk_bf16_f32 v147, v118, v119
    v_mfma_f32_32x32x16_bf16 v[96:111], v[188:191], v[156:159], v[96:111]
    s_max_u32 s42, s42, s44
    v_exp_f32 v120, v120
    v_exp_f32 v121, v121
    v_exp_f32 v122, v122
    v_exp_f32 v123, v123
    v_cvt_pk_bf16_f32 v148, v120, v121
    v_cvt_pk_bf16_f32 v149, v122, v123
    v_mfma_f32_32x32x16_bf16 v[48:63], v[200:203], v[144:147], v[48:63]
    s_max_u32 s42, s42, s22
    v_exp_f32 v124, v124
    v_exp_f32 v125, v125
    v_exp_f32 v126, v126
    v_exp_f32 v127, v127
    v_mul_legacy_f32 v235, s42, v234
    v_cvt_pk_bf16_f32 v150, v124, v125
    v_cvt_pk_bf16_f32 v151, v126, v127
    v_mfma_f32_32x32x16_bf16 v[112:127], v[192:195], v[32:35], 0
    buffer_load_dwordx4 v[180:183], v6, s[8:11], s30 offen offset:1024
    v_exp_f32 v128, v128
    v_exp_f32 v129, v129
    v_exp_f32 v130, v130
    v_exp_f32 v131, v131
    v_cmp_nge_f32 vcc, 0x42340000, v235
    v_cvt_pk_bf16_f32 v152, v128, v129
    v_cvt_pk_bf16_f32 v153, v130, v131
    v_mfma_f32_32x32x16_bf16 v[112:127], v[196:199], v[36:39], v[112:127]
    s_cbranch_vccnz attn_fallback
    v_exp_f32 v132, v132
    v_exp_f32 v133, v133
    v_exp_f32 v134, v134
    v_exp_f32 v135, v135
    v_cvt_pk_bf16_f32 v154, v132, v133
    v_cvt_pk_bf16_f32 v155, v134, v135
    v_mfma_f32_32x32x16_bf16 v[48:63], v[204:207], v[148:151], v[48:63]
    s_xor_b32 s42, s3, 3
    v_exp_f32 v136, v136
    v_exp_f32 v137, v137
    v_exp_f32 v138, v138
    v_exp_f32 v139, v139
    v_cvt_pk_bf16_f32 v156, v136, v137
    v_cvt_pk_bf16_f32 v157, v138, v139
    v_mfma_f32_32x32x16_bf16 v[64:79], v[200:203], v[152:155], v[64:79]
    s_mul_i32 s42, s42, 12288
    v_exp_f32 v140, v140
    v_exp_f32 v141, v141
    v_exp_f32 v142, v142
    v_exp_f32 v143, v143
    v_cvt_pk_bf16_f32 v158, v140, v141
    v_cvt_pk_bf16_f32 v159, v142, v143
    v_mfma_f32_32x32x16_bf16 v[128:143], v[192:195], v[40:43], 0
    buffer_load_dwordx4 v[184:187], v6, s[8:11], s30 offen offset:2048
    v_exp_f32 v112, v112
    v_exp_f32 v113, v113
    v_exp_f32 v114, v114
    v_exp_f32 v115, v115
    v_cvt_pk_bf16_f32 v144, v112, v113
    v_cvt_pk_bf16_f32 v145, v114, v115
    v_mfma_f32_32x32x16_bf16 v[128:143], v[196:199], v[44:47], v[128:143]
    s_waitcnt vmcnt(14)
    v_exp_f32 v116, v116
    v_exp_f32 v117, v117
    v_exp_f32 v118, v118
    v_exp_f32 v119, v119
    v_cvt_pk_bf16_f32 v146, v116, v117
    v_cvt_pk_bf16_f32 v147, v118, v119
    v_mfma_f32_32x32x16_bf16 v[64:79], v[204:207], v[156:159], v[64:79]
    s_add_u32 s42, s42, 114688
    v_exp_f32 v120, v120
    v_exp_f32 v121, v121
    v_exp_f32 v122, v122
    v_exp_f32 v123, v123
    v_add_u32 v12, s42, v6
    v_cvt_pk_bf16_f32 v148, v120, v121
    v_cvt_pk_bf16_f32 v149, v122, v123
    v_mfma_f32_32x32x16_bf16 v[80:95], v[200:203], v[144:147], v[80:95]
    s_xor_b32 s42, s3, 2
    v_exp_f32 v124, v124
    v_exp_f32 v125, v125
    v_exp_f32 v126, v126
    v_exp_f32 v127, v127
    v_cvt_pk_bf16_f32 v150, v124, v125
    v_cvt_pk_bf16_f32 v151, v126, v127
    v_mfma_f32_32x32x16_bf16 v[112:127], v[208:211], v[16:19], 0
    buffer_load_dwordx4 v[188:191], v6, s[8:11], s30 offen offset:3072
    v_exp_f32 v128, v128
    v_exp_f32 v129, v129
    v_exp_f32 v130, v130
    v_exp_f32 v131, v131
    v_cvt_pk_bf16_f32 v152, v128, v129
    v_cvt_pk_bf16_f32 v153, v130, v131
    v_mfma_f32_32x32x16_bf16 v[112:127], v[212:215], v[20:23], v[112:127]
    s_add_u32 s30, s30, 4096
    v_exp_f32 v132, v132
    v_exp_f32 v133, v133
    v_exp_f32 v134, v134
    v_exp_f32 v135, v135
    v_cvt_pk_bf16_f32 v154, v132, v133
    v_cvt_pk_bf16_f32 v155, v134, v135
    v_mfma_f32_32x32x16_bf16 v[80:95], v[204:207], v[148:151], v[80:95]
    s_mul_i32 s42, s42, 12288
    v_exp_f32 v136, v136
    v_exp_f32 v137, v137
    v_exp_f32 v138, v138
    v_exp_f32 v139, v139
    v_cvt_pk_bf16_f32 v156, v136, v137
    v_cvt_pk_bf16_f32 v157, v138, v139
    v_mfma_f32_32x32x16_bf16 v[96:111], v[200:203], v[152:155], v[96:111]
    s_add_u32 s42, s42, 114688
    v_exp_f32 v140, v140
    v_exp_f32 v141, v141
    v_exp_f32 v142, v142
    v_exp_f32 v143, v143
    v_add_u32 v13, s42, v6
    v_cvt_pk_bf16_f32 v158, v140, v141
    v_cvt_pk_bf16_f32 v159, v142, v143
    v_mfma_f32_32x32x16_bf16 v[128:143], v[208:211], v[24:27], 0
    buffer_load_dwordx4 v[192:195], v6, s[8:11], s30 offen offset:0
    v_exp_f32 v112, v112
    v_exp_f32 v113, v113
    v_exp_f32 v114, v114
    v_exp_f32 v115, v115
    v_cvt_pk_bf16_f32 v144, v112, v113
    v_cvt_pk_bf16_f32 v145, v114, v115
    v_mfma_f32_32x32x16_bf16 v[128:143], v[212:215], v[28:31], v[128:143]
    s_xor_b32 s42, s3, 1
    v_exp_f32 v116, v116
    v_exp_f32 v117, v117
    v_exp_f32 v118, v118
    v_exp_f32 v119, v119
    v_cvt_pk_bf16_f32 v146, v116, v117
    v_cvt_pk_bf16_f32 v147, v118, v119
    v_mfma_f32_32x32x16_bf16 v[96:111], v[204:207], v[156:159], v[96:111]
    s_mul_i32 s42, s42, 12288
    v_exp_f32 v120, v120
    v_exp_f32 v121, v121
    v_exp_f32 v122, v122
    v_exp_f32 v123, v123
    v_cvt_pk_bf16_f32 v148, v120, v121
    v_cvt_pk_bf16_f32 v149, v122, v123
    v_mfma_f32_32x32x16_bf16 v[48:63], v[216:219], v[144:147], v[48:63]
    s_add_u32 s42, s42, 114688
    v_exp_f32 v124, v124
    v_exp_f32 v125, v125
    v_exp_f32 v126, v126
    v_exp_f32 v127, v127
    v_add_u32 v14, s42, v6
    v_cvt_pk_bf16_f32 v150, v124, v125
    v_cvt_pk_bf16_f32 v151, v126, v127
    v_mfma_f32_32x32x16_bf16 v[112:127], v[208:211], v[32:35], 0
    buffer_load_dwordx4 v[196:199], v6, s[8:11], s30 offen offset:1024
    v_exp_f32 v128, v128
    v_exp_f32 v129, v129
    v_exp_f32 v130, v130
    v_exp_f32 v131, v131
    v_cvt_pk_bf16_f32 v152, v128, v129
    v_cvt_pk_bf16_f32 v153, v130, v131
    v_mfma_f32_32x32x16_bf16 v[112:127], v[212:215], v[36:39], v[112:127]
    s_add_u32 s25, s25, 24576
    v_exp_f32 v132, v132
    v_exp_f32 v133, v133
    v_exp_f32 v134, v134
    v_exp_f32 v135, v135
    v_cvt_pk_bf16_f32 v154, v132, v133
    v_cvt_pk_bf16_f32 v155, v134, v135
    v_mfma_f32_32x32x16_bf16 v[48:63], v[220:223], v[148:151], v[48:63]
    v_exp_f32 v136, v136
    v_exp_f32 v137, v137
    v_exp_f32 v138, v138
    v_exp_f32 v139, v139
    v_cvt_pk_bf16_f32 v156, v136, v137
    v_cvt_pk_bf16_f32 v157, v138, v139
    v_mfma_f32_32x32x16_bf16 v[64:79], v[216:219], v[152:155], v[64:79]
    v_exp_f32 v140, v140
    v_exp_f32 v141, v141
    v_exp_f32 v142, v142
    v_exp_f32 v143, v143
    v_cvt_pk_bf16_f32 v158, v140, v141
    v_cvt_pk_bf16_f32 v159, v142, v143
    v_mfma_f32_32x32x16_bf16 v[128:143], v[208:211], v[40:43], 0
    buffer_load_dwordx4 v[200:203], v6, s[8:11], s30 offen offset:2048
    v_exp_f32 v112, v112
    v_exp_f32 v113, v113
    v_exp_f32 v114, v114
    v_exp_f32 v115, v115
    v_cvt_pk_bf16_f32 v144, v112, v113
    v_cvt_pk_bf16_f32 v145, v114, v115
    v_mfma_f32_32x32x16_bf16 v[128:143], v[212:215], v[44:47], v[128:143]
    ds_write_b128 v12, v[48:51] offset:0
    v_exp_f32 v116, v116
    v_exp_f32 v117, v117
    v_exp_f32 v118, v118
    v_exp_f32 v119, v119
    v_cvt_pk_bf16_f32 v146, v116, v117
    v_cvt_pk_bf16_f32 v147, v118, v119
    v_mfma_f32_32x32x16_bf16 v[64:79], v[220:223], v[156:159], v[64:79]
    ds_write_b128 v12, v[52:55] offset:1024
    v_exp_f32 v120, v120
    v_exp_f32 v121, v121
    v_exp_f32 v122, v122
    v_exp_f32 v123, v123
    v_cvt_pk_bf16_f32 v148, v120, v121
    v_cvt_pk_bf16_f32 v149, v122, v123
    v_mfma_f32_32x32x16_bf16 v[80:95], v[216:219], v[144:147], v[80:95]
    ds_write_b128 v12, v[56:59] offset:2048
    ds_write_b128 v12, v[60:63] offset:3072
    v_exp_f32 v124, v124
    v_exp_f32 v125, v125
    v_exp_f32 v126, v126
    v_exp_f32 v127, v127
    v_cvt_pk_bf16_f32 v150, v124, v125
    v_cvt_pk_bf16_f32 v151, v126, v127
    buffer_load_dwordx4 v[204:207], v6, s[8:11], s30 offen offset:3072
    v_exp_f32 v128, v128
    v_exp_f32 v129, v129
    v_exp_f32 v130, v130
    v_exp_f32 v131, v131
    v_cvt_pk_bf16_f32 v152, v128, v129
    v_cvt_pk_bf16_f32 v153, v130, v131
    ds_write_b128 v13, v[64:67] offset:4096
    v_exp_f32 v132, v132
    v_exp_f32 v133, v133
    v_exp_f32 v134, v134
    v_exp_f32 v135, v135
    v_cvt_pk_bf16_f32 v154, v132, v133
    v_cvt_pk_bf16_f32 v155, v134, v135
    v_mfma_f32_32x32x16_bf16 v[80:95], v[220:223], v[148:151], v[80:95]
    ds_write_b128 v13, v[68:71] offset:5120
    v_exp_f32 v136, v136
    v_exp_f32 v137, v137
    v_exp_f32 v138, v138
    v_exp_f32 v139, v139
    v_cvt_pk_bf16_f32 v156, v136, v137
    v_cvt_pk_bf16_f32 v157, v138, v139
    v_mfma_f32_32x32x16_bf16 v[96:111], v[216:219], v[152:155], v[96:111]
    ds_write_b128 v13, v[72:75] offset:6144
    ds_write_b128 v13, v[76:79] offset:7168
    v_exp_f32 v140, v140
    v_exp_f32 v141, v141
    v_exp_f32 v142, v142
    v_exp_f32 v143, v143
    v_cvt_pk_bf16_f32 v158, v140, v141
    v_cvt_pk_bf16_f32 v159, v142, v143
    s_nop 1
    v_mfma_f32_32x32x16_bf16 v[96:111], v[220:223], v[156:159], v[96:111]
    ds_write_b128 v14, v[80:83] offset:8192
    ds_write_b128 v14, v[84:87] offset:9216
    ds_write_b128 v14, v[88:91] offset:10240
    ds_write_b128 v14, v[92:95] offset:11264
    s_mul_i32 s27, s3, 12288
    s_add_u32 s27, s27, 114688
    v_add_u32 v12, s27, v6
    v_add_u32 v14, 114688, v6
    s_lshl_b32 s23, s18, 15
    s_lshl_b32 s42, s3, 11
    s_add_u32 s23, s23, s42
    s_add_u32 s23, s23, s20
    s_lshl_b32 s42, s19, 13
    s_add_u32 s28, s23, s42
    s_lshl_b32 s29, s18, 7
    s_lshl_b32 s42, s3, 4
    s_add_u32 s29, s29, s42
    s_add_u32 s29, s29, s0
    s_lshl_b32 s42, s19, 2
    s_add_u32 s30, s29, s42
    v_mov_b32 v10, 1
    v_mov_b32 v11, 0
    s_waitcnt lgkmcnt(0)
    s_barrier
    ds_read_b128 v[48:51], v12 offset:0
    ds_read_b128 v[52:55], v12 offset:1024
    ds_read_b128 v[56:59], v12 offset:2048
    ds_read_b128 v[60:63], v12 offset:3072
    ds_read_b128 v[64:67], v12 offset:4096
    ds_read_b128 v[68:71], v12 offset:5120
    ds_read_b128 v[72:75], v12 offset:6144
    ds_read_b128 v[76:79], v12 offset:7168
    ds_read_b128 v[80:83], v12 offset:8192
    ds_read_b128 v[84:87], v12 offset:9216
    ds_read_b128 v[88:91], v12 offset:10240
    ds_read_b128 v[92:95], v12 offset:11264
    s_waitcnt vmcnt(48)
    s_mov_b32 exec_hi, 0
    v_cmp_ne_u32 vcc, s37, v9
    s_mov_b32 exec_hi, -1
    s_cmp_eq_u32 vcc_lo, 0
    s_cselect_b32 s38, 1, 0
    s_waitcnt lgkmcnt(8)
    v_pk_add_f32 v[96:97], v[96:97], v[48:49]
    v_pk_add_f32 v[98:99], v[98:99], v[50:51]
    v_pk_add_f32 v[100:101], v[100:101], v[52:53]
    v_pk_add_f32 v[102:103], v[102:103], v[54:55]
    v_pk_add_f32 v[104:105], v[104:105], v[56:57]
    v_pk_add_f32 v[106:107], v[106:107], v[58:59]
    v_pk_add_f32 v[108:109], v[108:109], v[60:61]
    v_pk_add_f32 v[110:111], v[110:111], v[62:63]
    s_waitcnt lgkmcnt(4)
    v_pk_add_f32 v[96:97], v[96:97], v[64:65]
    v_pk_add_f32 v[98:99], v[98:99], v[66:67]
    v_pk_add_f32 v[100:101], v[100:101], v[68:69]
    v_pk_add_f32 v[102:103], v[102:103], v[70:71]
    v_pk_add_f32 v[104:105], v[104:105], v[72:73]
    v_pk_add_f32 v[106:107], v[106:107], v[74:75]
    v_pk_add_f32 v[108:109], v[108:109], v[76:77]
    v_pk_add_f32 v[110:111], v[110:111], v[78:79]
    s_waitcnt lgkmcnt(0)
    v_pk_add_f32 v[96:97], v[96:97], v[80:81]
    v_pk_add_f32 v[98:99], v[98:99], v[82:83]
    v_pk_add_f32 v[100:101], v[100:101], v[84:85]
    v_pk_add_f32 v[102:103], v[102:103], v[86:87]
    v_pk_add_f32 v[104:105], v[104:105], v[88:89]
    v_pk_add_f32 v[106:107], v[106:107], v[90:91]
    v_pk_add_f32 v[108:109], v[108:109], v[92:93]
    v_pk_add_f32 v[110:111], v[110:111], v[94:95]
    v_mov_b32 v112, v108
    v_mov_b32 v113, v108
    s_nop 1
    v_permlane32_swap_b32 v112, v113
    v_rcp_f32 v113, v113
    s_nop 0
    v_pk_mul_f32 v[96:97], v[96:97], v[112:113] op_sel:[0,1] op_sel_hi:[1,1]
    v_pk_mul_f32 v[98:99], v[98:99], v[112:113] op_sel:[0,1] op_sel_hi:[1,1]
    v_pk_mul_f32 v[100:101], v[100:101], v[112:113] op_sel:[0,1] op_sel_hi:[1,1]
    v_pk_mul_f32 v[102:103], v[102:103], v[112:113] op_sel:[0,1] op_sel_hi:[1,1]
    v_pk_mul_f32 v[104:105], v[104:105], v[112:113] op_sel:[0,1] op_sel_hi:[1,1]
    v_pk_mul_f32 v[106:107], v[106:107], v[112:113] op_sel:[0,1] op_sel_hi:[1,1]
    v_pk_mul_f32 v[108:109], v[108:109], v[112:113] op_sel:[0,1] op_sel_hi:[1,1]
    v_pk_mul_f32 v[110:111], v[110:111], v[112:113] op_sel:[0,1] op_sel_hi:[1,1]
    v_cvt_pk_bf16_f32 v48, v96, v97
    v_cvt_pk_bf16_f32 v49, v98, v99
    v_cvt_pk_bf16_f32 v50, v100, v101
    v_cvt_pk_bf16_f32 v51, v102, v103
    v_cvt_pk_bf16_f32 v52, v104, v105
    v_cvt_pk_bf16_f32 v53, v106, v107
    v_cvt_pk_bf16_f32 v54, v108, v109
    v_cvt_pk_bf16_f32 v55, v110, v111
    s_mov_b32 s31, s38
    s_cmp_eq_u32 s31, 0
    s_cbranch_scc1 st_slow16
    buffer_store_dwordx4 v[48:51], v6, s[8:11], s28 offen offset:0
    buffer_store_dwordx4 v[52:55], v6, s[8:11], s28 offen offset:1024
    s_branch st_done16
st_slow16:
    buffer_store_dwordx4 v[48:51], v6, s[8:11], s28 offen offset:0 sc1
    buffer_store_dwordx4 v[52:55], v6, s[8:11], s28 offen offset:1024 sc1
st_done16:
    ds_write_b128 v12, v[48:51]
    ds_write_b128 v12, v[52:55] offset:1024
    s_waitcnt lgkmcnt(0)
    s_barrier
    ds_read_b128 v[112:115], v14 offset:0
    ds_read_b128 v[116:119], v14 offset:1024
    ds_read_b128 v[120:123], v14 offset:12288
    ds_read_b128 v[124:127], v14 offset:13312
    ds_read_b128 v[128:131], v14 offset:24576
    ds_read_b128 v[132:135], v14 offset:25600
    ds_read_b128 v[136:139], v14 offset:36864
    ds_read_b128 v[140:143], v14 offset:37888
    v_lshlrev_b32 v56, 16, v224
    v_and_b32 v57, 0xffff0000, v224
    v_lshlrev_b32 v58, 16, v225
    v_and_b32 v59, 0xffff0000, v225
    v_lshlrev_b32 v60, 16, v226
    v_and_b32 v61, 0xffff0000, v226
    v_lshlrev_b32 v62, 16, v227
    v_and_b32 v63, 0xffff0000, v227
    v_lshlrev_b32 v64, 16, v228
    v_and_b32 v65, 0xffff0000, v228
    v_lshlrev_b32 v66, 16, v229
    v_and_b32 v67, 0xffff0000, v229
    v_lshlrev_b32 v68, 16, v230
    v_and_b32 v69, 0xffff0000, v230
    v_lshlrev_b32 v70, 16, v231
    v_and_b32 v71, 0xffff0000, v231
    s_waitcnt lgkmcnt(7)
    v_mfma_f32_32x32x16_bf16 v[144:159], a[0:3], v[112:115], 0
    s_waitcnt lgkmcnt(6)
    v_mfma_f32_32x32x16_bf16 v[144:159], a[4:7], v[116:119], v[144:159]
    s_waitcnt lgkmcnt(5)
    v_mfma_f32_32x32x16_bf16 v[144:159], a[8:11], v[120:123], v[144:159]
    s_waitcnt lgkmcnt(4)
    v_mfma_f32_32x32x16_bf16 v[144:159], a[12:15], v[124:127], v[144:159]
    s_waitcnt vmcnt(0)
    s_mov_b64 exec, 1
    s_cmp_eq_u32 s38, 0
    s_cbranch_scc1 wf_slow17
    buffer_store_dword v10, v11, s[8:11], s30 offen
wf_done17:
    s_mov_b64 exec, -1
    s_waitcnt lgkmcnt(3)
    v_mfma_f32_32x32x16_bf16 v[144:159], a[16:19], v[128:131], v[144:159]
    s_waitcnt lgkmcnt(2)
    v_mfma_f32_32x32x16_bf16 v[144:159], a[20:23], v[132:135], v[144:159]
    s_waitcnt lgkmcnt(1)
    v_mfma_f32_32x32x16_bf16 v[144:159], a[24:27], v[136:139], v[144:159]
    s_waitcnt lgkmcnt(0)
    v_mfma_f32_32x32x16_bf16 v[144:159], a[28:31], v[140:143], v[144:159]
    s_xor_b32 s42, s19, 1
    s_lshl_b32 s42, s42, 13
    s_add_u32 s42, s42, s23
    s_xor_b32 s43, s19, 2
    s_lshl_b32 s43, s43, 13
    s_add_u32 s43, s43, s23
    s_xor_b32 s44, s19, 3
    s_lshl_b32 s44, s44, 13
    s_add_u32 s44, s44, s23
    s_mov_b32 s31, s44
    v_lshrrev_b32 v2, 2, v6
    s_mov_b64 exec, 0xf
    s_mov_b32 s45, 200000
poll18:
    buffer_load_dword v1, v2, s[8:11], s29 offen sc1
    s_sub_u32 s45, s45, 1
    s_cmp_eq_u32 s45, 0
    s_cbranch_scc1 poll_out18
    s_waitcnt vmcnt(0)
    v_cmp_ne_u32 vcc, 1, v1
    s_cbranch_vccnz poll18
poll_out18:
    s_waitcnt vmcnt(0)
poll_ok18:
    s_mov_b64 exec, -1
    s_add_u32 m0, s27, 2048
    s_nop 0
    buffer_load_dwordx4 v6, s[8:11], s42 offen offset:0 sc1 lds
    buffer_load_dwordx4 v6, s[8:11], s42 offen offset:1024 sc1 lds
    s_add_u32 m0, s27, 4096
    s_nop 0
    buffer_load_dwordx4 v6, s[8:11], s43 offen offset:0 sc1 lds
    buffer_load_dwordx4 v6, s[8:11], s43 offen offset:1024 sc1 lds
    s_add_u32 m0, s27, 6144
    s_nop 0
    buffer_load_dwordx4 v6, s[8:11], s31 offen offset:0 sc1 lds
    buffer_load_dwordx4 v6, s[8:11], s31 offen offset:1024 sc1 lds
    s_lshl_b32 s29, s18, 7
    s_lshl_b32 s42, s32, 2
    s_add_u32 s29, s29, s42
    s_add_u32 s29, s29, s0
    s_add_u32 s29, s29, 1024
    s_add_u32 s28, s34, s20
    s_add_u32 s28, s28, 2621440
    s_lshl_b32 s30, s18, 12
    s_lshr_b32 s42, s32, 1
    s_lshl_b32 s42, s42, 9
    s_add_u32 s30, s30, s42
    s_and_b32 s42, s32, 1
    s_lshl_b32 s42, s42, 3
    s_add_u32 s30, s30, s42
    s_add_u32 s30, s30, 42467328
    v_lshlrev_b32 v13, 4, v3
    s_waitcnt vmcnt(4)
    s_barrier
    ds_read_b128 v[112:115], v14 offset:2048
    ds_read_b128 v[116:119], v14 offset:3072
    ds_read_b128 v[120:123], v14 offset:14336
    ds_read_b128 v[124:127], v14 offset:15360
    ds_read_b128 v[128:131], v14 offset:26624
    ds_read_b128 v[132:135], v14 offset:27648
    s_waitcnt lgkmcnt(5)
    v_mfma_f32_32x32x16_bf16 v[144:159], a[32:35], v[112:115], v[144:159]
    ds_read_b128 v[136:139], v14 offset:38912
    ds_read_b128 v[140:143], v14 offset:39936
    s_waitcnt lgkmcnt(6)
    v_mfma_f32_32x32x16_bf16 v[144:159], a[36:39], v[116:119], v[144:159]
    s_waitcnt vmcnt(2)
    s_barrier
    ds_read_b128 v[112:115], v14 offset:4096
    s_waitcnt lgkmcnt(6)
    v_mfma_f32_32x32x16_bf16 v[144:159], a[40:43], v[120:123], v[144:159]
    ds_read_b128 v[116:119], v14 offset:5120
    s_waitcnt lgkmcnt(6)
    v_mfma_f32_32x32x16_bf16 v[144:159], a[44:47], v[124:127], v[144:159]
    ds_read_b128 v[120:123], v14 offset:16384
    s_waitcnt lgkmcnt(6)
    v_mfma_f32_32x32x16_bf16 v[144:159], a[48:51], v[128:131], v[144:159]
    ds_read_b128 v[124:127], v14 offset:17408
    s_waitcnt lgkmcnt(6)
    v_mfma_f32_32x32x16_bf16 v[144:159], a[52:55], v[132:135], v[144:159]
    ds_read_b128 v[128:131], v14 offset:28672
    s_waitcnt lgkmcnt(6)
    v_mfma_f32_32x32x16_bf16 v[144:159], a[56:59], v[136:139], v[144:159]
    ds_read_b128 v[132:135], v14 offset:29696
    s_waitcnt lgkmcnt(6)
    v_mfma_f32_32x32x16_bf16 v[144:159], a[60:63], v[140:143], v[144:159]
    ds_read_b128 v[136:139], v14 offset:40960
    s_waitcnt lgkmcnt(6)
    v_mfma_f32_32x32x16_bf16 v[144:159], v[240:243], v[112:115], v[144:159]
    ds_read_b128 v[140:143], v14 offset:41984
    s_waitcnt lgkmcnt(6)
    v_mfma_f32_32x32x16_bf16 v[144:159], v[244:247], v[116:119], v[144:159]
    s_waitcnt vmcnt(0)
    s_barrier
    ds_read_b128 v[112:115], v14 offset:6144
    s_waitcnt lgkmcnt(6)
    v_mfma_f32_32x32x16_bf16 v[144:159], v[248:251], v[120:123], v[144:159]
    ds_read_b128 v[116:119], v14 offset:7168
    s_waitcnt lgkmcnt(6)
    v_mfma_f32_32x32x16_bf16 v[144:159], v[252:255], v[124:127], v[144:159]
    ds_read_b128 v[120:123], v14 offset:18432
    s_waitcnt lgkmcnt(6)
    v_mfma_f32_32x32x16_bf16 v[144:159], v[160:163], v[128:131], v[144:159]
    ds_read_b128 v[124:127], v14 offset:19456
    s_waitcnt lgkmcnt(6)
    v_mfma_f32_32x32x16_bf16 v[144:159], v[164:167], v[132:135], v[144:159]
    ds_read_b128 v[128:131], v14 offset:30720
    s_waitcnt lgkmcnt(6)
    v_mfma_f32_32x32x16_bf16 v[144:159], v[168:171], v[136:139], v[144:159]
    ds_read_b128 v[132:135], v14 offset:31744
    s_waitcnt lgkmcnt(6)
    v_mfma_f32_32x32x16_bf16 v[144:159], v[172:175], v[140:143], v[144:159]
    ds_read_b128 v[136:139], v14 offset:43008
    s_waitcnt lgkmcnt(6)
    v_mfma_f32_32x32x16_bf16 v[144:159], v[176:179], v[112:115], v[144:159]
    ds_read_b128 v[140:143], v14 offset:44032
    s_waitcnt lgkmcnt(6)
    v_mfma_f32_32x32x16_bf16 v[144:159], v[180:183], v[116:119], v[144:159]
    s_waitcnt lgkmcnt(5)
    v_mfma_f32_32x32x16_bf16 v[144:159], v[184:187], v[120:123], v[144:159]
    s_waitcnt lgkmcnt(4)
    v_mfma_f32_32x32x16_bf16 v[144:159], v[188:191], v[124:127], v[144:159]
    s_waitcnt lgkmcnt(3)
    v_mfma_f32_32x32x16_bf16 v[144:159], v[192:195], v[128:131], v[144:159]
    s_waitcnt lgkmcnt(2)
    v_mfma_f32_32x32x16_bf16 v[144:159], v[196:199], v[132:135], v[144:159]
    s_waitcnt lgkmcnt(1)
    v_mfma_f32_32x32x16_bf16 v[144:159], v[200:203], v[136:139], v[144:159]
    s_waitcnt lgkmcnt(0)
    v_mfma_f32_32x32x16_bf16 v[144:159], v[204:207], v[140:143], v[144:159]
    s_barrier
    v_mov_b32 v248, v238
    v_mov_b32 v249, v239
    s_cmp_ge_u32 s32, 14
    s_cbranch_scc1 op_skip
    s_nop 6
    v_pk_add_f32 v[56:57], v[56:57], v[144:145]
    v_pk_add_f32 v[58:59], v[58:59], v[146:147]
    v_pk_add_f32 v[60:61], v[60:61], v[148:149]
    v_pk_add_f32 v[62:63], v[62:63], v[150:151]
    v_pk_add_f32 v[64:65], v[64:65], v[152:153]
    v_pk_add_f32 v[66:67], v[66:67], v[154:155]
    v_pk_add_f32 v[68:69], v[68:69], v[156:157]
    v_pk_add_f32 v[70:71], v[70:71], v[158:159]
    v_cvt_pk_bf16_f32 v48, v56, v57
    v_cvt_pk_bf16_f32 v49, v58, v59
    v_cvt_pk_bf16_f32 v50, v60, v61
    v_cvt_pk_bf16_f32 v51, v62, v63
    v_cvt_pk_bf16_f32 v52, v64, v65
    v_cvt_pk_bf16_f32 v53, v66, v67
    v_cvt_pk_bf16_f32 v54, v68, v69
    v_cvt_pk_bf16_f32 v55, v70, v71
    s_cmp_eq_u32 s38, 0
    s_cbranch_scc1 st_slow19
    buffer_store_dwordx4 v[48:51], v6, s[8:11], s28 offen offset:0
    buffer_store_dwordx4 v[52:55], v6, s[8:11], s28 offen offset:1024
    s_branch st_done19
st_slow19:
    buffer_store_dwordx4 v[48:51], v6, s[8:11], s28 offen offset:0 sc1
    buffer_store_dwordx4 v[52:55], v6, s[8:11], s28 offen offset:1024 sc1
st_done19:
    v_pk_add_f32 v[112:113], v[56:57], v[58:59]
    v_pk_mul_f32 v[114:115], v[56:57], v[56:57]
    v_pk_add_f32 v[116:117], v[60:61], v[62:63]
    v_pk_mul_f32 v[118:119], v[58:59], v[58:59]
    v_pk_fma_f32 v[114:115], v[60:61], v[60:61], v[114:115]
    v_pk_fma_f32 v[118:119], v[62:63], v[62:63], v[118:119]
    v_pk_add_f32 v[112:113], v[112:113], v[64:65]
    v_pk_fma_f32 v[114:115], v[64:65], v[64:65], v[114:115]
    v_pk_add_f32 v[116:117], v[116:117], v[66:67]
    v_pk_fma_f32 v[118:119], v[66:67], v[66:67], v[118:119]
    v_pk_add_f32 v[112:113], v[112:113], v[68:69]
    v_pk_fma_f32 v[114:115], v[68:69], v[68:69], v[114:115]
    v_pk_add_f32 v[116:117], v[116:117], v[70:71]
    v_pk_fma_f32 v[118:119], v[70:71], v[70:71], v[118:119]
    v_pk_add_f32 v[112:113], v[112:113], v[116:117]
    v_pk_add_f32 v[114:115], v[114:115], v[118:119]
    v_add_f32 v112, v112, v113
    v_add_f32 v113, v114, v115
    v_mov_b32 v114, v112
    v_mov_b32 v115, v113
    s_nop 0
    v_permlane32_swap_b32 v112, v114
    v_permlane32_swap_b32 v113, v115
    v_pk_add_f32 v[112:113], v[112:113], v[114:115]
    s_mov_b32 exec_hi, 0
    s_cmp_eq_u32 s38, 0
    s_cbranch_scc1 st_slow20
    buffer_store_dwordx2 v[112:113], v13, s[8:11], s30 offen
    s_branch st_done20
st_slow20:
    buffer_store_dwordx2 v[112:113], v13, s[8:11], s30 offen sc1
st_done20:
    s_mov_b32 exec_hi, -1
    s_waitcnt vmcnt(0)
    s_mov_b64 exec, 1
    s_cmp_eq_u32 s38, 0
    s_cbranch_scc1 wf_slow21
    buffer_store_dword v10, v11, s[8:11], s29 offen
wf_done21:
    s_mov_b64 exec, -1
op_skip:
    s_nop 1
    s_add_u32 m0, s26, 114688
    s_nop 0
    buffer_load_dwordx4 v6, s[8:11], s25 offen offset:0 lds
    buffer_load_dwordx4 v6, s[8:11], s25 offen offset:1024 lds
    buffer_load_dwordx4 v6, s[8:11], s25 offen offset:2048 lds
    buffer_load_dwordx4 v6, s[8:11], s25 offen offset:3072 lds
    s_add_u32 s25, s25, 4096
    s_add_u32 m0, s26, 118784
    s_nop 0
    buffer_load_dwordx4 v6, s[8:11], s25 offen offset:0 lds
    buffer_load_dwordx4 v6, s[8:11], s25 offen offset:1024 lds
    buffer_load_dwordx4 v6, s[8:11], s25 offen offset:2048 lds
    s_add_u32 s25, s25, 24576
    s_lshr_b32 s42, s17, 4
    s_lshl_b32 s42, s42, 2
    s_add_u32 s42, s42, s3
    s_lshl_b32 s28, s16, 3
    s_add_u32 s28, s28, s42
    s_lshl_b32 s44, s28, 7
    s_add_u32 s44, s44, s0
    s_add_u32 s44, s44, 1024
    s_mul_i32 s23, s28, 28672
    s_add_u32 s23, s23, s20
    s_add_u32 s23, s23, 2621440
    s_and_b32 s27, s38, s39
    v_add_u32 v7, 0x10000, v6
    v_add_u32 v8, 0x20000, v6
    v_and_b32 v3, 31, v0
    v_bfe_u32 v4, v0, 5, 1
    ds_read_b128 a[0:3], v6 offset:0
    ds_read_b128 a[4:7], v6 offset:1024
    ds_read_b128 a[8:11], v6 offset:2048
    ds_read_b128 a[12:15], v6 offset:3072
    ds_read_b128 a[16:19], v6 offset:4096
    ds_read_b128 a[20:23], v6 offset:5120
    ds_read_b128 a[24:27], v6 offset:6144
    s_and_b32 s37, s17, 3
    s_lshr_b32 s29, s17, 2
    s_lshl_b32 s32, s16, 3
    s_lshl_b32 s42, s37, 1
    s_add_u32 s32, s32, s42
    s_lshr_b32 s42, s3, 1
    s_add_u32 s32, s32, s42
    s_mul_i32 s34, s32, 28672
    s_min_u32 s42, s29, 6
    s_lshl_b32 s42, s42, 12
    s_add_u32 s34, s34, s42
    s_and_b32 s42, s3, 1
    s_lshl_b32 s42, s42, 11
    s_add_u32 s34, s34, s42
    s_lshl_b32 s36, s16, 10
    s_add_u32 s36, s36, s0
    s_add_u32 s36, s36, 4096
    v_bfe_u32 v250, v0, 1, 2
    v_and_b32 v251, 1, v0
    v_lshlrev_b32 v250, 4, v250
    v_lshl_add_u32 v250, v251, 2, v250
    s_lshr_b32 s42, s37, 1
    s_lshl_b32 s42, s42, 2
    s_add_u32 s42, s42, s3
    s_lshl_b32 s42, s42, 6
    s_and_b32 s43, s37, 1
    s_lshl_b32 s43, s43, 3
    s_add_u32 s42, s42, s43
    v_add_u32 v250, s42, v250
    s_lshl_b32 s42, s17, 4
    s_lshl_b32 s43, s3, 2
    s_add_u32 s42, s42, s43
    v_mov_b32 v251, s42
    v_mov_b32 v252, 1
    v_lshrrev_b32 v2, 2, v6
    s_mov_b64 exec, 0x3fff
    s_mov_b32 s45, 200000
poll22:
    buffer_load_dword v1, v2, s[8:11], s44 offen sc1
    s_sub_u32 s45, s45, 1
    s_cmp_eq_u32 s45, 0
    s_cbranch_scc1 poll_out22
    s_waitcnt vmcnt(0)
    v_cmp_ne_u32 vcc, 1, v1
    s_cbranch_vccnz poll22
poll_out22:
    s_waitcnt vmcnt(0)
poll_ok22:
    s_mov_b64 exec, -1
    buffer_load_dwordx4 v[16:19], v6, s[8:11], s23 offen offset:0 sc1
    buffer_load_dwordx4 v[20:23], v6, s[8:11], s23 offen offset:1024 sc1
    buffer_load_dwordx4 v[24:27], v6, s[8:11], s23 offen offset:2048 sc1
    buffer_load_dwordx4 v[28:31], v6, s[8:11], s23 offen offset:3072 sc1
    s_add_u32 s23, s23, 4096
    buffer_load_dwordx4 v[32:35], v6, s[8:11], s23 offen offset:0 sc1
    buffer_load_dwordx4 v[36:39], v6, s[8:11], s23 offen offset:1024 sc1
    buffer_load_dwordx4 v[40:43], v6, s[8:11], s23 offen offset:2048 sc1
    buffer_load_dwordx4 v[44:47], v6, s[8:11], s23 offen offset:3072 sc1
    s_add_u32 s23, s23, 4096
    s_waitcnt vmcnt(7)
    s_waitcnt lgkmcnt(6)
    v_mfma_f32_32x32x16_bf16 v[128:143], a[0:3], v[16:19], 0
    ds_read_b128 a[28:31], v6 offset:7168
    buffer_load_dwordx4 v[48:51], v6, s[8:11], s23 offen offset:0 sc1
    s_waitcnt lgkmcnt(6)
    v_mfma_f32_32x32x16_bf16 v[144:159], a[4:7], v[16:19], 0
    ds_read_b128 a[0:3], v6 offset:8192
    s_waitcnt lgkmcnt(6)
    v_mfma_f32_32x32x16_bf16 v[160:175], a[8:11], v[16:19], 0
    ds_read_b128 a[4:7], v6 offset:9216
    buffer_load_dwordx4 v[52:55], v6, s[8:11], s23 offen offset:1024 sc1
    s_waitcnt vmcnt(8)
    s_waitcnt lgkmcnt(6)
    v_mfma_f32_32x32x16_bf16 v[128:143], a[12:15], v[20:23], v[128:143]
    ds_read_b128 a[8:11], v6 offset:10240
    s_waitcnt lgkmcnt(6)
    v_mfma_f32_32x32x16_bf16 v[144:159], a[16:19], v[20:23], v[144:159]
    ds_read_b128 a[12:15], v6 offset:11264
    buffer_load_dwordx4 v[56:59], v6, s[8:11], s23 offen offset:2048 sc1
    s_waitcnt lgkmcnt(6)
    v_mfma_f32_32x32x16_bf16 v[160:175], a[20:23], v[20:23], v[160:175]
    ds_read_b128 a[16:19], v6 offset:12288
    s_waitcnt vmcnt(8)
    s_waitcnt lgkmcnt(6)
    v_mfma_f32_32x32x16_bf16 v[128:143], a[24:27], v[24:27], v[128:143]
    ds_read_b128 a[20:23], v6 offset:13312
    buffer_load_dwordx4 v[60:63], v6, s[8:11], s23 offen offset:3072 sc1
    s_add_u32 s23, s23, 4096
    s_waitcnt lgkmcnt(6)
    v_mfma_f32_32x32x16_bf16 v[144:159], a[28:31], v[24:27], v[144:159]
    ds_read_b128 a[24:27], v6 offset:14336
    s_waitcnt lgkmcnt(6)
    v_mfma_f32_32x32x16_bf16 v[160:175], a[0:3], v[24:27], v[160:175]
    ds_read_b128 a[28:31], v6 offset:15360
    buffer_load_dwordx4 v[64:67], v6, s[8:11], s23 offen offset:0 sc1
    s_waitcnt vmcnt(9)
    s_waitcnt lgkmcnt(6)
    v_mfma_f32_32x32x16_bf16 v[128:143], a[4:7], v[28:31], v[128:143]
    ds_read_b128 a[0:3], v6 offset:16384
    s_waitcnt lgkmcnt(6)
    v_mfma_f32_32x32x16_bf16 v[144:159], a[8:11], v[28:31], v[144:159]
    ds_read_b128 a[4:7], v6 offset:17408
    buffer_load_dwordx4 v[68:71], v6, s[8:11], s23 offen offset:1024 sc1
    s_waitcnt lgkmcnt(6)
    v_mfma_f32_32x32x16_bf16 v[160:175], a[12:15], v[28:31], v[160:175]
    ds_read_b128 a[8:11], v6 offset:18432
    s_waitcnt vmcnt(9)
    s_waitcnt lgkmcnt(6)
    v_mfma_f32_32x32x16_bf16 v[128:143], a[16:19], v[32:35], v[128:143]
    ds_read_b128 a[12:15], v6 offset:19456
    buffer_load_dwordx4 v[72:75], v6, s[8:11], s23 offen offset:2048 sc1
    s_waitcnt lgkmcnt(6)
    v_mfma_f32_32x32x16_bf16 v[144:159], a[20:23], v[32:35], v[144:159]
    ds_read_b128 a[16:19], v6 offset:20480
    s_waitcnt lgkmcnt(6)
    v_mfma_f32_32x32x16_bf16 v[160:175], a[24:27], v[32:35], v[160:175]
    ds_read_b128 a[20:23], v6 offset:21504
    buffer_load_dwordx4 v[76:79], v6, s[8:11], s23 offen offset:3072 sc1
    s_add_u32 s23, s23, 4096
    s_waitcnt vmcnt(10)
    s_waitcnt lgkmcnt(6)
    v_mfma_f32_32x32x16_bf16 v[128:143], a[28:31], v[36:39], v[128:143]
    ds_read_b128 a[24:27], v6 offset:22528
    s_waitcnt lgkmcnt(6)
    v_mfma_f32_32x32x16_bf16 v[144:159], a[0:3], v[36:39], v[144:159]
    ds_read_b128 a[28:31], v6 offset:23552
    buffer_load_dwordx4 v[80:83], v6, s[8:11], s23 offen offset:0 sc1
    s_waitcnt lgkmcnt(6)
    v_mfma_f32_32x32x16_bf16 v[160:175], a[4:7], v[36:39], v[160:175]
    ds_read_b128 a[0:3], v6 offset:24576
    s_waitcnt vmcnt(10)
    s_waitcnt lgkmcnt(6)
    v_mfma_f32_32x32x16_bf16 v[128:143], a[8:11], v[40:43], v[128:143]
    ds_read_b128 a[4:7], v6 offset:25600
    buffer_load_dwordx4 v[84:87], v6, s[8:11], s23 offen offset:1024 sc1
    s_waitcnt lgkmcnt(6)
    v_mfma_f32_32x32x16_bf16 v[144:159], a[12:15], v[40:43], v[144:159]
    ds_read_b128 a[8:11], v6 offset:26624
    s_waitcnt lgkmcnt(6)
    v_mfma_f32_32x32x16_bf16 v[160:175], a[16:19], v[40:43], v[160:175]
    ds_read_b128 a[12:15], v6 offset:27648
    buffer_load_dwordx4 v[88:91], v6, s[8:11], s23 offen offset:2048 sc1
    s_waitcnt vmcnt(11)
    s_waitcnt lgkmcnt(6)
    v_mfma_f32_32x32x16_bf16 v[128:143], a[20:23], v[44:47], v[128:143]
    ds_read_b128 a[16:19], v6 offset:28672
    s_waitcnt lgkmcnt(6)
    v_mfma_f32_32x32x16_bf16 v[144:159], a[24:27], v[44:47], v[144:159]
    ds_read_b128 a[20:23], v6 offset:29696
    buffer_load_dwordx4 v[92:95], v6, s[8:11], s23 offen offset:3072 sc1
    s_add_u32 s23, s23, 4096
    s_waitcnt lgkmcnt(6)
    v_mfma_f32_32x32x16_bf16 v[160:175], a[28:31], v[44:47], v[160:175]
    ds_read_b128 a[24:27], v6 offset:30720
    s_waitcnt vmcnt(11)
    s_waitcnt lgkmcnt(6)
    v_mfma_f32_32x32x16_bf16 v[128:143], a[0:3], v[48:51], v[128:143]
    ds_read_b128 a[28:31], v6 offset:31744
    buffer_load_dwordx4 v[96:99], v6, s[8:11], s23 offen offset:0 sc1
    s_waitcnt lgkmcnt(6)
    v_mfma_f32_32x32x16_bf16 v[144:159], a[4:7], v[48:51], v[144:159]
    ds_read_b128 a[0:3], v6 offset:32768
    s_waitcnt lgkmcnt(6)
    v_mfma_f32_32x32x16_bf16 v[160:175], a[8:11], v[48:51], v[160:175]
    ds_read_b128 a[4:7], v6 offset:33792
    buffer_load_dwordx4 v[100:103], v6, s[8:11], s23 offen offset:1024 sc1
    s_waitcnt vmcnt(12)
    s_waitcnt lgkmcnt(6)
    v_mfma_f32_32x32x16_bf16 v[128:143], a[12:15], v[52:55], v[128:143]
    ds_read_b128 a[8:11], v6 offset:34816
    s_barrier
    s_waitcnt lgkmcnt(6)
    v_mfma_f32_32x32x16_bf16 v[144:159], a[16:19], v[52:55], v[144:159]
    ds_read_b128 a[12:15], v6 offset:35840
    buffer_load_dwordx4 v[104:107], v6, s[8:11], s23 offen offset:2048 sc1
    s_waitcnt lgkmcnt(6)
    v_mfma_f32_32x32x16_bf16 v[160:175], a[20:23], v[52:55], v[160:175]
    ds_read_b128 a[16:19], v6 offset:36864
    s_waitcnt vmcnt(12)
    s_waitcnt lgkmcnt(6)
    v_mfma_f32_32x32x16_bf16 v[128:143], a[24:27], v[56:59], v[128:143]
    ds_read_b128 a[20:23], v6 offset:37888
    buffer_load_dwordx4 v[108:111], v6, s[8:11], s23 offen offset:3072 sc1
    s_add_u32 s23, s23, 4096
    s_waitcnt lgkmcnt(6)
    v_mfma_f32_32x32x16_bf16 v[144:159], a[28:31], v[56:59], v[144:159]
    ds_read_b128 a[24:27], v6 offset:38912
    s_waitcnt lgkmcnt(6)
    v_mfma_f32_32x32x16_bf16 v[160:175], a[0:3], v[56:59], v[160:175]
    ds_read_b128 a[28:31], v6 offset:39936
    buffer_load_dwordx4 v[112:115], v6, s[8:11], s23 offen offset:0 sc1
    s_waitcnt vmcnt(13)
    s_waitcnt lgkmcnt(6)
    v_mfma_f32_32x32x16_bf16 v[128:143], a[4:7], v[60:63], v[128:143]
    ds_read_b128 a[0:3], v6 offset:40960
    s_waitcnt lgkmcnt(6)
    v_mfma_f32_32x32x16_bf16 v[144:159], a[8:11], v[60:63], v[144:159]
    ds_read_b128 a[4:7], v6 offset:41984
    buffer_load_dwordx4 v[116:119], v6, s[8:11], s23 offen offset:1024 sc1
    s_waitcnt lgkmcnt(6)
    v_mfma_f32_32x32x16_bf16 v[160:175], a[12:15], v[60:63], v[160:175]
    ds_read_b128 a[8:11], v6 offset:43008
    s_waitcnt vmcnt(13)
    s_waitcnt lgkmcnt(6)
    v_mfma_f32_32x32x16_bf16 v[128:143], a[16:19], v[64:67], v[128:143]
    ds_read_b128 a[12:15], v6 offset:44032
    buffer_load_dwordx4 v[120:123], v6, s[8:11], s23 offen offset:2048 sc1
    s_waitcnt lgkmcnt(6)
    v_mfma_f32_32x32x16_bf16 v[144:159], a[20:23], v[64:67], v[144:159]
    ds_read_b128 a[16:19], v6 offset:45056
    s_waitcnt lgkmcnt(6)
    v_mfma_f32_32x32x16_bf16 v[160:175], a[24:27], v[64:67], v[160:175]
    ds_read_b128 a[20:23], v6 offset:46080
    buffer_load_dwordx4 v[124:127], v6, s[8:11], s23 offen offset:3072 sc1
    s_add_u32 s23, s23, 4096
    s_waitcnt vmcnt(14)
    s_waitcnt lgkmcnt(6)
    v_mfma_f32_32x32x16_bf16 v[128:143], a[28:31], v[68:71], v[128:143]
    ds_read_b128 a[24:27], v6 offset:47104
    s_add_u32 m0, s26, 0
    s_nop 0
    buffer_load_dwordx4 v6, s[8:11], s25 offen offset:0 lds
    s_waitcnt lgkmcnt(6)
    v_mfma_f32_32x32x16_bf16 v[144:159], a[0:3], v[68:71], v[144:159]
    ds_read_b128 a[28:31], v6 offset:48128
    s_waitcnt lgkmcnt(6)
    v_mfma_f32_32x32x16_bf16 v[160:175], a[4:7], v[68:71], v[160:175]
    ds_read_b128 a[0:3], v6 offset:49152
    s_waitcnt vmcnt(14)
    s_waitcnt lgkmcnt(6)
    v_mfma_f32_32x32x16_bf16 v[128:143], a[8:11], v[72:75], v[128:143]
    ds_read_b128 a[4:7], v6 offset:50176
    s_waitcnt lgkmcnt(6)
    v_mfma_f32_32x32x16_bf16 v[144:159], a[12:15], v[72:75], v[144:159]
    ds_read_b128 a[8:11], v6 offset:51200
    s_add_u32 m0, s26, 0
    s_nop 0
    buffer_load_dwordx4 v6, s[8:11], s25 offen offset:1024 lds
    s_waitcnt lgkmcnt(6)
    v_mfma_f32_32x32x16_bf16 v[160:175], a[16:19], v[72:75], v[160:175]
    ds_read_b128 a[12:15], v6 offset:52224
    s_waitcnt vmcnt(14)
    s_waitcnt lgkmcnt(6)
    v_mfma_f32_32x32x16_bf16 v[128:143], a[20:23], v[76:79], v[128:143]
    ds_read_b128 a[16:19], v6 offset:53248
    s_waitcnt lgkmcnt(6)
    v_mfma_f32_32x32x16_bf16 v[144:159], a[24:27], v[76:79], v[144:159]
    ds_read_b128 a[20:23], v6 offset:54272
    s_waitcnt lgkmcnt(6)
    v_mfma_f32_32x32x16_bf16 v[160:175], a[28:31], v[76:79], v[160:175]
    ds_read_b128 a[24:27], v6 offset:55296
    s_add_u32 m0, s26, 0
    s_nop 0
    buffer_load_dwordx4 v6, s[8:11], s25 offen offset:2048 lds
    s_waitcnt vmcnt(14)
    s_waitcnt lgkmcnt(6)
    v_mfma_f32_32x32x16_bf16 v[128:143], a[0:3], v[80:83], v[128:143]
    ds_read_b128 a[28:31], v6 offset:56320
    s_waitcnt lgkmcnt(6)
    v_mfma_f32_32x32x16_bf16 v[144:159], a[4:7], v[80:83], v[144:159]
    ds_read_b128 a[0:3], v6 offset:57344
    s_waitcnt lgkmcnt(6)
    v_mfma_f32_32x32x16_bf16 v[160:175], a[8:11], v[80:83], v[160:175]
    ds_read_b128 a[4:7], v6 offset:58368
    s_waitcnt vmcnt(13)
    s_waitcnt lgkmcnt(6)
    v_mfma_f32_32x32x16_bf16 v[128:143], a[12:15], v[84:87], v[128:143]
    ds_read_b128 a[8:11], v6 offset:59392
    s_add_u32 m0, s26, 0
    s_nop 0
    buffer_load_dwordx4 v6, s[8:11], s25 offen offset:3072 lds
    s_waitcnt lgkmcnt(6)
    v_mfma_f32_32x32x16_bf16 v[144:159], a[16:19], v[84:87], v[144:159]
    ds_read_b128 a[12:15], v6 offset:60416
    s_waitcnt lgkmcnt(6)
    v_mfma_f32_32x32x16_bf16 v[160:175], a[20:23], v[84:87], v[160:175]
    ds_read_b128 a[16:19], v6 offset:61440
    s_waitcnt vmcnt(13)
    s_waitcnt lgkmcnt(6)
    v_mfma_f32_32x32x16_bf16 v[128:143], a[24:27], v[88:91], v[128:143]
    ds_read_b128 a[20:23], v6 offset:62464
    s_waitcnt lgkmcnt(6)
    v_mfma_f32_32x32x16_bf16 v[144:159], a[28:31], v[88:91], v[144:159]
    ds_read_b128 a[24:27], v6 offset:63488
    s_add_u32 s25, s25, 4096
    s_add_u32 m0, s26, 4096
    s_nop 0
    buffer_load_dwordx4 v6, s[8:11], s25 offen offset:0 lds
    s_barrier
    s_waitcnt lgkmcnt(6)
    v_mfma_f32_32x32x16_bf16 v[160:175], a[0:3], v[88:91], v[160:175]
    ds_read_b128 a[28:31], v6 offset:64512
    s_waitcnt vmcnt(13)
    s_waitcnt lgkmcnt(6)
    v_mfma_f32_32x32x16_bf16 v[128:143], a[4:7], v[92:95], v[128:143]
    ds_read_b128 a[0:3], v7 offset:0
    s_waitcnt lgkmcnt(6)
    v_mfma_f32_32x32x16_bf16 v[144:159], a[8:11], v[92:95], v[144:159]
    ds_read_b128 a[4:7], v7 offset:1024
    s_waitcnt lgkmcnt(6)
    v_mfma_f32_32x32x16_bf16 v[160:175], a[12:15], v[92:95], v[160:175]
    ds_read_b128 a[8:11], v7 offset:2048
    s_add_u32 m0, s26, 4096
    s_nop 0
    buffer_load_dwordx4 v6, s[8:11], s25 offen offset:1024 lds
    s_waitcnt vmcnt(13)
    s_waitcnt lgkmcnt(6)
    v_mfma_f32_32x32x16_bf16 v[128:143], a[16:19], v[96:99], v[128:143]
    ds_read_b128 a[12:15], v7 offset:3072
    s_add_u32 s33, s35, 32768
    buffer_load_dwordx4 a[128:131], v248, s[8:11], s33 offen
    s_waitcnt lgkmcnt(6)
    v_mfma_f32_32x32x16_bf16 v[144:159], a[20:23], v[96:99], v[144:159]
    ds_read_b128 a[16:19], v7 offset:4096
    s_waitcnt lgkmcnt(6)
    v_mfma_f32_32x32x16_bf16 v[160:175], a[24:27], v[96:99], v[160:175]
    ds_read_b128 a[20:23], v7 offset:5120
    s_waitcnt vmcnt(13)
    s_waitcnt lgkmcnt(6)
    v_mfma_f32_32x32x16_bf16 v[128:143], a[28:31], v[100:103], v[128:143]
    ds_read_b128 a[24:27], v7 offset:6144
    s_add_u32 m0, s26, 4096
    s_nop 0
    buffer_load_dwordx4 v6, s[8:11], s25 offen offset:2048 lds
    s_add_u32 s25, s25, 24576
    s_waitcnt lgkmcnt(6)
    v_mfma_f32_32x32x16_bf16 v[144:159], a[0:3], v[100:103], v[144:159]
    ds_read_b128 a[28:31], v7 offset:7168
    s_waitcnt lgkmcnt(6)
    v_mfma_f32_32x32x16_bf16 v[160:175], a[4:7], v[100:103], v[160:175]
    ds_read_b128 a[0:3], v7 offset:8192
    s_waitcnt vmcnt(13)
    s_waitcnt lgkmcnt(6)
    v_mfma_f32_32x32x16_bf16 v[128:143], a[8:11], v[104:107], v[128:143]
    ds_read_b128 a[4:7], v7 offset:9216
    buffer_load_dwordx4 a[132:135], v249, s[8:11], s33 offen
    s_waitcnt lgkmcnt(6)
    v_mfma_f32_32x32x16_bf16 v[144:159], a[12:15], v[104:107], v[144:159]
    ds_read_b128 a[8:11], v7 offset:10240
    s_add_u32 m0, s26, 28672
    s_nop 0
    buffer_load_dwordx4 v6, s[8:11], s25 offen offset:0 lds
    s_waitcnt lgkmcnt(6)
    v_mfma_f32_32x32x16_bf16 v[160:175], a[16:19], v[104:107], v[160:175]
    ds_read_b128 a[12:15], v7 offset:11264
    s_waitcnt vmcnt(14)
    s_waitcnt lgkmcnt(6)
    v_mfma_f32_32x32x16_bf16 v[128:143], a[20:23], v[108:111], v[128:143]
    ds_read_b128 a[16:19], v7 offset:12288
    s_add_u32 s33, s35, 43008
    buffer_load_dwordx4 a[136:139], v248, s[8:11], s33 offen
    s_waitcnt lgkmcnt(6)
    v_mfma_f32_32x32x16_bf16 v[144:159], a[24:27], v[108:111], v[144:159]
    ds_read_b128 a[20:23], v7 offset:13312
    s_waitcnt lgkmcnt(6)
    v_mfma_f32_32x32x16_bf16 v[160:175], a[28:31], v[108:111], v[160:175]
    ds_read_b128 a[24:27], v7 offset:14336
    s_add_u32 m0, s26, 28672
    s_nop 0
    buffer_load_dwordx4 v6, s[8:11], s25 offen offset:1024 lds
    s_waitcnt vmcnt(15)
    s_waitcnt lgkmcnt(6)
    v_mfma_f32_32x32x16_bf16 v[128:143], a[0:3], v[112:115], v[128:143]
    ds_read_b128 a[28:31], v7 offset:15360
    buffer_load_dwordx4 a[140:143], v249, s[8:11], s33 offen
    s_waitcnt lgkmcnt(6)
    v_mfma_f32_32x32x16_bf16 v[144:159], a[4:7], v[112:115], v[144:159]
    ds_read_b128 a[0:3], v7 offset:16384
    s_waitcnt lgkmcnt(6)
    v_mfma_f32_32x32x16_bf16 v[160:175], a[8:11], v[112:115], v[160:175]
    ds_read_b128 a[4:7], v7 offset:17408
    s_waitcnt vmcnt(15)
    s_waitcnt lgkmcnt(6)
    v_mfma_f32_32x32x16_bf16 v[128:143], a[12:15], v[116:119], v[128:143]
    ds_read_b128 a[8:11], v7 offset:18432
    s_add_u32 m0, s26, 28672
    s_nop 0
    buffer_load_dwordx4 v6, s[8:11], s25 offen offset:2048 lds
    s_waitcnt lgkmcnt(6)
    v_mfma_f32_32x32x16_bf16 v[144:159], a[16:19], v[116:119], v[144:159]
    ds_read_b128 a[12:15], v7 offset:19456
    s_waitcnt lgkmcnt(6)
    v_mfma_f32_32x32x16_bf16 v[160:175], a[20:23], v[116:119], v[160:175]
    ds_read_b128 a[16:19], v7 offset:20480
    s_waitcnt vmcnt(15)
    s_waitcnt lgkmcnt(6)
    v_mfma_f32_32x32x16_bf16 v[128:143], a[24:27], v[120:123], v[128:143]
    ds_read_b128 a[20:23], v7 offset:21504
    s_add_u32 s33, s35, 45056
    buffer_load_dwordx4 a[144:147], v248, s[8:11], s33 offen
    s_waitcnt lgkmcnt(6)
    v_mfma_f32_32x32x16_bf16 v[144:159], a[28:31], v[120:123], v[144:159]
    ds_read_b128 a[24:27], v7 offset:22528
    s_add_u32 m0, s26, 28672
    s_nop 0
    buffer_load_dwordx4 v6, s[8:11], s25 offen offset:3072 lds
    s_waitcnt lgkmcnt(6)
    v_mfma_f32_32x32x16_bf16 v[160:175], a[0:3], v[120:123], v[160:175]
    ds_read_b128 a[28:31], v7 offset:23552
    s_waitcnt vmcnt(16)
    s_waitcnt lgkmcnt(6)
    v_mfma_f32_32x32x16_bf16 v[128:143], a[4:7], v[124:127], v[128:143]
    ds_read_b128 a[0:3], v7 offset:24576
    buffer_load_dwordx4 a[148:151], v249, s[8:11], s33 offen
    s_waitcnt lgkmcnt(6)
    v_mfma_f32_32x32x16_bf16 v[144:159], a[8:11], v[124:127], v[144:159]
    ds_read_b128 a[4:7], v7 offset:25600
    s_waitcnt lgkmcnt(6)
    v_mfma_f32_32x32x16_bf16 v[160:175], a[12:15], v[124:127], v[160:175]
    ds_read_b128 a[8:11], v7 offset:26624
    s_add_u32 s25, s25, 4096
    s_add_u32 m0, s26, 32768
    s_nop 0
    buffer_load_dwordx4 v6, s[8:11], s25 offen offset:0 lds
    s_waitcnt lgkmcnt(6)
    v_mfma_f32_32x32x16_bf16 v[176:191], a[16:19], v[16:19], 0
    ds_read_b128 a[12:15], v7 offset:27648
    s_add_u32 s33, s35, 47104
    buffer_load_dwordx4 a[152:155], v248, s[8:11], s33 offen
    s_waitcnt lgkmcnt(6)
    v_mfma_f32_32x32x16_bf16 v[192:207], a[20:23], v[16:19], 0
    ds_read_b128 a[16:19], v7 offset:28672
    s_mul_i32 s24, s28, 49152
    s_and_b32 s43, s17, 15
    s_mul_i32 s43, s43, 3072
    s_add_u32 s24, s24, s43
    s_add_u32 s24, s24, s20
    s_add_u32 s24, s24, 6815744
    v_mul_f32 v128, v128, v136
    v_mul_f32 v129, v129, v137
    v_mul_f32 v130, v130, v138
    v_mul_f32 v131, v131, v139
    s_waitcnt lgkmcnt(6)
    v_mfma_f32_32x32x16_bf16 v[176:191], a[24:27], v[20:23], v[176:191]
    ds_read_b128 a[20:23], v7 offset:29696
    v_mul_f32 v132, v132, v140
    v_mul_f32 v133, v133, v141
    v_mul_f32 v134, v134, v142
    v_mul_f32 v135, v135, v143
    s_waitcnt lgkmcnt(6)
    v_mfma_f32_32x32x16_bf16 v[192:207], a[28:31], v[20:23], v[192:207]
    ds_read_b128 a[24:27], v7 offset:30720
    s_add_u32 m0, s26, 32768
    s_nop 0
    buffer_load_dwordx4 v6, s[8:11], s25 offen offset:1024 lds
    v_cvt_pk_bf16_f32 v136, v128, v129
    v_cvt_pk_bf16_f32 v137, v130, v131
    v_cvt_pk_bf16_f32 v138, v132, v133
    v_cvt_pk_bf16_f32 v139, v134, v135
    s_waitcnt lgkmcnt(6)
    v_mfma_f32_32x32x16_bf16 v[176:191], a[0:3], v[24:27], v[176:191]
    ds_read_b128 a[28:31], v7 offset:31744
    buffer_store_dwordx4 v[136:139], v6, s[8:11], s24 offen offset:0 sc1
    v_mul_f32 v144, v144, v152
    v_mul_f32 v145, v145, v153
    v_mul_f32 v146, v146, v154
    v_mul_f32 v147, v147, v155
    s_waitcnt lgkmcnt(6)
    v_mfma_f32_32x32x16_bf16 v[192:207], a[4:7], v[24:27], v[192:207]
    ds_read_b128 a[0:3], v7 offset:32768
    v_mul_f32 v148, v148, v156
    v_mul_f32 v149, v149, v157
    v_mul_f32 v150, v150, v158
    v_mul_f32 v151, v151, v159
    s_waitcnt lgkmcnt(6)
    v_mfma_f32_32x32x16_bf16 v[176:191], a[8:11], v[28:31], v[176:191]
    ds_read_b128 a[4:7], v7 offset:33792
    buffer_load_dwordx4 a[156:159], v249, s[8:11], s33 offen
    v_cvt_pk_bf16_f32 v152, v144, v145
    v_cvt_pk_bf16_f32 v153, v146, v147
    v_cvt_pk_bf16_f32 v154, v148, v149
    v_cvt_pk_bf16_f32 v155, v150, v151
    s_waitcnt lgkmcnt(6)
    v_mfma_f32_32x32x16_bf16 v[192:207], a[12:15], v[28:31], v[192:207]
    ds_read_b128 a[8:11], v7 offset:34816
    s_add_u32 m0, s26, 32768
    s_nop 0
    buffer_load_dwordx4 v6, s[8:11], s25 offen offset:2048 lds
    s_add_u32 s25, s25, 24576
    buffer_store_dwordx4 v[152:155], v6, s[8:11], s24 offen offset:1024 sc1
    v_mul_f32 v160, v160, v168
    v_mul_f32 v161, v161, v169
    v_mul_f32 v162, v162, v170
    v_mul_f32 v163, v163, v171
    s_waitcnt lgkmcnt(6)
    v_mfma_f32_32x32x16_bf16 v[176:191], a[16:19], v[32:35], v[176:191]
    ds_read_b128 a[12:15], v7 offset:35840
    v_mul_f32 v164, v164, v172
    v_mul_f32 v165, v165, v173
    v_mul_f32 v166, v166, v174
    v_mul_f32 v167, v167, v175
    s_waitcnt lgkmcnt(6)
    v_mfma_f32_32x32x16_bf16 v[192:207], a[20:23], v[32:35], v[192:207]
    ds_read_b128 a[16:19], v7 offset:36864
    s_add_u32 s33, s35, 6144
    buffer_load_dwordx4 a[160:163], v248, s[8:11], s33 offen
    v_cvt_pk_bf16_f32 v168, v160, v161
    v_cvt_pk_bf16_f32 v169, v162, v163
    v_cvt_pk_bf16_f32 v170, v164, v165
    v_cvt_pk_bf16_f32 v171, v166, v167
    s_waitcnt lgkmcnt(6)
    v_mfma_f32_32x32x16_bf16 v[176:191], a[24:27], v[36:39], v[176:191]
    ds_read_b128 a[20:23], v7 offset:37888
    buffer_store_dwordx4 v[168:171], v6, s[8:11], s24 offen offset:2048 sc1
    s_waitcnt lgkmcnt(6)
    v_mfma_f32_32x32x16_bf16 v[192:207], a[28:31], v[36:39], v[192:207]
    ds_read_b128 a[24:27], v7 offset:38912
    s_waitcnt lgkmcnt(6)
    v_mfma_f32_32x32x16_bf16 v[176:191], a[0:3], v[40:43], v[176:191]
    ds_read_b128 a[28:31], v7 offset:39936
    buffer_load_dwordx4 a[164:167], v249, s[8:11], s33 offen
    s_waitcnt lgkmcnt(6)
    v_mfma_f32_32x32x16_bf16 v[192:207], a[4:7], v[40:43], v[192:207]
    ds_read_b128 a[0:3], v7 offset:40960
    s_waitcnt lgkmcnt(6)
    v_mfma_f32_32x32x16_bf16 v[176:191], a[8:11], v[44:47], v[176:191]
    ds_read_b128 a[4:7], v7 offset:41984
    s_waitcnt lgkmcnt(6)
    v_mfma_f32_32x32x16_bf16 v[192:207], a[12:15], v[44:47], v[192:207]
    ds_read_b128 a[8:11], v7 offset:43008
    s_add_u32 s33, s35, 8192
    buffer_load_dwordx4 a[168:171], v248, s[8:11], s33 offen
    s_waitcnt lgkmcnt(6)
    v_mfma_f32_32x32x16_bf16 v[176:191], a[16:19], v[48:51], v[176:191]
    ds_read_b128 a[12:15], v7 offset:44032
    s_waitcnt lgkmcnt(6)
    v_mfma_f32_32x32x16_bf16 v[192:207], a[20:23], v[48:51], v[192:207]
    ds_read_b128 a[16:19], v7 offset:45056
    s_waitcnt lgkmcnt(6)
    v_mfma_f32_32x32x16_bf16 v[176:191], a[24:27], v[52:55], v[176:191]
    ds_read_b128 a[20:23], v7 offset:46080
    buffer_load_dwordx4 a[172:175], v249, s[8:11], s33 offen
    s_waitcnt lgkmcnt(6)
    v_mfma_f32_32x32x16_bf16 v[192:207], a[28:31], v[52:55], v[192:207]
    ds_read_b128 a[24:27], v7 offset:47104
    s_waitcnt lgkmcnt(6)
    v_mfma_f32_32x32x16_bf16 v[176:191], a[0:3], v[56:59], v[176:191]
    ds_read_b128 a[28:31], v7 offset:48128
    s_barrier
    s_waitcnt lgkmcnt(6)
    v_mfma_f32_32x32x16_bf16 v[192:207], a[4:7], v[56:59], v[192:207]
    ds_read_b128 a[0:3], v7 offset:49152
    s_add_u32 s33, s35, 20480
    buffer_load_dwordx4 a[176:179], v248, s[8:11], s33 offen
    s_waitcnt lgkmcnt(6)
    v_mfma_f32_32x32x16_bf16 v[176:191], a[8:11], v[60:63], v[176:191]
    ds_read_b128 a[4:7], v7 offset:50176
    s_waitcnt lgkmcnt(6)
    v_mfma_f32_32x32x16_bf16 v[192:207], a[12:15], v[60:63], v[192:207]
    ds_read_b128 a[8:11], v7 offset:51200
    s_waitcnt lgkmcnt(6)
    v_mfma_f32_32x32x16_bf16 v[176:191], a[16:19], v[64:67], v[176:191]
    ds_read_b128 a[12:15], v7 offset:52224
    buffer_load_dwordx4 a[180:183], v249, s[8:11], s33 offen
    s_waitcnt lgkmcnt(6)
    v_mfma_f32_32x32x16_bf16 v[192:207], a[20:23], v[64:67], v[192:207]
    ds_read_b128 a[16:19], v7 offset:53248
    s_waitcnt lgkmcnt(6)
    v_mfma_f32_32x32x16_bf16 v[176:191], a[24:27], v[68:71], v[176:191]
    ds_read_b128 a[20:23], v7 offset:54272
    s_waitcnt lgkmcnt(6)
    v_mfma_f32_32x32x16_bf16 v[192:207], a[28:31], v[68:71], v[192:207]
    ds_read_b128 a[24:27], v7 offset:55296
    s_add_u32 s33, s35, 22528
    buffer_load_dwordx4 a[184:187], v248, s[8:11], s33 offen
    s_waitcnt lgkmcnt(6)
    v_mfma_f32_32x32x16_bf16 v[176:191], a[0:3], v[72:75], v[176:191]
    ds_read_b128 a[28:31], v7 offset:56320
    s_waitcnt lgkmcnt(6)
    v_mfma_f32_32x32x16_bf16 v[192:207], a[4:7], v[72:75], v[192:207]
    ds_read_b128 a[0:3], v7 offset:57344
    s_waitcnt lgkmcnt(6)
    v_mfma_f32_32x32x16_bf16 v[176:191], a[8:11], v[76:79], v[176:191]
    ds_read_b128 a[4:7], v7 offset:58368
    buffer_load_dwordx4 a[188:191], v249, s[8:11], s33 offen
    s_waitcnt lgkmcnt(6)
    v_mfma_f32_32x32x16_bf16 v[192:207], a[12:15], v[76:79], v[192:207]
    ds_read_b128 a[8:11], v7 offset:59392
    s_waitcnt lgkmcnt(6)
    v_mfma_f32_32x32x16_bf16 v[176:191], a[16:19], v[80:83], v[176:191]
    ds_read_b128 a[12:15], v7 offset:60416
    s_waitcnt lgkmcnt(6)
    v_mfma_f32_32x32x16_bf16 v[192:207], a[20:23], v[80:83], v[192:207]
    ds_read_b128 a[16:19], v7 offset:61440
    s_add_u32 s33, s35, 34816
    buffer_load_dwordx4 a[192:195], v248, s[8:11], s33 offen
    s_waitcnt lgkmcnt(6)
    v_mfma_f32_32x32x16_bf16 v[176:191], a[24:27], v[84:87], v[176:191]
    ds_read_b128 a[20:23], v7 offset:62464
    s_waitcnt lgkmcnt(6)
    v_mfma_f32_32x32x16_bf16 v[192:207], a[28:31], v[84:87], v[192:207]
    ds_read_b128 a[24:27], v7 offset:63488
    s_waitcnt lgkmcnt(6)
    v_mfma_f32_32x32x16_bf16 v[176:191], a[0:3], v[88:91], v[176:191]
    ds_read_b128 a[28:31], v7 offset:64512
    buffer_load_dwordx4 a[196:199], v249, s[8:11], s33 offen
    s_waitcnt lgkmcnt(6)
    v_mfma_f32_32x32x16_bf16 v[192:207], a[4:7], v[88:91], v[192:207]
    ds_read_b128 a[0:3], v8 offset:0
    s_waitcnt lgkmcnt(6)
    v_mfma_f32_32x32x16_bf16 v[176:191], a[8:11], v[92:95], v[176:191]
    ds_read_b128 a[4:7], v8 offset:1024
    s_waitcnt lgkmcnt(6)
    v_mfma_f32_32x32x16_bf16 v[192:207], a[12:15], v[92:95], v[192:207]
    ds_read_b128 a[8:11], v8 offset:2048
    s_add_u32 s33, s35, 36864
    buffer_load_dwordx4 a[200:203], v248, s[8:11], s33 offen
    s_waitcnt lgkmcnt(6)
    v_mfma_f32_32x32x16_bf16 v[176:191], a[16:19], v[96:99], v[176:191]
    ds_read_b128 a[12:15], v8 offset:3072
    s_waitcnt lgkmcnt(6)
    v_mfma_f32_32x32x16_bf16 v[192:207], a[20:23], v[96:99], v[192:207]
    ds_read_b128 a[16:19], v8 offset:4096
    s_waitcnt lgkmcnt(6)
    v_mfma_f32_32x32x16_bf16 v[176:191], a[24:27], v[100:103], v[176:191]
    ds_read_b128 a[20:23], v8 offset:5120
    buffer_load_dwordx4 a[204:207], v249, s[8:11], s33 offen
    s_waitcnt lgkmcnt(6)
    v_mfma_f32_32x32x16_bf16 v[192:207], a[28:31], v[100:103], v[192:207]
    ds_read_b128 a[24:27], v8 offset:6144
    s_waitcnt lgkmcnt(6)
    v_mfma_f32_32x32x16_bf16 v[176:191], a[0:3], v[104:107], v[176:191]
    ds_read_b128 a[28:31], v8 offset:7168
    s_waitcnt lgkmcnt(6)
    v_mfma_f32_32x32x16_bf16 v[192:207], a[4:7], v[104:107], v[192:207]
    ds_read_b128 a[0:3], v8 offset:8192
    s_add_u32 s33, s35, 49152
    buffer_load_dwordx4 a[208:211], v248, s[8:11], s33 offen
    s_waitcnt lgkmcnt(6)
    v_mfma_f32_32x32x16_bf16 v[176:191], a[8:11], v[108:111], v[176:191]
    ds_read_b128 a[4:7], v8 offset:9216
    s_waitcnt lgkmcnt(6)
    v_mfma_f32_32x32x16_bf16 v[192:207], a[12:15], v[108:111], v[192:207]
    ds_read_b128 a[8:11], v8 offset:10240
    s_waitcnt lgkmcnt(6)
    v_mfma_f32_32x32x16_bf16 v[176:191], a[16:19], v[112:115], v[176:191]
    ds_read_b128 a[12:15], v8 offset:11264
    buffer_load_dwordx4 a[212:215], v249, s[8:11], s33 offen
    s_waitcnt vmcnt(31)
    s_barrier
    s_waitcnt lgkmcnt(6)
    v_mfma_f32_32x32x16_bf16 v[192:207], a[20:23], v[112:115], v[192:207]
    ds_read_b128 a[16:19], v6 offset:0
    s_waitcnt lgkmcnt(6)
    v_mfma_f32_32x32x16_bf16 v[176:191], a[24:27], v[116:119], v[176:191]
    ds_read_b128 a[20:23], v6 offset:1024
    s_waitcnt vmcnt(13)
    s_add_u32 s42, s36, 0
    s_mov_b64 exec, 1
    s_cmp_eq_u32 s38, 0
    s_cbranch_scc1 fl_slow26
    buffer_store_dword v252, v251, s[8:11], s42 offen
fl_done26:
    s_mov_b64 exec, -1
    s_waitcnt lgkmcnt(6)
    v_mfma_f32_32x32x16_bf16 v[192:207], a[28:31], v[116:119], v[192:207]
    ds_read_b128 a[24:27], v6 offset:2048
    s_add_u32 s33, s35, 51200
    buffer_load_dwordx4 a[216:219], v248, s[8:11], s33 offen
    s_waitcnt lgkmcnt(6)
    v_mfma_f32_32x32x16_bf16 v[176:191], a[0:3], v[120:123], v[176:191]
    ds_read_b128 a[28:31], v6 offset:3072
    s_waitcnt lgkmcnt(6)
    v_mfma_f32_32x32x16_bf16 v[192:207], a[4:7], v[120:123], v[192:207]
    ds_read_b128 a[0:3], v6 offset:4096
    s_waitcnt lgkmcnt(6)
    v_mfma_f32_32x32x16_bf16 v[176:191], a[8:11], v[124:127], v[176:191]
    ds_read_b128 a[4:7], v6 offset:5120
    buffer_load_dwordx4 a[220:223], v249, s[8:11], s33 offen
    s_waitcnt lgkmcnt(6)
    v_mfma_f32_32x32x16_bf16 v[192:207], a[12:15], v[124:127], v[192:207]
    ds_read_b128 a[8:11], v6 offset:6144
    s_waitcnt lgkmcnt(6)
    v_mfma_f32_32x32x16_bf16 v[128:143], a[16:19], v[16:19], 0
    ds_read_b128 a[12:15], v6 offset:7168
    s_waitcnt lgkmcnt(6)
    v_mfma_f32_32x32x16_bf16 v[144:159], a[20:23], v[16:19], 0
    ds_read_b128 a[16:19], v6 offset:8192
    s_add_u32 s33, s35, 10240
    buffer_load_dwordx4 a[224:227], v248, s[8:11], s33 offen
    s_mul_i32 s24, s28, 32768
    s_and_b32 s43, s17, 15
    s_mul_i32 s43, s43, 2048
    s_add_u32 s24, s24, s43
    s_add_u32 s24, s24, s20
    s_add_u32 s24, s24, 9961472
    v_mul_f32 v176, v176, v184
    v_mul_f32 v177, v177, v185
    v_mul_f32 v178, v178, v186
    v_mul_f32 v179, v179, v187
    s_waitcnt lgkmcnt(6)
    v_mfma_f32_32x32x16_bf16 v[128:143], a[24:27], v[20:23], v[128:143]
    ds_read_b128 a[20:23], v6 offset:9216
    v_mul_f32 v180, v180, v188
    v_mul_f32 v181, v181, v189
    v_mul_f32 v182, v182, v190
    v_mul_f32 v183, v183, v191
    s_waitcnt lgkmcnt(6)
    v_mfma_f32_32x32x16_bf16 v[144:159], a[28:31], v[20:23], v[144:159]
    ds_read_b128 a[24:27], v6 offset:10240
    v_cvt_pk_bf16_f32 v184, v176, v177
    v_cvt_pk_bf16_f32 v185, v178, v179
    v_cvt_pk_bf16_f32 v186, v180, v181
    v_cvt_pk_bf16_f32 v187, v182, v183
    s_waitcnt lgkmcnt(6)
    v_mfma_f32_32x32x16_bf16 v[128:143], a[0:3], v[24:27], v[128:143]
    ds_read_b128 a[28:31], v6 offset:11264
    buffer_load_dwordx4 a[228:231], v249, s[8:11], s33 offen
    buffer_store_dwordx4 v[184:187], v6, s[8:11], s24 offen offset:0 sc1
    v_mul_f32 v192, v192, v200
    v_mul_f32 v193, v193, v201
    v_mul_f32 v194, v194, v202
    v_mul_f32 v195, v195, v203
    s_waitcnt lgkmcnt(6)
    v_mfma_f32_32x32x16_bf16 v[144:159], a[4:7], v[24:27], v[144:159]
    ds_read_b128 a[0:3], v6 offset:12288
    v_mul_f32 v196, v196, v204
    v_mul_f32 v197, v197, v205
    v_mul_f32 v198, v198, v206
    v_mul_f32 v199, v199, v207
    s_waitcnt lgkmcnt(6)
    v_mfma_f32_32x32x16_bf16 v[128:143], a[8:11], v[28:31], v[128:143]
    ds_read_b128 a[4:7], v6 offset:13312
    s_add_u32 s42, s36, 0
    buffer_load_dword v9, v250, s[8:11], s42 offen sc1
    v_cvt_pk_bf16_f32 v200, v192, v193
    v_cvt_pk_bf16_f32 v201, v194, v195
    v_cvt_pk_bf16_f32 v202, v196, v197
    v_cvt_pk_bf16_f32 v203, v198, v199
    s_waitcnt lgkmcnt(6)
    v_mfma_f32_32x32x16_bf16 v[144:159], a[12:15], v[28:31], v[144:159]
    ds_read_b128 a[8:11], v6 offset:14336
    s_add_u32 s33, s35, 12288
    buffer_load_dwordx4 a[232:235], v248, s[8:11], s33 offen
    buffer_store_dwordx4 v[200:203], v6, s[8:11], s24 offen offset:1024 sc1
    s_waitcnt lgkmcnt(6)
    v_mfma_f32_32x32x16_bf16 v[128:143], a[16:19], v[32:35], v[128:143]
    ds_read_b128 a[12:15], v6 offset:15360
    s_waitcnt lgkmcnt(6)
    v_mfma_f32_32x32x16_bf16 v[144:159], a[20:23], v[32:35], v[144:159]
    ds_read_b128 a[16:19], v6 offset:16384
    s_waitcnt lgkmcnt(6)
    v_mfma_f32_32x32x16_bf16 v[128:143], a[24:27], v[36:39], v[128:143]
    ds_read_b128 a[20:23], v6 offset:17408
    buffer_load_dwordx4 a[236:239], v249, s[8:11], s33 offen
    s_waitcnt lgkmcnt(6)
    v_mfma_f32_32x32x16_bf16 v[144:159], a[28:31], v[36:39], v[144:159]
    ds_read_b128 a[24:27], v6 offset:18432
    s_waitcnt lgkmcnt(6)
    v_mfma_f32_32x32x16_bf16 v[128:143], a[0:3], v[40:43], v[128:143]
    ds_read_b128 a[28:31], v6 offset:19456
    s_waitcnt lgkmcnt(6)
    v_mfma_f32_32x32x16_bf16 v[144:159], a[4:7], v[40:43], v[144:159]
    ds_read_b128 a[0:3], v6 offset:20480
    s_add_u32 s33, s35, 24576
    buffer_load_dwordx4 a[240:243], v248, s[8:11], s33 offen
    s_waitcnt lgkmcnt(6)
    v_mfma_f32_32x32x16_bf16 v[128:143], a[8:11], v[44:47], v[128:143]
    ds_read_b128 a[4:7], v6 offset:21504
    s_waitcnt lgkmcnt(6)
    v_mfma_f32_32x32x16_bf16 v[144:159], a[12:15], v[44:47], v[144:159]
    ds_read_b128 a[8:11], v6 offset:22528
    s_waitcnt lgkmcnt(6)
    v_mfma_f32_32x32x16_bf16 v[128:143], a[16:19], v[48:51], v[128:143]
    ds_read_b128 a[12:15], v6 offset:23552
    buffer_load_dwordx4 a[244:247], v249, s[8:11], s33 offen
    s_waitcnt lgkmcnt(6)
    v_mfma_f32_32x32x16_bf16 v[144:159], a[20:23], v[48:51], v[144:159]
    ds_read_b128 a[16:19], v6 offset:24576
    s_waitcnt lgkmcnt(6)
    v_mfma_f32_32x32x16_bf16 v[128:143], a[24:27], v[52:55], v[128:143]
    ds_read_b128 a[20:23], v6 offset:25600
    s_waitcnt lgkmcnt(6)
    v_mfma_f32_32x32x16_bf16 v[144:159], a[28:31], v[52:55], v[144:159]
    ds_read_b128 a[24:27], v6 offset:26624
    s_add_u32 s33, s35, 26624
    buffer_load_dwordx4 a[248:251], v248, s[8:11], s33 offen
    s_waitcnt lgkmcnt(6)
    v_mfma_f32_32x32x16_bf16 v[128:143], a[0:3], v[56:59], v[128:143]
    ds_read_b128 a[28:31], v6 offset:27648
    s_waitcnt vmcnt(29)
    s_barrier
    s_waitcnt lgkmcnt(6)
    v_mfma_f32_32x32x16_bf16 v[144:159], a[4:7], v[56:59], v[144:159]
    ds_read_b128 a[0:3], v6 offset:28672
    s_waitcnt lgkmcnt(6)
    v_mfma_f32_32x32x16_bf16 v[128:143], a[8:11], v[60:63], v[128:143]
    ds_read_b128 a[4:7], v6 offset:29696
    buffer_load_dwordx4 a[252:255], v249, s[8:11], s33 offen
    s_waitcnt lgkmcnt(6)
    v_mfma_f32_32x32x16_bf16 v[144:159], a[12:15], v[60:63], v[144:159]
    ds_read_b128 a[8:11], v6 offset:30720
    s_waitcnt lgkmcnt(6)
    v_mfma_f32_32x32x16_bf16 v[128:143], a[16:19], v[64:67], v[128:143]
    ds_read_b128 a[12:15], v6 offset:31744
    s_waitcnt lgkmcnt(6)
    v_mfma_f32_32x32x16_bf16 v[144:159], a[20:23], v[64:67], v[144:159]
    ds_read_b128 a[16:19], v6 offset:32768
    s_add_u32 s33, s35, 38912
    buffer_load_dwordx4 v[208:211], v248, s[8:11], s33 offen
    s_waitcnt lgkmcnt(6)
    v_mfma_f32_32x32x16_bf16 v[128:143], a[24:27], v[68:71], v[128:143]
    ds_read_b128 a[20:23], v6 offset:33792
    s_waitcnt lgkmcnt(6)
    v_mfma_f32_32x32x16_bf16 v[144:159], a[28:31], v[68:71], v[144:159]
    ds_read_b128 a[24:27], v6 offset:34816
    s_waitcnt lgkmcnt(6)
    v_mfma_f32_32x32x16_bf16 v[128:143], a[0:3], v[72:75], v[128:143]
    ds_read_b128 a[28:31], v6 offset:35840
    buffer_load_dwordx4 v[212:215], v249, s[8:11], s33 offen
    s_waitcnt lgkmcnt(6)
    v_mfma_f32_32x32x16_bf16 v[144:159], a[4:7], v[72:75], v[144:159]
    ds_read_b128 a[0:3], v6 offset:36864
    s_waitcnt lgkmcnt(6)
    v_mfma_f32_32x32x16_bf16 v[128:143], a[8:11], v[76:79], v[128:143]
    ds_read_b128 a[4:7], v6 offset:37888
    s_waitcnt lgkmcnt(6)
    v_mfma_f32_32x32x16_bf16 v[144:159], a[12:15], v[76:79], v[144:159]
    ds_read_b128 a[8:11], v6 offset:38912
    s_add_u32 s33, s35, 40960
    buffer_load_dwordx4 v[216:219], v248, s[8:11], s33 offen
    s_waitcnt lgkmcnt(6)
    v_mfma_f32_32x32x16_bf16 v[128:143], a[16:19], v[80:83], v[128:143]
    ds_read_b128 a[12:15], v6 offset:39936
    s_waitcnt lgkmcnt(6)
    v_mfma_f32_32x32x16_bf16 v[144:159], a[20:23], v[80:83], v[144:159]
    ds_read_b128 a[16:19], v6 offset:40960
    s_waitcnt lgkmcnt(6)
    v_mfma_f32_32x32x16_bf16 v[128:143], a[24:27], v[84:87], v[128:143]
    ds_read_b128 a[20:23], v6 offset:41984
    buffer_load_dwordx4 v[220:223], v249, s[8:11], s33 offen
    s_waitcnt lgkmcnt(6)
    v_mfma_f32_32x32x16_bf16 v[144:159], a[28:31], v[84:87], v[144:159]
    ds_read_b128 a[24:27], v6 offset:43008
    s_waitcnt lgkmcnt(6)
    v_mfma_f32_32x32x16_bf16 v[128:143], a[0:3], v[88:91], v[128:143]
    ds_read_b128 a[28:31], v6 offset:44032
    s_waitcnt lgkmcnt(6)
    v_mfma_f32_32x32x16_bf16 v[144:159], a[4:7], v[88:91], v[144:159]
    ds_read_b128 a[0:3], v6 offset:45056
    s_add_u32 s33, s35, 53248
    buffer_load_dwordx4 v[224:227], v248, s[8:11], s33 offen
    s_waitcnt lgkmcnt(6)
    v_mfma_f32_32x32x16_bf16 v[128:143], a[8:11], v[92:95], v[128:143]
    ds_read_b128 a[4:7], v6 offset:46080
    s_waitcnt lgkmcnt(6)
    v_mfma_f32_32x32x16_bf16 v[144:159], a[12:15], v[92:95], v[144:159]
    ds_read_b128 a[8:11], v6 offset:47104
    s_waitcnt lgkmcnt(6)
    v_mfma_f32_32x32x16_bf16 v[128:143], a[16:19], v[96:99], v[128:143]
    ds_read_b128 a[12:15], v6 offset:48128
    buffer_load_dwordx4 v[228:231], v249, s[8:11], s33 offen
    s_waitcnt lgkmcnt(6)
    v_mfma_f32_32x32x16_bf16 v[144:159], a[20:23], v[96:99], v[144:159]
    ds_read_b128 a[16:19], v6 offset:49152
    s_waitcnt lgkmcnt(6)
    v_mfma_f32_32x32x16_bf16 v[128:143], a[24:27], v[100:103], v[128:143]
    ds_read_b128 a[20:23], v6 offset:50176
    s_waitcnt lgkmcnt(6)
    v_mfma_f32_32x32x16_bf16 v[144:159], a[28:31], v[100:103], v[144:159]
    ds_read_b128 a[24:27], v6 offset:51200
    s_add_u32 s33, s35, 55296
    buffer_load_dwordx4 v[232:235], v248, s[8:11], s33 offen
    s_waitcnt vmcnt(12)
    s_add_u32 s42, s36, 512
    s_mov_b64 exec, 1
    s_cmp_eq_u32 s38, 0
    s_cbranch_scc1 fl_slow29
    buffer_store_dword v252, v251, s[8:11], s42 offen
fl_done29:
    s_mov_b64 exec, -1
    s_waitcnt lgkmcnt(6)
    v_mfma_f32_32x32x16_bf16 v[128:143], a[0:3], v[104:107], v[128:143]
    ds_read_b128 a[28:31], v6 offset:52224
    s_waitcnt vmcnt(15)
    v_cmp_ne_u32 vcc, 1, v9
    s_cbranch_vccnz ck_slow30
ck_done30:
    s_mul_i32 s23, s32, 49152
    s_xor_b32 s42, s32, 1
    s_mul_i32 s25, s42, 49152
    s_mul_i32 s42, s3, 12288
    s_add_u32 s42, s42, s20
    s_add_u32 s42, s42, 6815744
    s_add_u32 s23, s23, s42
    s_add_u32 s25, s25, s42
    buffer_load_dwordx4 v[16:19], v6, s[8:11], s23 offen offset:0 sc1
    buffer_load_dwordx4 v[20:23], v6, s[8:11], s25 offen offset:0 sc1
    s_waitcnt lgkmcnt(6)
    v_mfma_f32_32x32x16_bf16 v[144:159], a[4:7], v[104:107], v[144:159]
    ds_read_b128 a[0:3], v6 offset:53248
    buffer_load_dwordx4 v[24:27], v6, s[8:11], s23 offen offset:1024 sc1
    buffer_load_dwordx4 v[28:31], v6, s[8:11], s25 offen offset:1024 sc1
    s_waitcnt lgkmcnt(6)
    v_mfma_f32_32x32x16_bf16 v[128:143], a[8:11], v[108:111], v[128:143]
    ds_read_b128 a[4:7], v6 offset:54272
    buffer_load_dwordx4 v[236:239], v249, s[8:11], s33 offen
    buffer_load_dwordx4 v[32:35], v6, s[8:11], s23 offen offset:2048 sc1
    buffer_load_dwordx4 v[36:39], v6, s[8:11], s25 offen offset:2048 sc1
    s_waitcnt lgkmcnt(6)
    v_mfma_f32_32x32x16_bf16 v[144:159], a[12:15], v[108:111], v[144:159]
    ds_read_b128 a[8:11], v6 offset:55296
    buffer_load_dwordx4 v[40:43], v6, s[8:11], s23 offen offset:3072 sc1
    buffer_load_dwordx4 v[44:47], v6, s[8:11], s25 offen offset:3072 sc1
    s_add_u32 s23, s23, 4096
    s_add_u32 s25, s25, 4096
    s_waitcnt lgkmcnt(6)
    v_mfma_f32_32x32x16_bf16 v[128:143], a[16:19], v[112:115], v[128:143]
    ds_read_b128 a[12:15], v6 offset:56320
    buffer_load_dwordx4 v[48:51], v6, s[8:11], s23 offen offset:0 sc1
    buffer_load_dwordx4 v[52:55], v6, s[8:11], s25 offen offset:0 sc1
    s_waitcnt lgkmcnt(6)
    v_mfma_f32_32x32x16_bf16 v[144:159], a[20:23], v[112:115], v[144:159]
    buffer_load_dwordx4 v[56:59], v6, s[8:11], s23 offen offset:1024 sc1
    buffer_load_dwordx4 v[60:63], v6, s[8:11], s25 offen offset:1024 sc1
    s_waitcnt lgkmcnt(5)
    v_mfma_f32_32x32x16_bf16 v[128:143], a[24:27], v[116:119], v[128:143]
    s_waitcnt lgkmcnt(4)
    v_mfma_f32_32x32x16_bf16 v[144:159], a[28:31], v[116:119], v[144:159]
    s_waitcnt lgkmcnt(3)
    v_mfma_f32_32x32x16_bf16 v[128:143], a[0:3], v[120:123], v[128:143]
    s_waitcnt lgkmcnt(2)
    v_mfma_f32_32x32x16_bf16 v[144:159], a[4:7], v[120:123], v[144:159]
    s_waitcnt lgkmcnt(1)
    v_mfma_f32_32x32x16_bf16 v[128:143], a[8:11], v[124:127], v[128:143]
    s_waitcnt lgkmcnt(0)
    v_mfma_f32_32x32x16_bf16 v[144:159], a[12:15], v[124:127], v[144:159]
    s_add_u32 s42, s36, 512
    buffer_load_dword v9, v250, s[8:11], s42 offen sc1
    s_mul_i32 s24, s28, 32768
    s_and_b32 s43, s17, 15
    s_mul_i32 s43, s43, 2048
    s_add_u32 s24, s24, s43
    s_add_u32 s24, s24, s20
    s_add_u32 s24, s24, 0
    v_pk_mul_f32 v[128:129], v[128:129], v[136:137]
    v_pk_mul_f32 v[130:131], v[130:131], v[138:139]
    v_pk_mul_f32 v[132:133], v[132:133], v[140:141]
    v_pk_mul_f32 v[134:135], v[134:135], v[142:143]
    v_cvt_pk_bf16_f32 v136, v128, v129
    v_cvt_pk_bf16_f32 v137, v130, v131
    v_cvt_pk_bf16_f32 v138, v132, v133
    v_cvt_pk_bf16_f32 v139, v134, v135
    s_cmp_eq_u32 s38, 0
    s_cbranch_scc1 st_slow31
    buffer_store_dwordx4 v[136:139], v6, s[8:11], s24 offen offset:0
    s_branch st_done31
st_slow31:
    buffer_store_dwordx4 v[136:139], v6, s[8:11], s24 offen offset:0 sc1
st_done31:
    v_pk_mul_f32 v[144:145], v[144:145], v[152:153]
    v_pk_mul_f32 v[146:147], v[146:147], v[154:155]
    v_pk_mul_f32 v[148:149], v[148:149], v[156:157]
    v_pk_mul_f32 v[150:151], v[150:151], v[158:159]
    v_cvt_pk_bf16_f32 v152, v144, v145
    v_cvt_pk_bf16_f32 v153, v146, v147
    v_cvt_pk_bf16_f32 v154, v148, v149
    v_cvt_pk_bf16_f32 v155, v150, v151
    s_cmp_eq_u32 s38, 0
    s_cbranch_scc1 st_slow32
    buffer_store_dwordx4 v[152:155], v6, s[8:11], s24 offen offset:1024
    s_branch st_done32
st_slow32:
    buffer_store_dwordx4 v[152:155], v6, s[8:11], s24 offen offset:1024 sc1
st_done32:
    s_cmp_ge_u32 s17, 28
    s_cbranch_scc1 down_skip
    s_waitcnt vmcnt(11)
    s_waitcnt vmcnt(14)
    v_mfma_f32_32x32x16_bf16 v[192:207], a[64:67], v[16:19], 0
    v_mfma_f32_32x32x16_bf16 a[16:31], a[68:71], v[16:19], 0
    s_lshl_b32 s42, s32, 12
    s_add_u32 s42, s42, 42467328
    v_mov_b32 v13, 0x7fffff00
    v_cmp_eq_u32 vcc, 0, v4
    s_nop 1
    v_cndmask_b32 v13, v13, v6, vcc
    buffer_load_dwordx4 v[176:179], v6, s[8:11], s42 offen offset:0 sc1
    buffer_load_dwordx4 v[180:183], v6, s[8:11], s42 offen offset:1024 sc1
    buffer_load_dwordx4 v[184:187], v6, s[8:11], s42 offen offset:2048 sc1
    buffer_load_dwordx4 v[188:191], v13, s[8:11], s42 offen offset:3072 sc1
    v_mfma_f32_32x32x16_bf16 a[32:47], a[64:67], v[20:23], 0
    v_mfma_f32_32x32x16_bf16 a[48:63], a[68:71], v[20:23], 0
    s_add_u32 s42, s34, s20
    s_add_u32 s42, s42, 2621440
    buffer_load_dwordx4 v[240:243], v6, s[8:11], s42 offen sc1
    buffer_load_dwordx4 v[244:247], v6, s[8:11], s42 offen offset:1024 sc1
    s_waitcnt vmcnt(18)
    v_mfma_f32_32x32x16_bf16 v[192:207], a[72:75], v[24:27], v[192:207]
    buffer_load_dwordx4 v[64:67], v6, s[8:11], s23 offen offset:2048 sc1
    buffer_load_dwordx4 v[68:71], v6, s[8:11], s25 offen offset:2048 sc1
    v_mfma_f32_32x32x16_bf16 a[16:31], a[76:79], v[24:27], a[16:31]
    v_mfma_f32_32x32x16_bf16 a[32:47], a[72:75], v[28:31], a[32:47]
    v_mfma_f32_32x32x16_bf16 a[48:63], a[76:79], v[28:31], a[48:63]
    s_waitcnt vmcnt(17)
    v_mfma_f32_32x32x16_bf16 v[192:207], a[80:83], v[32:35], v[192:207]
    buffer_load_dwordx4 v[72:75], v6, s[8:11], s23 offen offset:3072 sc1
    buffer_load_dwordx4 v[76:79], v6, s[8:11], s25 offen offset:3072 sc1
    s_add_u32 s23, s23, 4096
    s_add_u32 s25, s25, 4096
    v_mfma_f32_32x32x16_bf16 a[16:31], a[84:87], v[32:35], a[16:31]
    v_mfma_f32_32x32x16_bf16 a[32:47], a[80:83], v[36:39], a[32:47]
    v_mfma_f32_32x32x16_bf16 a[48:63], a[84:87], v[36:39], a[48:63]
    s_waitcnt vmcnt(17)
    v_mfma_f32_32x32x16_bf16 v[192:207], a[88:91], v[40:43], v[192:207]
    buffer_load_dwordx4 v[80:83], v6, s[8:11], s23 offen offset:0 sc1
    buffer_load_dwordx4 v[84:87], v6, s[8:11], s25 offen offset:0 sc1
    v_mfma_f32_32x32x16_bf16 a[16:31], a[92:95], v[40:43], a[16:31]
    s_waitcnt vmcnt(14)
    v_cmp_ne_u32 vcc, 1, v9
    s_cbranch_vccnz ck_slow33
ck_done33:
    v_mfma_f32_32x32x16_bf16 a[32:47], a[88:91], v[44:47], a[32:47]
    v_mfma_f32_32x32x16_bf16 a[48:63], a[92:95], v[44:47], a[48:63]
    s_waitcnt vmcnt(17)
    v_mfma_f32_32x32x16_bf16 v[192:207], a[96:99], v[48:51], v[192:207]
    buffer_load_dwordx4 v[88:91], v6, s[8:11], s23 offen offset:1024 sc1
    buffer_load_dwordx4 v[92:95], v6, s[8:11], s25 offen offset:1024 sc1
    v_mfma_f32_32x32x16_bf16 a[16:31], a[100:103], v[48:51], a[16:31]
    s_waitcnt vmcnt(14)
    s_add_u32 s42, s36, 1024
    s_mov_b64 exec, 1
    s_cmp_eq_u32 s38, 0
    s_cbranch_scc1 fl_slow34
    buffer_store_dword v252, v251, s[8:11], s42 offen
fl_done34:
    s_mov_b64 exec, -1
    v_mfma_f32_32x32x16_bf16 a[32:47], a[96:99], v[52:55], a[32:47]
    v_mfma_f32_32x32x16_bf16 a[48:63], a[100:103], v[52:55], a[48:63]
    s_waitcnt vmcnt(18)
    v_mfma_f32_32x32x16_bf16 v[192:207], a[104:107], v[56:59], v[192:207]
    buffer_load_dwordx4 v[96:99], v6, s[8:11], s23 offen offset:2048 sc1
    buffer_load_dwordx4 v[100:103], v6, s[8:11], s25 offen offset:2048 sc1
    v_mfma_f32_32x32x16_bf16 a[16:31], a[108:111], v[56:59], a[16:31]
    v_mfma_f32_32x32x16_bf16 a[32:47], a[104:107], v[60:63], a[32:47]
    v_mfma_f32_32x32x16_bf16 a[48:63], a[108:111], v[60:63], a[48:63]
    s_waitcnt vmcnt(9)
    v_mfma_f32_32x32x16_bf16 v[192:207], a[112:115], v[64:67], v[192:207]
    buffer_load_dwordx4 v[104:107], v6, s[8:11], s23 offen offset:3072 sc1
    buffer_load_dwordx4 v[108:111], v6, s[8:11], s25 offen offset:3072 sc1
    s_add_u32 s23, s23, 4096
    s_add_u32 s25, s25, 4096
    v_mfma_f32_32x32x16_bf16 a[16:31], a[116:119], v[64:67], a[16:31]
    v_mfma_f32_32x32x16_bf16 a[32:47], a[112:115], v[68:71], a[32:47]
    v_mfma_f32_32x32x16_bf16 a[48:63], a[116:119], v[68:71], a[48:63]
    s_waitcnt vmcnt(9)
    v_mfma_f32_32x32x16_bf16 v[192:207], a[120:123], v[72:75], v[192:207]
    s_waitcnt vmcnt(15)
    v_add_f32 v176, v176, v184
    v_add_f32 v177, v177, v185
    s_mul_i32 s23, s32, 32768
    s_xor_b32 s42, s32, 1
    s_mul_i32 s25, s42, 32768
    s_mul_i32 s42, s3, 8192
    s_add_u32 s42, s42, s20
    s_add_u32 s42, s42, 9961472
    s_add_u32 s23, s23, s42
    s_add_u32 s25, s25, s42
    buffer_load_dwordx4 v[112:115], v6, s[8:11], s23 offen offset:0 sc1
    buffer_load_dwordx4 v[116:119], v6, s[8:11], s25 offen offset:0 sc1
    v_mfma_f32_32x32x16_bf16 a[16:31], a[124:127], v[72:75], a[16:31]
    v_add_f32 v178, v178, v186
    v_add_f32 v179, v179, v187
    v_add_f32 v180, v180, v188
    v_mfma_f32_32x32x16_bf16 a[32:47], a[120:123], v[76:79], a[32:47]
    v_add_f32 v181, v181, v189
    v_add_f32 v182, v182, v190
    v_add_f32 v183, v183, v191
    v_mfma_f32_32x32x16_bf16 a[48:63], a[124:127], v[76:79], a[48:63]
    s_add_u32 s42, s36, 1024
    buffer_load_dword v9, v250, s[8:11], s42 offen sc1
    v_add_f32 v176, v176, v180
    v_add_f32 v177, v177, v181
    v_add_f32 v178, v178, v182
    s_waitcnt vmcnt(10)
    v_mfma_f32_32x32x16_bf16 v[192:207], a[128:131], v[80:83], v[192:207]
    v_add_f32 v179, v179, v183
    v_add_f32 v12, v176, v178
    v_add_f32 v13, v177, v179
    buffer_load_dwordx4 v[120:123], v6, s[8:11], s23 offen offset:1024 sc1
    buffer_load_dwordx4 v[124:127], v6, s[8:11], s25 offen offset:1024 sc1
    v_mfma_f32_32x32x16_bf16 a[16:31], a[132:135], v[80:83], a[16:31]
    v_mov_b32 v14, v12
    v_mov_b32 v15, v13
    s_nop 0
    v_permlane32_swap_b32 v12, v14
    v_mfma_f32_32x32x16_bf16 a[32:47], a[128:131], v[84:87], a[32:47]
    v_permlane32_swap_b32 v13, v15
    v_add_f32 v12, v12, v14
    v_add_f32 v13, v13, v15
    v_mfma_f32_32x32x16_bf16 a[48:63], a[132:135], v[84:87], a[48:63]
    v_mul_f32 v12, 0x3b124925, v12
    v_mul_f32 v13, 0x3b124925, v13
    v_fma_f32 v13, -v12, v12, v13
    s_waitcnt vmcnt(10)
    v_mfma_f32_32x32x16_bf16 v[192:207], a[136:139], v[88:91], v[192:207]
    v_max_f32 v13, 0, v13
    v_add_f32 v13, 0x3727c5ac, v13
    v_rcp_f32 v10, v13
    buffer_load_dwordx4 v[128:131], v6, s[8:11], s23 offen offset:2048 sc1
    buffer_load_dwordx4 v[132:135], v6, s[8:11], s25 offen offset:2048 sc1
    v_mfma_f32_32x32x16_bf16 a[16:31], a[140:143], v[88:91], a[16:31]
    v_mov_b32 v11, v10
    s_xor_b32 s42, s3, 1
    s_mul_i32 s42, s42, 12288
    v_add_u32 v13, s42, v6
    v_mfma_f32_32x32x16_bf16 a[32:47], a[136:139], v[92:95], a[32:47]
    s_xor_b32 s42, s3, 2
    s_mul_i32 s42, s42, 12288
    v_add_u32 v14, s42, v6
    s_xor_b32 s42, s3, 3
    s_mul_i32 s42, s42, 12288
    v_mfma_f32_32x32x16_bf16 a[48:63], a[140:143], v[92:95], a[48:63]
    v_add_u32 v15, s42, v6
    s_mul_i32 s42, s3, 12288
    v_add_u32 v12, s42, v6
    s_waitcnt vmcnt(9)
    s_barrier
    v_mfma_f32_32x32x16_bf16 v[192:207], a[144:147], v[96:99], v[192:207]
    buffer_load_dwordx4 v[136:139], v6, s[8:11], s23 offen offset:3072 sc1
    buffer_load_dwordx4 v[140:143], v6, s[8:11], s25 offen offset:3072 sc1
    s_add_u32 s23, s23, 4096
    s_add_u32 s25, s25, 4096
    v_mfma_f32_32x32x16_bf16 a[16:31], a[148:151], v[96:99], a[16:31]
    v_mfma_f32_32x32x16_bf16 a[32:47], a[144:147], v[100:103], a[32:47]
    v_mfma_f32_32x32x16_bf16 a[48:63], a[148:151], v[100:103], a[48:63]
    s_waitcnt vmcnt(9)
    v_mfma_f32_32x32x16_bf16 v[192:207], a[152:155], v[104:107], v[192:207]
    buffer_load_dwordx4 v[144:147], v6, s[8:11], s23 offen offset:0 sc1
    buffer_load_dwordx4 v[148:151], v6, s[8:11], s25 offen offset:0 sc1
    v_mfma_f32_32x32x16_bf16 a[16:31], a[156:159], v[104:107], a[16:31]
    s_waitcnt vmcnt(8)
    v_cmp_ne_u32 vcc, 1, v9
    s_cbranch_vccnz ck_slow35
ck_done35:
    v_mfma_f32_32x32x16_bf16 a[32:47], a[152:155], v[108:111], a[32:47]
    v_mfma_f32_32x32x16_bf16 a[48:63], a[156:159], v[108:111], a[48:63]
    s_waitcnt vmcnt(9)
    v_mfma_f32_32x32x16_bf16 v[192:207], a[160:163], v[112:115], v[192:207]
    buffer_load_dwordx4 v[152:155], v6, s[8:11], s23 offen offset:1024 sc1
    buffer_load_dwordx4 v[156:159], v6, s[8:11], s25 offen offset:1024 sc1
    v_mfma_f32_32x32x16_bf16 a[16:31], a[164:167], v[112:115], a[16:31]
    v_mfma_f32_32x32x16_bf16 a[32:47], a[160:163], v[116:119], a[32:47]
    v_mfma_f32_32x32x16_bf16 a[48:63], a[164:167], v[116:119], a[48:63]
    s_waitcnt vmcnt(8)
    v_mfma_f32_32x32x16_bf16 v[192:207], a[168:171], v[120:123], v[192:207]
    buffer_load_dwordx4 v[160:163], v6, s[8:11], s23 offen offset:2048 sc1
    buffer_load_dwordx4 v[164:167], v6, s[8:11], s25 offen offset:2048 sc1
    v_mfma_f32_32x32x16_bf16 a[16:31], a[172:175], v[120:123], a[16:31]
    v_mfma_f32_32x32x16_bf16 a[32:47], a[168:171], v[124:127], a[32:47]
    v_mfma_f32_32x32x16_bf16 a[48:63], a[172:175], v[124:127], a[48:63]
    s_waitcnt vmcnt(8)
    v_mfma_f32_32x32x16_bf16 v[192:207], a[176:179], v[128:131], v[192:207]
    buffer_load_dwordx4 v[168:171], v6, s[8:11], s23 offen offset:3072 sc1
    buffer_load_dwordx4 v[172:175], v6, s[8:11], s25 offen offset:3072 sc1
    s_add_u32 s23, s23, 4096
    s_add_u32 s25, s25, 4096
    v_mfma_f32_32x32x16_bf16 a[16:31], a[180:183], v[128:131], a[16:31]
    v_mfma_f32_32x32x16_bf16 a[32:47], a[176:179], v[132:135], a[32:47]
    v_mfma_f32_32x32x16_bf16 a[48:63], a[180:183], v[132:135], a[48:63]
    s_waitcnt vmcnt(8)
    v_mfma_f32_32x32x16_bf16 v[192:207], a[184:187], v[136:139], v[192:207]
    s_mul_i32 s23, s32, 32768
    s_xor_b32 s42, s32, 1
    s_mul_i32 s25, s42, 32768
    s_mul_i32 s42, s3, 8192
    s_add_u32 s42, s42, s20
    s_add_u32 s42, s42, 0
    s_add_u32 s23, s23, s42
    s_add_u32 s25, s25, s42
    buffer_load_dwordx4 v[176:179], v6, s[8:11], s23 offen offset:0 sc1
    buffer_load_dwordx4 v[180:183], v6, s[8:11], s25 offen offset:0 sc1
    v_mfma_f32_32x32x16_bf16 a[16:31], a[188:191], v[136:139], a[16:31]
    v_mfma_f32_32x32x16_bf16 a[32:47], a[184:187], v[140:143], a[32:47]
    v_mfma_f32_32x32x16_bf16 a[48:63], a[188:191], v[140:143], a[48:63]
    s_waitcnt vmcnt(8)
    v_mfma_f32_32x32x16_bf16 v[192:207], a[192:195], v[144:147], v[192:207]
    buffer_load_dwordx4 v[184:187], v6, s[8:11], s23 offen offset:1024 sc1
    buffer_load_dwordx4 v[188:191], v6, s[8:11], s25 offen offset:1024 sc1
    v_mfma_f32_32x32x16_bf16 a[16:31], a[196:199], v[144:147], a[16:31]
    v_mfma_f32_32x32x16_bf16 a[32:47], a[192:195], v[148:151], a[32:47]
    v_mfma_f32_32x32x16_bf16 a[48:63], a[196:199], v[148:151], a[48:63]
    s_waitcnt vmcnt(8)
    v_mfma_f32_32x32x16_bf16 v[192:207], a[200:203], v[152:155], v[192:207]
    buffer_load_dwordx4 v[16:19], v6, s[8:11], s23 offen offset:2048 sc1
    buffer_load_dwordx4 v[20:23], v6, s[8:11], s25 offen offset:2048 sc1
    v_mfma_f32_32x32x16_bf16 a[16:31], a[204:207], v[152:155], a[16:31]
    v_mfma_f32_32x32x16_bf16 a[32:47], a[200:203], v[156:159], a[32:47]
    v_mfma_f32_32x32x16_bf16 a[48:63], a[204:207], v[156:159], a[48:63]
    s_waitcnt vmcnt(8)
    v_mfma_f32_32x32x16_bf16 v[192:207], a[208:211], v[160:163], v[192:207]
    buffer_load_dwordx4 v[24:27], v6, s[8:11], s23 offen offset:3072 sc1
    buffer_load_dwordx4 v[28:31], v6, s[8:11], s25 offen offset:3072 sc1
    s_add_u32 s23, s23, 4096
    s_add_u32 s25, s25, 4096
    v_mfma_f32_32x32x16_bf16 a[16:31], a[212:215], v[160:163], a[16:31]
    v_mfma_f32_32x32x16_bf16 a[32:47], a[208:211], v[164:167], a[32:47]
    v_mfma_f32_32x32x16_bf16 a[48:63], a[212:215], v[164:167], a[48:63]
    s_waitcnt vmcnt(8)
    v_mfma_f32_32x32x16_bf16 v[192:207], a[216:219], v[168:171], v[192:207]
    buffer_load_dwordx4 v[32:35], v6, s[8:11], s23 offen offset:0 sc1
    buffer_load_dwordx4 v[36:39], v6, s[8:11], s25 offen offset:0 sc1
    v_mfma_f32_32x32x16_bf16 a[16:31], a[220:223], v[168:171], a[16:31]
    v_mfma_f32_32x32x16_bf16 a[32:47], a[216:219], v[172:175], a[32:47]
    v_mfma_f32_32x32x16_bf16 a[48:63], a[220:223], v[172:175], a[48:63]
    s_waitcnt vmcnt(8)
    v_mfma_f32_32x32x16_bf16 v[192:207], a[224:227], v[176:179], v[192:207]
    buffer_load_dwordx4 v[40:43], v6, s[8:11], s23 offen offset:1024 sc1
    buffer_load_dwordx4 v[44:47], v6, s[8:11], s25 offen offset:1024 sc1
    v_mfma_f32_32x32x16_bf16 a[16:31], a[228:231], v[176:179], a[16:31]
    v_mfma_f32_32x32x16_bf16 a[32:47], a[224:227], v[180:183], a[32:47]
    v_mfma_f32_32x32x16_bf16 a[48:63], a[228:231], v[180:183], a[48:63]
    s_waitcnt vmcnt(8)
    v_mfma_f32_32x32x16_bf16 v[192:207], a[232:235], v[184:187], v[192:207]
    buffer_load_dwordx4 v[48:51], v6, s[8:11], s23 offen offset:2048 sc1
    buffer_load_dwordx4 v[52:55], v6, s[8:11], s25 offen offset:2048 sc1
    v_mfma_f32_32x32x16_bf16 a[16:31], a[236:239], v[184:187], a[16:31]
    v_mfma_f32_32x32x16_bf16 a[32:47], a[232:235], v[188:191], a[32:47]
    v_mfma_f32_32x32x16_bf16 a[48:63], a[236:239], v[188:191], a[48:63]
    s_waitcnt vmcnt(8)
    v_mfma_f32_32x32x16_bf16 v[192:207], a[240:243], v[16:19], v[192:207]
    buffer_load_dwordx4 v[56:59], v6, s[8:11], s23 offen offset:3072 sc1
    buffer_load_dwordx4 v[60:63], v6, s[8:11], s25 offen offset:3072 sc1
    s_add_u32 s23, s23, 4096
    s_add_u32 s25, s25, 4096
    s_waitcnt vmcnt(46)
    v_lshlrev_b32 v112, 16, v240
    v_and_b32 v113, 0xffff0000, v240
    v_mfma_f32_32x32x16_bf16 a[16:31], a[244:247], v[16:19], a[16:31]
    v_lshlrev_b32 v114, 16, v241
    v_and_b32 v115, 0xffff0000, v241
    v_mfma_f32_32x32x16_bf16 a[32:47], a[240:243], v[20:23], a[32:47]
    v_lshlrev_b32 v116, 16, v242
    v_and_b32 v117, 0xffff0000, v242
    v_mfma_f32_32x32x16_bf16 a[48:63], a[244:247], v[20:23], a[48:63]
    v_lshlrev_b32 v118, 16, v243
    v_and_b32 v119, 0xffff0000, v243
    s_waitcnt vmcnt(8)
    v_mfma_f32_32x32x16_bf16 v[192:207], a[248:251], v[24:27], v[192:207]
    v_lshlrev_b32 v120, 16, v244
    v_and_b32 v121, 0xffff0000, v244
    v_mfma_f32_32x32x16_bf16 a[16:31], a[252:255], v[24:27], a[16:31]
    v_lshlrev_b32 v122, 16, v245
    v_and_b32 v123, 0xffff0000, v245
    v_mfma_f32_32x32x16_bf16 a[32:47], a[248:251], v[28:31], a[32:47]
    v_lshlrev_b32 v124, 16, v246
    v_and_b32 v125, 0xffff0000, v246
    v_mfma_f32_32x32x16_bf16 a[48:63], a[252:255], v[28:31], a[48:63]
    v_lshlrev_b32 v126, 16, v247
    v_and_b32 v127, 0xffff0000, v247
    s_waitcnt vmcnt(6)
    v_mfma_f32_32x32x16_bf16 a[16:31], v[212:215], v[32:35], a[16:31]
    s_waitcnt vmcnt(4)
    v_mfma_f32_32x32x16_bf16 a[16:31], v[220:223], v[40:43], a[16:31]
    s_waitcnt vmcnt(2)
    v_mfma_f32_32x32x16_bf16 a[16:31], v[228:231], v[48:51], a[16:31]
    s_waitcnt vmcnt(0)
    v_mfma_f32_32x32x16_bf16 a[16:31], v[236:239], v[56:59], a[16:31]
    s_lshr_b32 s42, s19, 1
    s_or_b32 s42, s42, s39
    s_cselect_b64 vcc, -1, 0
    v_mfma_f32_32x32x16_bf16 a[32:47], v[208:211], v[36:39], a[32:47]
    s_cbranch_vccnz wq_no36
    s_add_u32 s42, s19, 16
    s_mul_i32 s42, s42, 28672
    s_add_u32 s6, s42, s26
    s_add_u32 s7, s6, 4096
    buffer_load_dwordx4 a[64:67], v6, s[8:11], s6 offen offset:0
wq_no36:
    v_mfma_f32_32x32x16_bf16 a[32:47], v[216:219], v[44:47], a[32:47]
    ds_write_b128 v13, a[16:19] offset:0
    v_mfma_f32_32x32x16_bf16 a[32:47], v[224:227], v[52:55], a[32:47]
    ds_write_b128 v13, a[20:23] offset:1024
    s_cbranch_vccnz wq_no37
    buffer_load_dwordx4 a[68:71], v6, s[8:11], s6 offen offset:1024
wq_no37:
    v_mfma_f32_32x32x16_bf16 a[32:47], v[232:235], v[60:63], a[32:47]
    ds_write_b128 v13, a[24:27] offset:2048
    v_mfma_f32_32x32x16_bf16 a[48:63], v[212:215], v[36:39], a[48:63]
    ds_write_b128 v13, a[28:31] offset:3072
    s_cbranch_vccnz wq_no38
    buffer_load_dwordx4 a[72:75], v6, s[8:11], s6 offen offset:2048
wq_no38:
    v_mfma_f32_32x32x16_bf16 a[48:63], v[220:223], v[44:47], a[48:63]
    ds_write_b128 v14, a[32:35] offset:4096
    v_mfma_f32_32x32x16_bf16 a[48:63], v[228:231], v[52:55], a[48:63]
    ds_write_b128 v14, a[36:39] offset:5120
    s_cbranch_vccnz wq_no39
    buffer_load_dwordx4 a[76:79], v6, s[8:11], s6 offen offset:3072
wq_no39:
    v_mfma_f32_32x32x16_bf16 a[48:63], v[236:239], v[60:63], a[48:63]
    ds_write_b128 v14, a[40:43] offset:6144
    v_mfma_f32_32x32x16_bf16 v[192:207], v[208:211], v[32:35], v[192:207]
    ds_write_b128 v14, a[44:47] offset:7168
    s_cbranch_vccnz wq_no40
    buffer_load_dwordx4 a[80:83], v6, s[8:11], s7 offen offset:0
wq_no40:
    v_mfma_f32_32x32x16_bf16 v[192:207], v[216:219], v[40:43], v[192:207]
    ds_write_b128 v15, a[48:51] offset:8192
    v_mfma_f32_32x32x16_bf16 v[192:207], v[224:227], v[48:51], v[192:207]
    ds_write_b128 v15, a[52:55] offset:9216
    s_cbranch_vccnz wq_no41
    buffer_load_dwordx4 a[84:87], v6, s[8:11], s7 offen offset:1024
wq_no41:
    v_mfma_f32_32x32x16_bf16 v[192:207], v[232:235], v[56:59], v[192:207]
    s_waitcnt lgkmcnt(2)
    s_barrier
    ds_read_b128 v[64:67], v12 offset:0
    ds_read_b128 v[68:71], v12 offset:1024
    ds_write_b128 v15, a[56:59] offset:10240
    ds_read_b128 v[72:75], v12 offset:2048
    s_cbranch_vccnz wq_no42
    buffer_load_dwordx4 a[88:91], v6, s[8:11], s7 offen offset:2048
wq_no42:
    s_cmp_eq_u32 s39, 1
    s_cselect_b64 vcc, -1, 0
    ds_read_b128 v[76:79], v12 offset:3072
    s_cbranch_vccnz wq_no43
    s_xor_b32 s42, s3, 1
    s_lshl_b32 s43, s19, 2
    s_add_u32 s42, s42, s43
    s_mul_i32 s42, s42, 28672
    s_add_u32 s6, s42, s26
    s_add_u32 s7, s6, 4096
    buffer_load_dwordx4 a[92:95], v6, s[8:11], s6 offen offset:0
wq_no43:
    ds_write_b128 v15, a[60:63] offset:11264
    s_cbranch_vccnz wq_no44
    buffer_load_dwordx4 a[96:99], v6, s[8:11], s6 offen offset:1024
wq_no44:
    ds_read_b128 v[80:83], v12 offset:4096
    s_cbranch_vccnz wq_no45
    buffer_load_dwordx4 a[100:103], v6, s[8:11], s6 offen offset:2048
wq_no45:
    ds_read_b128 v[84:87], v12 offset:5120
    s_cbranch_vccnz wq_no46
    buffer_load_dwordx4 a[104:107], v6, s[8:11], s6 offen offset:3072
wq_no46:
    ds_read_b128 v[88:91], v12 offset:6144
    s_cbranch_vccnz wq_no47
    buffer_load_dwordx4 a[108:111], v6, s[8:11], s7 offen offset:0
wq_no47:
    ds_read_b128 v[92:95], v12 offset:7168
    s_cbranch_vccnz wq_no48
    buffer_load_dwordx4 a[112:115], v6, s[8:11], s7 offen offset:1024
wq_no48:
    s_waitcnt lgkmcnt(4)
    s_barrier
    ds_read_b128 v[96:99], v12 offset:8192
    s_cbranch_vccnz wq_no49
    buffer_load_dwordx4 a[116:119], v6, s[8:11], s7 offen offset:2048
wq_no49:
    ds_read_b128 v[100:103], v12 offset:9216
    s_cbranch_vccnz wq_no50
    s_xor_b32 s42, s3, 2
    s_lshl_b32 s43, s19, 2
    s_add_u32 s42, s42, s43
    s_mul_i32 s42, s42, 28672
    s_add_u32 s6, s42, s26
    s_add_u32 s7, s6, 4096
    buffer_load_dwordx4 a[120:123], v6, s[8:11], s6 offen offset:0
wq_no50:
    ds_read_b128 v[104:107], v12 offset:10240
    s_cbranch_vccnz wq_no51
    buffer_load_dwordx4 a[124:127], v6, s[8:11], s6 offen offset:1024
wq_no51:
    ds_read_b128 v[108:111], v12 offset:11264
    s_cbranch_vccnz wq_no52
    buffer_load_dwordx4 a[128:131], v6, s[8:11], s6 offen offset:2048
wq_no52:
    s_waitcnt lgkmcnt(4)
    v_add_f32 v64, v64, v80
    v_add_f32 v65, v65, v81
    v_add_f32 v66, v66, v82
    v_add_f32 v67, v67, v83
    v_add_f32 v68, v68, v84
    v_add_f32 v69, v69, v85
    v_add_f32 v70, v70, v86
    v_add_f32 v71, v71, v87
    v_add_f32 v72, v72, v88
    v_add_f32 v73, v73, v89
    v_add_f32 v74, v74, v90
    v_add_f32 v75, v75, v91
    v_add_f32 v76, v76, v92
    v_add_f32 v77, v77, v93
    v_add_f32 v78, v78, v94
    v_add_f32 v79, v79, v95
    v_fma_f32 v64, v64, v10, v112
    v_fma_f32 v65, v65, v10, v113
    v_fma_f32 v66, v66, v10, v114
    v_fma_f32 v67, v67, v10, v115
    v_fma_f32 v68, v68, v10, v116
    v_fma_f32 v69, v69, v10, v117
    v_fma_f32 v70, v70, v10, v118
    v_fma_f32 v71, v71, v10, v119
    v_fma_f32 v72, v72, v10, v120
    v_fma_f32 v73, v73, v10, v121
    v_fma_f32 v74, v74, v10, v122
    v_fma_f32 v75, v75, v10, v123
    v_fma_f32 v76, v76, v10, v124
    v_fma_f32 v77, v77, v10, v125
    v_fma_f32 v78, v78, v10, v126
    v_fma_f32 v79, v79, v10, v127
    s_waitcnt lgkmcnt(0)
    v_pk_add_f32 v[192:193], v[192:193], v[96:97]
    v_pk_add_f32 v[194:195], v[194:195], v[98:99]
    v_pk_add_f32 v[196:197], v[196:197], v[100:101]
    v_pk_add_f32 v[198:199], v[198:199], v[102:103]
    v_pk_add_f32 v[200:201], v[200:201], v[104:105]
    v_pk_add_f32 v[202:203], v[202:203], v[106:107]
    v_pk_add_f32 v[204:205], v[204:205], v[108:109]
    v_pk_add_f32 v[206:207], v[206:207], v[110:111]
    v_pk_fma_f32 v[16:17], v[192:193], v[10:11], v[64:65]
    v_pk_fma_f32 v[18:19], v[194:195], v[10:11], v[66:67]
    v_pk_fma_f32 v[20:21], v[196:197], v[10:11], v[68:69]
    v_pk_fma_f32 v[22:23], v[198:199], v[10:11], v[70:71]
    v_pk_fma_f32 v[24:25], v[200:201], v[10:11], v[72:73]
    v_pk_fma_f32 v[26:27], v[202:203], v[10:11], v[74:75]
    v_pk_fma_f32 v[28:29], v[204:205], v[10:11], v[76:77]
    v_pk_fma_f32 v[30:31], v[206:207], v[10:11], v[78:79]
    v_cvt_pk_bf16_f32 v96, v16, v17
    v_cvt_pk_bf16_f32 v97, v18, v19
    v_cvt_pk_bf16_f32 v98, v20, v21
    v_cvt_pk_bf16_f32 v99, v22, v23
    v_cvt_pk_bf16_f32 v100, v24, v25
    v_cvt_pk_bf16_f32 v101, v26, v27
    v_cvt_pk_bf16_f32 v102, v28, v29
    v_cvt_pk_bf16_f32 v103, v30, v31
    s_cmp_eq_u32 s39, 1
    s_cbranch_scc0 down_x2
    v_mul_u32_u24 v5, 896, v3
    v_lshl_add_u32 v5, v4, 4, v5
    s_mul_i32 s42, s32, 28672
    s_lshl_b32 s43, s29, 7
    s_add_u32 s42, s42, s43
    s_and_b32 s43, s3, 1
    s_lshl_b32 s43, s43, 6
    s_add_u32 s42, s42, s43
    buffer_store_dwordx4 v[96:99], v5, s[12:15], s42 offen
    buffer_store_dwordx4 v[100:103], v5, s[12:15], s42 offen offset:32
    s_endpgm
down_x2:
    s_nop 1
    s_add_u32 s42, s34, s20
    s_add_u32 s42, s42, 2621440
    s_cmp_eq_u32 s38, 0
    s_cbranch_scc1 st_slow53
    buffer_store_dwordx4 v[96:99], v6, s[8:11], s42 offen
    buffer_store_dwordx4 v[100:103], v6, s[8:11], s42 offen offset:1024
    s_branch st_done53
st_slow53:
    buffer_store_dwordx4 v[96:99], v6, s[8:11], s42 offen sc1
    buffer_store_dwordx4 v[100:103], v6, s[8:11], s42 offen offset:1024 sc1
st_done53:
    v_lshlrev_b32 v40, 4, v3
    s_lshl_b32 s42, s32, 12
    s_lshl_b32 s43, s29, 9
    s_add_u32 s42, s42, s43
    s_and_b32 s43, s3, 1
    s_lshl_b32 s24, s43, 2
    s_lshl_b32 s43, s43, 3
    s_add_u32 s42, s42, s43
    s_add_u32 s42, s42, 42205184
    v_pk_add_f32 v[32:33], v[16:17], v[18:19]
    v_pk_mul_f32 v[34:35], v[16:17], v[16:17]
    v_pk_add_f32 v[36:37], v[20:21], v[22:23]
    v_pk_mul_f32 v[38:39], v[18:19], v[18:19]
    v_pk_fma_f32 v[34:35], v[20:21], v[20:21], v[34:35]
    v_pk_fma_f32 v[38:39], v[22:23], v[22:23], v[38:39]
    v_pk_add_f32 v[32:33], v[32:33], v[24:25]
    v_pk_fma_f32 v[34:35], v[24:25], v[24:25], v[34:35]
    v_pk_add_f32 v[36:37], v[36:37], v[26:27]
    v_pk_fma_f32 v[38:39], v[26:27], v[26:27], v[38:39]
    v_pk_add_f32 v[32:33], v[32:33], v[28:29]
    v_pk_fma_f32 v[34:35], v[28:29], v[28:29], v[34:35]
    v_pk_add_f32 v[36:37], v[36:37], v[30:31]
    v_pk_fma_f32 v[38:39], v[30:31], v[30:31], v[38:39]
    v_pk_add_f32 v[32:33], v[32:33], v[36:37]
    v_pk_add_f32 v[34:35], v[34:35], v[38:39]
    v_add_f32 v32, v32, v33
    v_add_f32 v33, v34, v35
    v_mov_b32 v34, v32
    v_mov_b32 v35, v33
    s_nop 0
    v_permlane32_swap_b32 v32, v34
    v_permlane32_swap_b32 v33, v35
    v_pk_add_f32 v[32:33], v[32:33], v[34:35]
    s_mov_b32 exec_hi, 0
    s_cmp_eq_u32 s38, 0
    s_cbranch_scc1 st_slow54
    buffer_store_dwordx2 v[32:33], v40, s[8:11], s42 offen
    s_branch st_done54
st_slow54:
    buffer_store_dwordx2 v[32:33], v40, s[8:11], s42 offen sc1
st_done54:
    s_mov_b32 exec_hi, -1
    s_lshl_b32 s42, s32, 7
    s_add_u32 s24, s24, s42
    s_lshl_b32 s42, s29, 3
    s_add_u32 s24, s24, s42
    s_add_u32 s24, s24, s0
    s_add_u32 s24, s24, 2048
    v_mov_b32 v41, 0
    s_waitcnt vmcnt(0)
    s_mov_b64 exec, 1
    s_cmp_eq_u32 s38, 0
    s_cbranch_scc1 wf_slow55
    buffer_store_dword v252, v41, s[8:11], s24 offen
wf_done55:
    s_mov_b64 exec, -1
    buffer_load_dwordx4 a[132:135], v6, s[8:11], s6 offen offset:3072
    buffer_load_dwordx4 a[136:139], v6, s[8:11], s7 offen offset:0
    buffer_load_dwordx4 a[140:143], v6, s[8:11], s7 offen offset:1024
    buffer_load_dwordx4 a[144:147], v6, s[8:11], s7 offen offset:2048
    s_branch qkv_wait
down_skip:
    s_nop 3
    s_waitcnt vmcnt(0)
    s_add_u32 s42, s36, 1024
    s_mov_b64 exec, 1
    s_cmp_eq_u32 s38, 0
    s_cbranch_scc1 fl_slow56
    buffer_store_dword v252, v251, s[8:11], s42 offen
fl_done56:
    s_mov_b64 exec, -1
    s_cmp_eq_u32 s39, 1
    s_cbranch_scc1 main_end
    s_cmp_ge_u32 s19, 2
    s_cbranch_scc1 wq_nokv57
    s_add_u32 s42, s19, 16
    s_mul_i32 s42, s42, 28672
    s_add_u32 s6, s42, s26
    s_add_u32 s7, s6, 4096
    buffer_load_dwordx4 a[64:67], v6, s[8:11], s6 offen offset:0
    buffer_load_dwordx4 a[68:71], v6, s[8:11], s6 offen offset:1024
    buffer_load_dwordx4 a[72:75], v6, s[8:11], s6 offen offset:2048
    buffer_load_dwordx4 a[76:79], v6, s[8:11], s6 offen offset:3072
    buffer_load_dwordx4 a[80:83], v6, s[8:11], s7 offen offset:0
    buffer_load_dwordx4 a[84:87], v6, s[8:11], s7 offen offset:1024
    buffer_load_dwordx4 a[88:91], v6, s[8:11], s7 offen offset:2048
wq_nokv57:
    s_xor_b32 s42, s3, 1
    s_lshl_b32 s43, s19, 2
    s_add_u32 s42, s42, s43
    s_mul_i32 s42, s42, 28672
    s_add_u32 s6, s42, s26
    s_add_u32 s7, s6, 4096
    buffer_load_dwordx4 a[92:95], v6, s[8:11], s6 offen offset:0
    buffer_load_dwordx4 a[96:99], v6, s[8:11], s6 offen offset:1024
    buffer_load_dwordx4 a[100:103], v6, s[8:11], s6 offen offset:2048
    buffer_load_dwordx4 a[104:107], v6, s[8:11], s6 offen offset:3072
    buffer_load_dwordx4 a[108:111], v6, s[8:11], s7 offen offset:0
    buffer_load_dwordx4 a[112:115], v6, s[8:11], s7 offen offset:1024
    buffer_load_dwordx4 a[116:119], v6, s[8:11], s7 offen offset:2048
    s_xor_b32 s42, s3, 2
    s_lshl_b32 s43, s19, 2
    s_add_u32 s42, s42, s43
    s_mul_i32 s42, s42, 28672
    s_add_u32 s6, s42, s26
    s_add_u32 s7, s6, 4096
    buffer_load_dwordx4 a[120:123], v6, s[8:11], s6 offen offset:0
    buffer_load_dwordx4 a[124:127], v6, s[8:11], s6 offen offset:1024
    buffer_load_dwordx4 a[128:131], v6, s[8:11], s6 offen offset:2048
    buffer_load_dwordx4 a[132:135], v6, s[8:11], s6 offen offset:3072
    buffer_load_dwordx4 a[136:139], v6, s[8:11], s7 offen offset:0
    buffer_load_dwordx4 a[140:143], v6, s[8:11], s7 offen offset:1024
    buffer_load_dwordx4 a[144:147], v6, s[8:11], s7 offen offset:2048
qkv_wait:
    s_nop 3
    s_lshl_b32 s44, s18, 7
    s_add_u32 s44, s44, s0
    s_add_u32 s44, s44, 2048
    s_add_u32 s21, s20, 2621440
    s_lshl_b32 s24, s18, 12
    s_add_u32 s24, s24, 42205184
    s_mul_i32 s28, s18, 28672
    s_add_u32 s28, s28, s26
    s_add_u32 s28, s28, s21
    s_add_u32 s29, s28, 4096
    v_lshrrev_b32 v2, 2, v6
    s_mov_b64 exec, 0x3fff
    s_mov_b32 s45, 200000
poll58:
    buffer_load_dword v1, v2, s[8:11], s44 offen sc1
    s_sub_u32 s45, s45, 1
    s_cmp_eq_u32 s45, 0
    s_cbranch_scc1 poll_out58
    s_waitcnt vmcnt(0)
    v_cmp_ne_u32 vcc, 1, v1
    s_cbranch_vccnz poll58
poll_out58:
    s_waitcnt vmcnt(0)
poll_ok58:
    s_mov_b64 exec, -1
qkv_go:
    buffer_load_dwordx4 v[96:99], v6, s[8:11], s28 offen offset:0 sc1
    buffer_load_dwordx4 v[100:103], v6, s[8:11], s28 offen offset:1024 sc1
    buffer_load_dwordx4 v[104:107], v6, s[8:11], s28 offen offset:2048 sc1
    buffer_load_dwordx4 v[108:111], v6, s[8:11], s28 offen offset:3072 sc1
    buffer_load_dwordx4 v[112:115], v6, s[8:11], s29 offen offset:0 sc1
    buffer_load_dwordx4 v[116:119], v6, s[8:11], s29 offen offset:1024 sc1
    buffer_load_dwordx4 v[120:123], v6, s[8:11], s29 offen offset:2048 sc1
    s_mov_b32 s4, s24
    s_lshl_b32 s5, s16, 12
    s_add_u32 s5, s5, 41959424
    v_lshlrev_b32 v9, 7, v3
    buffer_load_dwordx4 v[128:131], v6, s[8:11], s4 offen offset:0 sc1
    buffer_load_dwordx4 v[132:135], v6, s[8:11], s4 offen offset:1024 sc1
    s_getreg_b32 s23, hwreg(HW_REG_XCC_ID)
    s_and_b32 s23, s23, 15
    s_add_u32 s23, s23, 1
    s_xor_b32 s42, s3, 1
    s_mul_i32 s43, s42, 12288
    s_add_u32 s43, s43, 81920
    v_add_u32 v125, s43, v6
    s_xor_b32 s42, s3, 2
    s_mul_i32 s43, s42, 12288
    s_add_u32 s43, s43, 81920
    v_add_u32 v126, s43, v6
    s_xor_b32 s42, s3, 3
    s_mul_i32 s43, s42, 12288
    s_add_u32 s43, s43, 81920
    v_add_u32 v127, s43, v6
    s_lshl_b32 s43, s3, 12
    s_add_u32 s43, s43, 49152
    v_add_u32 v208, s43, v6
    s_mul_i32 s42, s3, 12288
    s_add_u32 s42, s42, 81920
    v_add_u32 v12, s42, v6
    s_lshl_b32 s42, s3, 7
    s_add_u32 s42, s42, 65536
    v_lshl_add_u32 v212, v3, 2, s42
    v_lshl_add_u32 v213, v4, 4, s42
    s_and_b32 s43, s3, 1
    s_lshl_b32 s42, s43, 6
    v_add_u32 v213, s42, v213
    s_lshl_b32 s42, s43, 11
    s_add_u32 s42, s42, 49152
    v_add_u32 v209, s42, v6
    s_lshl_b32 s42, s3, 8
    s_add_u32 s42, s42, 66560
    v_lshrrev_b32 v215, 2, v6
    v_add_u32 v215, s42, v215
    v_lshlrev_b32 v210, 2, v3
    v_add_u32 v210, 66560, v210
    s_mov_b32 s36, 0
    s_sub_u32 s37, 0, s43
    v_cmp_eq_u32 vcc, 28, v3
    s_nop 1
    v_cndmask_b32 v214, 0, 1.0, vcc
    s_add_u32 s39, s39, 1
    s_add_u32 s0, s0, 0x10000
    s_lshl_b32 s28, s39, 24
    s_add_u32 s28, s28, 8388608
    s_lshl_b32 s29, s18, 12
    s_add_u32 s29, s29, s28
    s_lshl_b32 s42, s19, 1
    s_add_u32 s42, s42, s43
    s_lshl_b32 s43, s42, 10
    s_add_u32 s29, s29, s43
    s_lshl_b32 s24, s18, 7
    s_add_u32 s24, s24, s0
    s_add_u32 s24, s24, 3072
    s_lshl_b32 s43, s39, 6
    s_add_u32 s43, s43, s18
    s_mul_i32 s43, s43, 4352
    s_add_u32 s43, s43, 42729472
    s_cmp_lt_u32 s3, 2
    s_cselect_b32 s24, s24, s43
    s_lshl_b32 s42, s42, 2
    s_add_u32 s24, s24, s42
    s_lshl_b32 s40, s39, 8
    s_add_u32 s40, s40, 41942784
    s_lshl_b32 s25, s18, 2
    s_add_u32 s25, s25, s40
    v_mov_b32 v226, 0
    v_mov_b32 v227, 1
    s_cmp_lt_u32 s3, 2
    s_cselect_b64 s[30:31], -1, 0
    s_cmp_eq_u32 s19, 0
    s_cbranch_scc1 qkv_mmk
    s_cmp_eq_u32 s19, 1
    s_cbranch_scc1 qkv_mmv
    s_waitcnt vmcnt(8)
    v_mfma_f32_32x32x16_bf16 v[32:47], a[92:95], v[96:99], 0
    buffer_load_dwordx4 v[136:139], v6, s[8:11], s4 offen offset:2048 sc1
    s_waitcnt vmcnt(8)
    v_mfma_f32_32x32x16_bf16 v[32:47], a[96:99], v[100:103], v[32:47]
    buffer_load_dwordx4 v[140:143], v6, s[8:11], s4 offen offset:3072 sc1
    s_waitcnt vmcnt(8)
    v_mfma_f32_32x32x16_bf16 v[32:47], a[100:103], v[104:107], v[32:47]
    s_xor_b32 s42, s3, 3
    s_lshl_b32 s43, s19, 2
    s_add_u32 s42, s42, s43
    s_mul_i32 s42, s42, 28672
    s_add_u32 s6, s42, s26
    s_add_u32 s7, s6, 4096
    buffer_load_dwordx4 a[148:151], v6, s[8:11], s6 offen offset:0
    s_waitcnt vmcnt(8)
    v_mfma_f32_32x32x16_bf16 v[32:47], a[104:107], v[108:111], v[32:47]
    buffer_load_dwordx4 a[152:155], v6, s[8:11], s6 offen offset:1024
    s_waitcnt vmcnt(8)
    v_mfma_f32_32x32x16_bf16 v[32:47], a[108:111], v[112:115], v[32:47]
    buffer_load_dwordx4 a[156:159], v6, s[8:11], s6 offen offset:2048
    s_waitcnt vmcnt(8)
    v_mfma_f32_32x32x16_bf16 v[32:47], a[112:115], v[116:119], v[32:47]
    buffer_load_dwordx4 a[160:163], v6, s[8:11], s6 offen offset:3072
    s_waitcnt vmcnt(8)
    v_mfma_f32_32x32x16_bf16 v[32:47], a[116:119], v[120:123], v[32:47]
    buffer_load_dwordx4 a[164:167], v6, s[8:11], s7 offen offset:0
    v_mfma_f32_32x32x16_bf16 v[48:63], a[120:123], v[96:99], 0
    buffer_load_dwordx4 a[168:171], v6, s[8:11], s7 offen offset:1024
    s_waitcnt vmcnt(6)
    v_add_f32 v128, v128, v136
    v_add_f32 v129, v129, v137
    v_add_f32 v130, v130, v138
    v_add_f32 v131, v131, v139
    v_mfma_f32_32x32x16_bf16 v[48:63], a[124:127], v[100:103], v[48:63]
    buffer_load_dwordx4 a[172:175], v6, s[8:11], s7 offen offset:2048
    v_add_f32 v132, v132, v140
    ds_write_b128 v125, v[32:35] offset:0
    v_mfma_f32_32x32x16_bf16 v[48:63], a[128:131], v[104:107], v[48:63]
    s_xor_b32 s42, s3, 0
    s_lshl_b32 s43, s19, 2
    s_add_u32 s42, s42, s43
    s_mul_i32 s42, s42, 28672
    s_add_u32 s6, s42, s26
    s_add_u32 s7, s6, 4096
    buffer_load_dwordx4 a[176:179], v6, s[8:11], s6 offen offset:0
    v_add_f32 v133, v133, v141
    ds_write_b128 v125, v[36:39] offset:1024
    v_mfma_f32_32x32x16_bf16 v[48:63], a[132:135], v[108:111], v[48:63]
    buffer_load_dwordx4 a[180:183], v6, s[8:11], s6 offen offset:1024
    v_add_f32 v134, v134, v142
    ds_write_b128 v125, v[40:43] offset:2048
    v_mfma_f32_32x32x16_bf16 v[48:63], a[136:139], v[112:115], v[48:63]
    buffer_load_dwordx4 a[184:187], v6, s[8:11], s6 offen offset:2048
    v_add_f32 v135, v135, v143
    ds_write_b128 v125, v[44:47] offset:3072
    v_mfma_f32_32x32x16_bf16 v[48:63], a[140:143], v[116:119], v[48:63]
    buffer_load_dwordx4 a[188:191], v6, s[8:11], s6 offen offset:3072
    v_add_f32 v128, v128, v132
    v_add_f32 v129, v129, v133
    v_add_f32 v130, v130, v134
    v_add_f32 v131, v131, v135
    v_add_f32 v128, v128, v130
    v_mfma_f32_32x32x16_bf16 v[48:63], a[144:147], v[120:123], v[48:63]
    buffer_load_dwordx4 a[192:195], v6, s[8:11], s7 offen offset:0
    v_add_f32 v129, v129, v131
    v_mov_b32 v130, v128
    v_mov_b32 v131, v129
    s_nop 0
    v_permlane32_swap_b32 v128, v130
    v_permlane32_swap_b32 v129, v131
    s_waitcnt vmcnt(11)
    v_mfma_f32_32x32x16_bf16 v[64:79], a[148:151], v[96:99], 0
    buffer_load_dwordx4 a[196:199], v6, s[8:11], s7 offen offset:1024
    v_add_f32 v128, v128, v130
    v_add_f32 v129, v129, v131
    v_mul_f32 v128, 0x3b124925, v128
    v_mul_f32 v129, 0x3b124925, v129
    v_fma_f32 v129, -v128, v128, v129
    s_waitcnt vmcnt(11)
    v_mfma_f32_32x32x16_bf16 v[64:79], a[152:155], v[100:103], v[64:79]
    buffer_load_dwordx4 a[200:203], v6, s[8:11], s7 offen offset:2048
    v_max_f32 v129, 0, v129
    ds_write_b128 v126, v[48:51] offset:4096
    s_waitcnt vmcnt(11)
    v_mfma_f32_32x32x16_bf16 v[64:79], a[156:159], v[104:107], v[64:79]
    v_add_f32 v129, 0x3727c5ac, v129
    ds_write_b128 v126, v[52:55] offset:5120
    s_waitcnt vmcnt(10)
    v_mfma_f32_32x32x16_bf16 v[64:79], a[160:163], v[108:111], v[64:79]
    v_rsq_f32 v10, v129
    ds_write_b128 v126, v[56:59] offset:6144
    s_waitcnt vmcnt(9)
    v_mfma_f32_32x32x16_bf16 v[64:79], a[164:167], v[112:115], v[64:79]
    v_mov_b32 v11, v10
    ds_write_b128 v126, v[60:63] offset:7168
    s_waitcnt vmcnt(8)
    v_mfma_f32_32x32x16_bf16 v[64:79], a[168:171], v[116:119], v[64:79]
    s_waitcnt vmcnt(7)
    v_mfma_f32_32x32x16_bf16 v[64:79], a[172:175], v[120:123], v[64:79]
    s_waitcnt vmcnt(6)
    v_mfma_f32_32x32x16_bf16 v[16:31], a[176:179], v[96:99], 0
    s_waitcnt lgkmcnt(0)
    s_barrier
    ds_read_b128 v[32:35], v12 offset:0
    ds_read_b128 v[36:39], v12 offset:1024
    s_waitcnt vmcnt(5)
    v_mfma_f32_32x32x16_bf16 v[16:31], a[180:183], v[100:103], v[16:31]
    ds_read_b128 v[40:43], v12 offset:2048
    ds_read_b128 v[44:47], v12 offset:3072
    ds_write_b128 v127, v[64:67] offset:8192
    s_waitcnt vmcnt(4)
    v_mfma_f32_32x32x16_bf16 v[16:31], a[184:187], v[104:107], v[16:31]
    ds_read_b128 v[48:51], v12 offset:4096
    ds_read_b128 v[52:55], v12 offset:5120
    ds_write_b128 v127, v[68:71] offset:9216
    s_waitcnt vmcnt(3)
    v_mfma_f32_32x32x16_bf16 v[16:31], a[188:191], v[108:111], v[16:31]
    ds_read_b128 v[56:59], v12 offset:6144
    ds_read_b128 v[60:63], v12 offset:7168
    ds_write_b128 v127, v[72:75] offset:10240
    s_waitcnt vmcnt(2)
    v_mfma_f32_32x32x16_bf16 v[16:31], a[192:195], v[112:115], v[16:31]
    ds_write_b128 v127, v[76:79] offset:11264
    s_waitcnt vmcnt(1)
    v_mfma_f32_32x32x16_bf16 v[16:31], a[196:199], v[116:119], v[16:31]
    s_waitcnt vmcnt(0)
    v_mfma_f32_32x32x16_bf16 v[16:31], a[200:203], v[120:123], v[16:31]
    s_waitcnt lgkmcnt(2)
    v_add_f32 v32, v32, v48
    v_add_f32 v33, v33, v49
    v_add_f32 v34, v34, v50
    v_add_f32 v35, v35, v51
    s_waitcnt lgkmcnt(0)
    s_barrier
    ds_read_b128 v[64:67], v12 offset:8192
    ds_read_b128 v[68:71], v12 offset:9216
    ds_read_b128 v[72:75], v12 offset:10240
    ds_read_b128 v[76:79], v12 offset:11264
    v_add_f32 v36, v36, v52
    v_add_f32 v37, v37, v53
    v_add_f32 v38, v38, v54
    v_add_f32 v39, v39, v55
    v_add_f32 v40, v40, v56
    v_add_f32 v41, v41, v57
    v_add_f32 v42, v42, v58
    v_add_f32 v43, v43, v59
    v_add_f32 v44, v44, v60
    v_add_f32 v45, v45, v61
    v_add_f32 v46, v46, v62
    v_add_f32 v47, v47, v63
    v_mul_f32 v32, v32, v10
    v_mul_f32 v33, v33, v10
    v_mul_f32 v34, v34, v10
    v_mul_f32 v35, v35, v10
    v_mul_f32 v36, v36, v10
    v_mul_f32 v37, v37, v10
    v_mul_f32 v38, v38, v10
    v_mul_f32 v39, v39, v10
    v_mul_f32 v40, v40, v10
    v_mul_f32 v41, v41, v10
    v_mul_f32 v42, v42, v10
    v_mul_f32 v43, v43, v10
    v_mul_f32 v44, v44, v10
    v_mul_f32 v45, v45, v10
    v_mul_f32 v46, v46, v10
    v_mul_f32 v47, v47, v10
    s_waitcnt lgkmcnt(0)
    v_pk_add_f32 v[16:17], v[16:17], v[64:65]
    v_pk_add_f32 v[18:19], v[18:19], v[66:67]
    v_pk_add_f32 v[20:21], v[20:21], v[68:69]
    v_pk_add_f32 v[22:23], v[22:23], v[70:71]
    v_pk_add_f32 v[24:25], v[24:25], v[72:73]
    v_pk_add_f32 v[26:27], v[26:27], v[74:75]
    v_pk_add_f32 v[28:29], v[28:29], v[76:77]
    v_pk_add_f32 v[30:31], v[30:31], v[78:79]
    v_pk_fma_f32 v[16:17], v[16:17], v[10:11], v[32:33]
    v_pk_fma_f32 v[18:19], v[18:19], v[10:11], v[34:35]
    v_pk_fma_f32 v[20:21], v[20:21], v[10:11], v[36:37]
    v_pk_fma_f32 v[22:23], v[22:23], v[10:11], v[38:39]
    v_pk_fma_f32 v[24:25], v[24:25], v[10:11], v[40:41]
    v_pk_fma_f32 v[26:27], v[26:27], v[10:11], v[42:43]
    v_pk_fma_f32 v[28:29], v[28:29], v[10:11], v[44:45]
    v_pk_fma_f32 v[30:31], v[30:31], v[10:11], v[46:47]
    s_branch qkv_red
qkv_mmk:
    s_waitcnt vmcnt(8)
    v_mfma_f32_32x32x16_bf16 v[80:95], a[64:67], v[96:99], 0
    buffer_load_dwordx4 v[136:139], v6, s[8:11], s4 offen offset:2048 sc1
    s_waitcnt vmcnt(8)
    v_mfma_f32_32x32x16_bf16 v[80:95], a[68:71], v[100:103], v[80:95]
    buffer_load_dwordx4 v[140:143], v6, s[8:11], s4 offen offset:3072 sc1
    s_waitcnt vmcnt(8)
    v_mfma_f32_32x32x16_bf16 v[80:95], a[72:75], v[104:107], v[80:95]
    buffer_load_dword v9, v9, s[8:11], s5 offen sc1
    s_waitcnt vmcnt(8)
    v_mfma_f32_32x32x16_bf16 v[80:95], a[76:79], v[108:111], v[80:95]
    s_xor_b32 s42, s3, 3
    s_lshl_b32 s43, s19, 2
    s_add_u32 s42, s42, s43
    s_mul_i32 s42, s42, 28672
    s_add_u32 s6, s42, s26
    s_add_u32 s7, s6, 4096
    buffer_load_dwordx4 a[148:151], v6, s[8:11], s6 offen offset:0
    s_waitcnt vmcnt(8)
    v_mfma_f32_32x32x16_bf16 v[80:95], a[80:83], v[112:115], v[80:95]
    buffer_load_dwordx4 a[152:155], v6, s[8:11], s6 offen offset:1024
    s_waitcnt vmcnt(8)
    v_mfma_f32_32x32x16_bf16 v[80:95], a[84:87], v[116:119], v[80:95]
    buffer_load_dwordx4 a[156:159], v6, s[8:11], s6 offen offset:2048
    s_waitcnt vmcnt(8)
    v_mfma_f32_32x32x16_bf16 v[80:95], a[88:91], v[120:123], v[80:95]
    buffer_load_dwordx4 a[160:163], v6, s[8:11], s6 offen offset:3072
    v_mfma_f32_32x32x16_bf16 v[32:47], a[92:95], v[96:99], 0
    buffer_load_dwordx4 a[164:167], v6, s[8:11], s7 offen offset:0
    s_waitcnt vmcnt(6)
    v_add_f32 v128, v128, v136
    v_add_f32 v129, v129, v137
    v_add_f32 v130, v130, v138
    v_add_f32 v131, v131, v139
    v_mfma_f32_32x32x16_bf16 v[32:47], a[96:99], v[100:103], v[32:47]
    buffer_load_dwordx4 a[168:171], v6, s[8:11], s7 offen offset:1024
    v_add_f32 v132, v132, v140
    v_add_f32 v133, v133, v141
    v_add_f32 v134, v134, v142
    ds_write_b128 v208, v[80:83] offset:0
    v_add_f32 v135, v135, v143
    v_mfma_f32_32x32x16_bf16 v[32:47], a[100:103], v[104:107], v[32:47]
    buffer_load_dwordx4 a[172:175], v6, s[8:11], s7 offen offset:2048
    v_add_f32 v128, v128, v132
    v_add_f32 v129, v129, v133
    ds_write_b128 v208, v[84:87] offset:1024
    v_add_f32 v130, v130, v134
    v_add_f32 v131, v131, v135
    v_mfma_f32_32x32x16_bf16 v[32:47], a[104:107], v[108:111], v[32:47]
    s_xor_b32 s42, s3, 0
    s_lshl_b32 s43, s19, 2
    s_add_u32 s42, s42, s43
    s_mul_i32 s42, s42, 28672
    s_add_u32 s6, s42, s26
    s_add_u32 s7, s6, 4096
    buffer_load_dwordx4 a[176:179], v6, s[8:11], s6 offen offset:0
    v_add_f32 v128, v128, v130
    ds_write_b128 v208, v[88:91] offset:2048
    v_add_f32 v129, v129, v131
    v_mov_b32 v130, v128
    v_mov_b32 v131, v129
    v_mfma_f32_32x32x16_bf16 v[32:47], a[108:111], v[112:115], v[32:47]
    buffer_load_dwordx4 a[180:183], v6, s[8:11], s6 offen offset:1024
    ds_write_b128 v208, v[92:95] offset:3072
    v_permlane32_swap_b32 v128, v130
    v_permlane32_swap_b32 v129, v131
    v_add_f32 v128, v128, v130
    v_add_f32 v129, v129, v131
    v_mfma_f32_32x32x16_bf16 v[32:47], a[112:115], v[116:119], v[32:47]
    buffer_load_dwordx4 a[184:187], v6, s[8:11], s6 offen offset:2048
    v_mul_f32 v128, 0x3b124925, v128
    v_mul_f32 v129, 0x3b124925, v129
    v_fma_f32 v129, -v128, v128, v129
    v_max_f32 v129, 0, v129
    v_add_f32 v129, 0x3727c5ac, v129
    v_mfma_f32_32x32x16_bf16 v[32:47], a[116:119], v[120:123], v[32:47]
    buffer_load_dwordx4 a[188:191], v6, s[8:11], s6 offen offset:3072
    v_rsq_f32 v10, v129
    s_nop 0
    v_mov_b32 v11, v10
    s_waitcnt lgkmcnt(0)
    s_barrier
    ds_read_b128 v[160:163], v209 offset:0
    v_mfma_f32_32x32x16_bf16 v[48:63], a[120:123], v[96:99], 0
    buffer_load_dwordx4 a[192:195], v6, s[8:11], s7 offen offset:0
    ds_read_b128 v[164:167], v209 offset:1024
    ds_read_b128 v[168:171], v209 offset:4096
    ds_read_b128 v[172:175], v209 offset:5120
    ds_read_b128 v[176:179], v209 offset:8192
    ds_read_b128 v[180:183], v209 offset:9216
    v_mfma_f32_32x32x16_bf16 v[48:63], a[124:127], v[100:103], v[48:63]
    buffer_load_dwordx4 a[196:199], v6, s[8:11], s7 offen offset:1024
    ds_read_b128 v[184:187], v209 offset:12288
    ds_read_b128 v[188:191], v209 offset:13312
    v_mfma_f32_32x32x16_bf16 v[48:63], a[128:131], v[104:107], v[48:63]
    buffer_load_dwordx4 a[200:203], v6, s[8:11], s7 offen offset:2048
    v_mfma_f32_32x32x16_bf16 v[48:63], a[132:135], v[108:111], v[48:63]
    s_waitcnt lgkmcnt(4)
    v_add_f32 v160, v160, v168
    v_add_f32 v161, v161, v169
    v_add_f32 v162, v162, v170
    v_add_f32 v163, v163, v171
    v_mfma_f32_32x32x16_bf16 v[48:63], a[136:139], v[112:115], v[48:63]
    v_add_f32 v164, v164, v172
    v_add_f32 v165, v165, v173
    v_add_f32 v166, v166, v174
    v_add_f32 v167, v167, v175
    s_waitcnt lgkmcnt(0)
    v_mfma_f32_32x32x16_bf16 v[48:63], a[140:143], v[116:119], v[48:63]
    v_add_f32 v176, v176, v184
    v_add_f32 v177, v177, v185
    v_add_f32 v178, v178, v186
    v_add_f32 v179, v179, v187
    v_add_f32 v180, v180, v188
    v_mfma_f32_32x32x16_bf16 v[48:63], a[144:147], v[120:123], v[48:63]
    v_add_f32 v181, v181, v189
    v_add_f32 v182, v182, v190
    v_add_f32 v183, v183, v191
    v_add_f32 v160, v160, v176
    v_add_f32 v161, v161, v177
    s_waitcnt vmcnt(13)
    v_mfma_f32_32x32x16_bf16 v[64:79], a[148:151], v[96:99], 0
    v_add_f32 v162, v162, v178
    v_add_f32 v163, v163, v179
    v_add_f32 v164, v164, v180
    v_add_f32 v165, v165, v181
    v_add_f32 v166, v166, v182
    s_waitcnt vmcnt(12)
    v_mfma_f32_32x32x16_bf16 v[64:79], a[152:155], v[100:103], v[64:79]
    v_add_f32 v167, v167, v183
    v_mul_f32 v160, v160, v10
    v_mul_f32 v161, v161, v10
    s_waitcnt vmcnt(14)
    s_mov_b32 exec_hi, 0
    v_cmp_ne_u32 vcc, s23, v9
    s_mov_b32 exec_hi, -1
    s_cmp_eq_u32 vcc_lo, 0
    s_cselect_b32 s38, 1, 0
    s_cselect_b64 s[30:31], s[30:31], 0
    s_not_b64 s[34:35], s[30:31]
    s_waitcnt vmcnt(11)
    v_mfma_f32_32x32x16_bf16 v[64:79], a[156:159], v[104:107], v[64:79]
    v_mul_f32 v162, v162, v10
    v_mul_f32 v163, v163, v10
    v_mul_f32 v164, v164, v10
    v_mul_f32 v165, v165, v10
    v_mul_f32 v166, v166, v10
    s_waitcnt vmcnt(10)
    v_mfma_f32_32x32x16_bf16 v[64:79], a[160:163], v[108:111], v[64:79]
    v_mul_f32 v167, v167, v10
    v_cvt_pk_bf16_f32 v152, v160, v161
    v_cvt_pk_bf16_f32 v153, v162, v163
    v_cvt_pk_bf16_f32 v154, v164, v165
    v_cvt_pk_bf16_f32 v155, v166, v167
    s_waitcnt vmcnt(9)
    v_mfma_f32_32x32x16_bf16 v[64:79], a[164:167], v[112:115], v[64:79]
    v_mov_b32 v156, v154
    v_mov_b32 v157, v155
    s_mov_b64 exec, s[36:37]
    v_mov_b32 v154, 0x3f803f80
    v_mov_b32 v155, 0x00003f80
    s_mov_b64 exec, s[30:31]
    buffer_store_dwordx4 v[152:155], v6, s[8:11], s29 offen
    s_mov_b64 exec, s[34:35]
    buffer_store_dwordx4 v[152:155], v6, s[8:11], s29 offen sc1
    s_mov_b64 exec, -1
    v_mov_b32 v216, 0
    s_waitcnt vmcnt(10)
    v_mfma_f32_32x32x16_bf16 v[64:79], a[168:171], v[116:119], v[64:79]
    v_mov_b32 v217, 0
    v_dot2_f32_bf16 v216, v152, v152, v216
    v_dot2_f32_bf16 v217, v153, v153, v217
    v_dot2_f32_bf16 v216, v156, v156, v216
    v_dot2_f32_bf16 v217, v157, v157, v217
    s_waitcnt vmcnt(9)
    v_mfma_f32_32x32x16_bf16 v[64:79], a[172:175], v[120:123], v[64:79]
    ds_write_b128 v125, v[32:35] offset:0
    s_waitcnt vmcnt(8)
    v_mfma_f32_32x32x16_bf16 v[16:31], a[176:179], v[96:99], 0
    v_add_f32 v216, v216, v217
    ds_write_b128 v125, v[36:39] offset:1024
    s_waitcnt vmcnt(7)
    v_mfma_f32_32x32x16_bf16 v[16:31], a[180:183], v[100:103], v[16:31]
    ds_write_b32 v215, v216
    ds_write_b128 v125, v[40:43] offset:2048
    s_waitcnt vmcnt(6)
    v_mfma_f32_32x32x16_bf16 v[16:31], a[184:187], v[104:107], v[16:31]
    ds_write_b128 v125, v[44:47] offset:3072
    s_waitcnt vmcnt(5)
    v_mfma_f32_32x32x16_bf16 v[16:31], a[188:191], v[108:111], v[16:31]
    ds_write_b128 v126, v[48:51] offset:4096
    s_waitcnt vmcnt(4)
    v_mfma_f32_32x32x16_bf16 v[16:31], a[192:195], v[112:115], v[16:31]
    ds_write_b128 v126, v[52:55] offset:5120
    s_waitcnt vmcnt(3)
    v_mfma_f32_32x32x16_bf16 v[16:31], a[196:199], v[116:119], v[16:31]
    ds_write_b128 v126, v[56:59] offset:6144
    s_waitcnt vmcnt(2)
    v_mfma_f32_32x32x16_bf16 v[16:31], a[200:203], v[120:123], v[16:31]
    ds_write_b128 v126, v[60:63] offset:7168
    ds_write_b128 v127, v[64:67] offset:8192
    ds_write_b128 v127, v[68:71] offset:9216
    s_waitcnt lgkmcnt(2)
    s_barrier
    ds_read_b128 v[32:35], v12 offset:0
    ds_read_b128 v[36:39], v12 offset:1024
    ds_write_b128 v127, v[72:75] offset:10240
    ds_read_b128 v[40:43], v12 offset:2048
    ds_read_b128 v[44:47], v12 offset:3072
    ds_write_b128 v127, v[76:79] offset:11264
    ds_read_b128 v[48:51], v12 offset:4096
    ds_read_b128 v[52:55], v12 offset:5120
    ds_read_b128 v[56:59], v12 offset:6144
    ds_read_b128 v[60:63], v12 offset:7168
    s_waitcnt lgkmcnt(4)
    s_barrier
    ds_read_b128 v[64:67], v12 offset:8192
    ds_read_b128 v[68:71], v12 offset:9216
    ds_read_b128 v[72:75], v12 offset:10240
    ds_read_b128 v[76:79], v12 offset:11264
    s_waitcnt lgkmcnt(4)
    v_add_f32 v32, v32, v48
    v_add_f32 v33, v33, v49
    v_add_f32 v34, v34, v50
    v_add_f32 v35, v35, v51
    v_add_f32 v36, v36, v52
    v_add_f32 v37, v37, v53
    v_add_f32 v38, v38, v54
    v_add_f32 v39, v39, v55
    v_add_f32 v40, v40, v56
    v_add_f32 v41, v41, v57
    v_add_f32 v42, v42, v58
    v_add_f32 v43, v43, v59
    v_add_f32 v44, v44, v60
    v_add_f32 v45, v45, v61
    v_add_f32 v46, v46, v62
    v_add_f32 v47, v47, v63
    v_mul_f32 v32, v32, v10
    v_mul_f32 v33, v33, v10
    v_mul_f32 v34, v34, v10
    v_mul_f32 v35, v35, v10
    v_mul_f32 v36, v36, v10
    v_mul_f32 v37, v37, v10
    v_mul_f32 v38, v38, v10
    v_mul_f32 v39, v39, v10
    v_mul_f32 v40, v40, v10
    v_mul_f32 v41, v41, v10
    v_mul_f32 v42, v42, v10
    v_mul_f32 v43, v43, v10
    v_mul_f32 v44, v44, v10
    v_mul_f32 v45, v45, v10
    v_mul_f32 v46, v46, v10
    v_mul_f32 v47, v47, v10
    s_waitcnt vmcnt(0)
    s_and_b64 exec, s[30:31], 1
    buffer_store_dword v227, v226, s[8:11], s24 offen
    s_and_b64 exec, s[34:35], 1
    buffer_store_dword v227, v226, s[8:11], s24 offen sc1
    s_mov_b64 exec, -1
    s_waitcnt lgkmcnt(0)
    v_pk_add_f32 v[16:17], v[16:17], v[64:65]
    v_pk_add_f32 v[18:19], v[18:19], v[66:67]
    v_pk_add_f32 v[20:21], v[20:21], v[68:69]
    v_pk_add_f32 v[22:23], v[22:23], v[70:71]
    v_pk_add_f32 v[24:25], v[24:25], v[72:73]
    v_pk_add_f32 v[26:27], v[26:27], v[74:75]
    v_pk_add_f32 v[28:29], v[28:29], v[76:77]
    v_pk_add_f32 v[30:31], v[30:31], v[78:79]
    v_pk_fma_f32 v[16:17], v[16:17], v[10:11], v[32:33]
    v_pk_fma_f32 v[18:19], v[18:19], v[10:11], v[34:35]
    v_pk_fma_f32 v[20:21], v[20:21], v[10:11], v[36:37]
    v_pk_fma_f32 v[22:23], v[22:23], v[10:11], v[38:39]
    v_pk_fma_f32 v[24:25], v[24:25], v[10:11], v[40:41]
    v_pk_fma_f32 v[26:27], v[26:27], v[10:11], v[42:43]
    v_pk_fma_f32 v[28:29], v[28:29], v[10:11], v[44:45]
    v_pk_fma_f32 v[30:31], v[30:31], v[10:11], v[46:47]
    s_branch qkv_red
qkv_mmv:
    s_waitcnt vmcnt(8)
    v_mfma_f32_32x32x16_bf16 v[80:95], v[96:99], a[64:67], 0
    buffer_load_dwordx4 v[136:139], v6, s[8:11], s4 offen offset:2048 sc1
    s_waitcnt vmcnt(8)
    v_mfma_f32_32x32x16_bf16 v[80:95], v[100:103], a[68:71], v[80:95]
    buffer_load_dwordx4 v[140:143], v6, s[8:11], s4 offen offset:3072 sc1
    s_waitcnt vmcnt(8)
    v_mfma_f32_32x32x16_bf16 v[80:95], v[104:107], a[72:75], v[80:95]
    buffer_load_dword v9, v9, s[8:11], s5 offen sc1
    s_waitcnt vmcnt(8)
    v_mfma_f32_32x32x16_bf16 v[80:95], v[108:111], a[76:79], v[80:95]
    s_xor_b32 s42, s3, 3
    s_lshl_b32 s43, s19, 2
    s_add_u32 s42, s42, s43
    s_mul_i32 s42, s42, 28672
    s_add_u32 s6, s42, s26
    s_add_u32 s7, s6, 4096
    buffer_load_dwordx4 a[148:151], v6, s[8:11], s6 offen offset:0
    s_waitcnt vmcnt(8)
    v_mfma_f32_32x32x16_bf16 v[80:95], v[112:115], a[80:83], v[80:95]
    buffer_load_dwordx4 a[152:155], v6, s[8:11], s6 offen offset:1024
    s_waitcnt vmcnt(8)
    v_mfma_f32_32x32x16_bf16 v[80:95], v[116:119], a[84:87], v[80:95]
    buffer_load_dwordx4 a[156:159], v6, s[8:11], s6 offen offset:2048
    s_waitcnt vmcnt(8)
    v_mfma_f32_32x32x16_bf16 v[80:95], v[120:123], a[88:91], v[80:95]
    buffer_load_dwordx4 a[160:163], v6, s[8:11], s6 offen offset:3072
    v_mfma_f32_32x32x16_bf16 v[32:47], a[92:95], v[96:99], 0
    buffer_load_dwordx4 a[164:167], v6, s[8:11], s7 offen offset:0
    s_waitcnt vmcnt(6)
    v_add_f32 v128, v128, v136
    v_add_f32 v129, v129, v137
    v_add_f32 v130, v130, v138
    v_add_f32 v131, v131, v139
    v_mfma_f32_32x32x16_bf16 v[32:47], a[96:99], v[100:103], v[32:47]
    buffer_load_dwordx4 a[168:171], v6, s[8:11], s7 offen offset:1024
    v_add_f32 v132, v132, v140
    v_add_f32 v133, v133, v141
    v_add_f32 v134, v134, v142
    ds_write_b128 v208, v[80:83] offset:0
    v_add_f32 v135, v135, v143
    v_mfma_f32_32x32x16_bf16 v[32:47], a[100:103], v[104:107], v[32:47]
    buffer_load_dwordx4 a[172:175], v6, s[8:11], s7 offen offset:2048
    v_add_f32 v128, v128, v132
    v_add_f32 v129, v129, v133
    ds_write_b128 v208, v[84:87] offset:1024
    v_add_f32 v130, v130, v134
    v_add_f32 v131, v131, v135
    v_mfma_f32_32x32x16_bf16 v[32:47], a[104:107], v[108:111], v[32:47]
    s_xor_b32 s42, s3, 0
    s_lshl_b32 s43, s19, 2
    s_add_u32 s42, s42, s43
    s_mul_i32 s42, s42, 28672
    s_add_u32 s6, s42, s26
    s_add_u32 s7, s6, 4096
    buffer_load_dwordx4 a[176:179], v6, s[8:11], s6 offen offset:0
    v_add_f32 v128, v128, v130
    ds_write_b128 v208, v[88:91] offset:2048
    v_add_f32 v129, v129, v131
    v_mov_b32 v130, v128
    v_mov_b32 v131, v129
    v_mfma_f32_32x32x16_bf16 v[32:47], a[108:111], v[112:115], v[32:47]
    buffer_load_dwordx4 a[180:183], v6, s[8:11], s6 offen offset:1024
    ds_write_b128 v208, v[92:95] offset:3072
    v_permlane32_swap_b32 v128, v130
    v_permlane32_swap_b32 v129, v131
    v_add_f32 v128, v128, v130
    v_add_f32 v129, v129, v131
    v_mfma_f32_32x32x16_bf16 v[32:47], a[112:115], v[116:119], v[32:47]
    buffer_load_dwordx4 a[184:187], v6, s[8:11], s6 offen offset:2048
    v_mul_f32 v128, 0x3b124925, v128
    v_mul_f32 v129, 0x3b124925, v129
    v_fma_f32 v129, -v128, v128, v129
    v_max_f32 v129, 0, v129
    v_add_f32 v129, 0x3727c5ac, v129
    v_mfma_f32_32x32x16_bf16 v[32:47], a[116:119], v[120:123], v[32:47]
    buffer_load_dwordx4 a[188:191], v6, s[8:11], s6 offen offset:3072
    v_rsq_f32 v10, v129
    s_nop 0
    v_mov_b32 v11, v10
    ds_write_b32 v212, v10
    s_waitcnt lgkmcnt(0)
    s_barrier
    v_mfma_f32_32x32x16_bf16 v[48:63], a[120:123], v[96:99], 0
    buffer_load_dwordx4 a[192:195], v6, s[8:11], s7 offen offset:0
    ds_read_b128 v[160:163], v209 offset:0
    ds_read_b128 v[164:167], v209 offset:1024
    ds_read_b128 v[168:171], v209 offset:4096
    ds_read_b128 v[172:175], v209 offset:5120
    ds_read_b128 v[176:179], v209 offset:8192
    v_mfma_f32_32x32x16_bf16 v[48:63], a[124:127], v[100:103], v[48:63]
    buffer_load_dwordx4 a[196:199], v6, s[8:11], s7 offen offset:1024
    ds_read_b128 v[180:183], v209 offset:9216
    ds_read_b128 v[184:187], v209 offset:12288
    ds_read_b128 v[188:191], v209 offset:13312
    ds_read_b128 v[216:219], v213 offset:0
    ds_read_b128 v[220:223], v213 offset:32
    v_mfma_f32_32x32x16_bf16 v[48:63], a[128:131], v[104:107], v[48:63]
    buffer_load_dwordx4 a[200:203], v6, s[8:11], s7 offen offset:2048
    v_mfma_f32_32x32x16_bf16 v[48:63], a[132:135], v[108:111], v[48:63]
    v_mfma_f32_32x32x16_bf16 v[48:63], a[136:139], v[112:115], v[48:63]
    s_waitcnt lgkmcnt(6)
    v_add_f32 v160, v160, v168
    v_add_f32 v161, v161, v169
    v_add_f32 v162, v162, v170
    v_add_f32 v163, v163, v171
    v_mfma_f32_32x32x16_bf16 v[48:63], a[140:143], v[116:119], v[48:63]
    v_add_f32 v164, v164, v172
    v_add_f32 v165, v165, v173
    v_add_f32 v166, v166, v174
    v_add_f32 v167, v167, v175
    s_waitcnt lgkmcnt(2)
    v_mfma_f32_32x32x16_bf16 v[48:63], a[144:147], v[120:123], v[48:63]
    v_add_f32 v176, v176, v184
    v_add_f32 v177, v177, v185
    v_add_f32 v178, v178, v186
    v_add_f32 v179, v179, v187
    v_add_f32 v180, v180, v188
    s_waitcnt vmcnt(13)
    v_mfma_f32_32x32x16_bf16 v[64:79], a[148:151], v[96:99], 0
    v_add_f32 v181, v181, v189
    v_add_f32 v182, v182, v190
    v_add_f32 v183, v183, v191
    v_add_f32 v160, v160, v176
    v_add_f32 v161, v161, v177
    s_waitcnt vmcnt(12)
    v_mfma_f32_32x32x16_bf16 v[64:79], a[152:155], v[100:103], v[64:79]
    v_add_f32 v162, v162, v178
    v_add_f32 v163, v163, v179
    v_add_f32 v164, v164, v180
    v_add_f32 v165, v165, v181
    v_add_f32 v166, v166, v182
    s_waitcnt vmcnt(11)
    v_mfma_f32_32x32x16_bf16 v[64:79], a[156:159], v[104:107], v[64:79]
    v_add_f32 v167, v167, v183
    s_waitcnt lgkmcnt(0)
    s_waitcnt vmcnt(14)
    s_mov_b32 exec_hi, 0
    v_cmp_ne_u32 vcc, s23, v9
    s_mov_b32 exec_hi, -1
    s_cmp_eq_u32 vcc_lo, 0
    s_cselect_b32 s38, 1, 0
    s_cselect_b64 s[30:31], s[30:31], 0
    s_not_b64 s[34:35], s[30:31]
    v_fma_f32 v160, v160, v216, v214
    s_waitcnt vmcnt(10)
    v_mfma_f32_32x32x16_bf16 v[64:79], a[160:163], v[108:111], v[64:79]
    v_fma_f32 v161, v161, v217, v214
    v_fma_f32 v162, v162, v218, v214
    v_fma_f32 v163, v163, v219, v214
    v_fma_f32 v164, v164, v220, v214
    v_fma_f32 v165, v165, v221, v214
    s_waitcnt vmcnt(9)
    v_mfma_f32_32x32x16_bf16 v[64:79], a[164:167], v[112:115], v[64:79]
    v_fma_f32 v166, v166, v222, v214
    v_fma_f32 v167, v167, v223, v214
    v_cvt_pk_bf16_f32 v152, v160, v161
    v_cvt_pk_bf16_f32 v153, v162, v163
    v_cvt_pk_bf16_f32 v154, v164, v165
    s_waitcnt vmcnt(8)
    v_mfma_f32_32x32x16_bf16 v[64:79], a[168:171], v[116:119], v[64:79]
    v_cvt_pk_bf16_f32 v155, v166, v167
    ds_write_b128 v125, v[32:35] offset:0
    s_waitcnt vmcnt(7)
    v_mfma_f32_32x32x16_bf16 v[64:79], a[172:175], v[120:123], v[64:79]
    s_mov_b64 exec, s[30:31]
    buffer_store_dwordx4 v[152:155], v6, s[8:11], s29 offen
    s_mov_b64 exec, s[34:35]
    buffer_store_dwordx4 v[152:155], v6, s[8:11], s29 offen sc1
    s_mov_b64 exec, -1
    ds_write_b128 v125, v[36:39] offset:1024
    s_waitcnt vmcnt(6)
    v_mfma_f32_32x32x16_bf16 v[16:31], a[176:179], v[96:99], 0
    ds_write_b128 v125, v[40:43] offset:2048
    s_waitcnt vmcnt(7)
    v_mfma_f32_32x32x16_bf16 v[16:31], a[180:183], v[100:103], v[16:31]
    ds_write_b128 v125, v[44:47] offset:3072
    s_waitcnt vmcnt(6)
    v_mfma_f32_32x32x16_bf16 v[16:31], a[184:187], v[104:107], v[16:31]
    ds_write_b128 v126, v[48:51] offset:4096
    s_waitcnt vmcnt(5)
    v_mfma_f32_32x32x16_bf16 v[16:31], a[188:191], v[108:111], v[16:31]
    ds_write_b128 v126, v[52:55] offset:5120
    s_waitcnt vmcnt(4)
    v_mfma_f32_32x32x16_bf16 v[16:31], a[192:195], v[112:115], v[16:31]
    ds_write_b128 v126, v[56:59] offset:6144
    s_waitcnt vmcnt(3)
    v_mfma_f32_32x32x16_bf16 v[16:31], a[196:199], v[116:119], v[16:31]
    ds_write_b128 v126, v[60:63] offset:7168
    s_waitcnt vmcnt(2)
    v_mfma_f32_32x32x16_bf16 v[16:31], a[200:203], v[120:123], v[16:31]
    ds_write_b128 v127, v[64:67] offset:8192
    ds_write_b128 v127, v[68:71] offset:9216
    s_waitcnt lgkmcnt(2)
    s_barrier
    ds_read_b128 v[32:35], v12 offset:0
    ds_read_b128 v[36:39], v12 offset:1024
    ds_write_b128 v127, v[72:75] offset:10240
    ds_read_b128 v[40:43], v12 offset:2048
    ds_read_b128 v[44:47], v12 offset:3072
    ds_write_b128 v127, v[76:79] offset:11264
    ds_read_b128 v[48:51], v12 offset:4096
    ds_read_b128 v[52:55], v12 offset:5120
    ds_read_b128 v[56:59], v12 offset:6144
    ds_read_b128 v[60:63], v12 offset:7168
    s_waitcnt lgkmcnt(4)
    s_barrier
    ds_read_b128 v[64:67], v12 offset:8192
    ds_read_b128 v[68:71], v12 offset:9216
    ds_read_b128 v[72:75], v12 offset:10240
    ds_read_b128 v[76:79], v12 offset:11264
    s_waitcnt lgkmcnt(4)
    v_add_f32 v32, v32, v48
    v_add_f32 v33, v33, v49
    v_add_f32 v34, v34, v50
    v_add_f32 v35, v35, v51
    v_add_f32 v36, v36, v52
    v_add_f32 v37, v37, v53
    v_add_f32 v38, v38, v54
    v_add_f32 v39, v39, v55
    v_add_f32 v40, v40, v56
    v_add_f32 v41, v41, v57
    v_add_f32 v42, v42, v58
    v_add_f32 v43, v43, v59
    v_add_f32 v44, v44, v60
    v_add_f32 v45, v45, v61
    v_add_f32 v46, v46, v62
    v_add_f32 v47, v47, v63
    v_mul_f32 v32, v32, v10
    v_mul_f32 v33, v33, v10
    v_mul_f32 v34, v34, v10
    v_mul_f32 v35, v35, v10
    v_mul_f32 v36, v36, v10
    v_mul_f32 v37, v37, v10
    v_mul_f32 v38, v38, v10
    v_mul_f32 v39, v39, v10
    v_mul_f32 v40, v40, v10
    v_mul_f32 v41, v41, v10
    v_mul_f32 v42, v42, v10
    v_mul_f32 v43, v43, v10
    v_mul_f32 v44, v44, v10
    v_mul_f32 v45, v45, v10
    v_mul_f32 v46, v46, v10
    v_mul_f32 v47, v47, v10
    s_waitcnt vmcnt(0)
    s_and_b64 exec, s[30:31], 1
    buffer_store_dword v227, v226, s[8:11], s24 offen
    s_and_b64 exec, s[34:35], 1
    buffer_store_dword v227, v226, s[8:11], s24 offen sc1
    s_mov_b64 exec, -1
    s_waitcnt lgkmcnt(0)
    v_pk_add_f32 v[16:17], v[16:17], v[64:65]
    v_pk_add_f32 v[18:19], v[18:19], v[66:67]
    v_pk_add_f32 v[20:21], v[20:21], v[68:69]
    v_pk_add_f32 v[22:23], v[22:23], v[70:71]
    v_pk_add_f32 v[24:25], v[24:25], v[72:73]
    v_pk_add_f32 v[26:27], v[26:27], v[74:75]
    v_pk_add_f32 v[28:29], v[28:29], v[76:77]
    v_pk_add_f32 v[30:31], v[30:31], v[78:79]
    v_pk_fma_f32 v[16:17], v[16:17], v[10:11], v[32:33]
    v_pk_fma_f32 v[18:19], v[18:19], v[10:11], v[34:35]
    v_pk_fma_f32 v[20:21], v[20:21], v[10:11], v[36:37]
    v_pk_fma_f32 v[22:23], v[22:23], v[10:11], v[38:39]
    v_pk_fma_f32 v[24:25], v[24:25], v[10:11], v[40:41]
    v_pk_fma_f32 v[26:27], v[26:27], v[10:11], v[42:43]
    v_pk_fma_f32 v[28:29], v[28:29], v[10:11], v[44:45]
    v_pk_fma_f32 v[30:31], v[30:31], v[10:11], v[46:47]
qkv_red:
    v_cvt_pk_bf16_f32 v144, v16, v17
    v_cvt_pk_bf16_f32 v145, v18, v19
    v_cvt_pk_bf16_f32 v146, v20, v21
    v_cvt_pk_bf16_f32 v147, v22, v23
    v_cvt_pk_bf16_f32 v148, v24, v25
    v_cvt_pk_bf16_f32 v149, v26, v27
    v_cvt_pk_bf16_f32 v150, v28, v29
    v_cvt_pk_bf16_f32 v151, v30, v31
    ds_write_b128 v12, v[144:147]
    v_mov_b32 v132, 0
    v_mov_b32 v133, 0
    v_dot2_f32_bf16 v132, v144, v144, v132
    v_dot2_f32_bf16 v133, v145, v145, v133
    v_dot2_f32_bf16 v132, v146, v146, v132
    v_dot2_f32_bf16 v133, v147, v147, v133
    v_dot2_f32_bf16 v132, v148, v148, v132
    v_dot2_f32_bf16 v133, v149, v149, v133
    v_dot2_f32_bf16 v132, v150, v150, v132
    v_dot2_f32_bf16 v133, v151, v151, v133
    s_nop 2
    v_add_f32 v132, v132, v133
    v_mov_b32 v133, v132
    s_nop 1
    v_permlane32_swap_b32 v132, v133
    v_add_f32 v132, v132, v133
    v_sqrt_f32 v132, v132
    s_nop 0
    v_mul_f32 v132, 0x3f8147ae, v132
    s_mov_b32 exec_lo, 0
    v_cvt_pk_bf16_f32 v150, v132, 0
    s_mov_b32 exec_lo, -1
    ds_write_b128 v12, v[148:151] offset:1024
    s_lshl_b32 s29, s16, 3
    s_lshl_b32 s42, s3, 1
    s_add_u32 s29, s29, s42
    v_bfe_u32 v15, v0, 2, 1
    v_and_b32 v13, 56, v0
    v_add3_u32 v8, v15, v13, s29
    v_and_b32 v8, 63, v8
    v_and_b32 v13, 3, v0
    v_lshlrev_b32 v13, 2, v13
    v_mul_u32_u24 v8, 4352, v8
    v_add_u32 v8, v8, v13
    s_mul_i32 s42, s39, 278528
    s_add_u32 s42, s42, 42729472
    v_add_u32 v8, s42, v8
    s_lshl_b32 s42, s16, 5
    s_add_u32 s42, s42, s17
    s_lshl_b32 s42, s42, 7
    s_add_u32 s42, s42, 41959424
    v_writelane_b32 v8, s42, 0
    s_lshl_b32 s31, s29, 12
    v_lshrrev_b32 v7, 2, v6
    s_lshl_b32 s30, s29, 7
    s_add_u32 s30, s30, s0
    s_add_u32 s30, s30, 3072
    v_lshl_add_u32 v15, v15, 7, v13
    buffer_load_dword v232, v15, s[8:11], s30 offen sc1
    s_waitcnt lgkmcnt(0)
    s_barrier
    ds_read_b128 v[16:19], v127 offset:0
    ds_read_b128 v[20:23], v127 offset:1024
    ds_read_b128 v[24:27], v126 offset:0
    ds_read_b128 v[28:31], v126 offset:1024
    ds_read_b128 v[32:35], v125 offset:0
    ds_read_b128 v[36:39], v125 offset:1024
    ds_read_b128 v[40:43], v12 offset:0
    ds_read_b128 v[44:47], v12 offset:1024
    s_cmp_lg_u32 s19, 0
    s_cbranch_scc1 qkv_nn
    s_cmp_lg_u32 s3, 2
    s_cbranch_scc1 qkv_nn
    ds_read2_b32 v[220:221], v210 offset0:0 offset1:32
    ds_read2_b32 v[222:223], v210 offset0:64 offset1:96
    s_waitcnt lgkmcnt(0)
    v_add_f32 v220, v220, v221
    v_add_f32 v222, v222, v223
    v_add_f32 v220, v220, v222
    s_nop 1
    v_max_f32_dpp v220, v220, v220 row_shr:1 row_mask:0xf bank_mask:0xf
    s_nop 1
    v_max_f32_dpp v220, v220, v220 row_shr:2 row_mask:0xf bank_mask:0xf
    s_nop 1
    v_max_f32_dpp v220, v220, v220 row_shr:4 row_mask:0xf bank_mask:0xf
    s_nop 1
    v_max_f32_dpp v220, v220, v220 row_shr:8 row_mask:0xf bank_mask:0xf
    s_nop 0
    v_readlane_b32 s42, v220, 15
    v_readlane_b32 s43, v220, 31
    s_nop 0
    s_max_u32 s42, s42, s43
    v_sqrt_f32 v220, s42
    s_nop 0
    v_mul_f32 v220, 0x3f8147ae, v220
    v_or_b32 v220, 1, v220
    s_mov_b64 exec, 1
    buffer_store_dword v220, v226, s[8:11], s25 offen sc1
    s_mov_b64 exec, -1
qkv_nn:
    s_getreg_b32 s37, hwreg(HW_REG_XCC_ID)
    s_and_b32 s37, s37, 15
    s_add_u32 s37, s37, 1
    s_lshl_b32 s36, s16, 12
    s_add_u32 s36, s36, 41959424
    s_lshl_b32 s32, s19, 2
    s_add_u32 s32, s32, s3
    s_min_u32 s42, s32, 13
    s_lshl_b32 s24, s42, 15
    s_add_u32 s24, s24, 524288
    s_mul_i32 s34, s18, 28672
    s_lshl_b32 s42, s42, 11
    s_add_u32 s34, s34, s42
    v_and_b32 v3, 31, v0
    v_bfe_u32 v4, v0, 5, 1
    v_lshlrev_b32 v9, 7, v3
    v_lshlrev_b32 v10, 3, v6
    v_min_u32 v10, 5504, v10
    s_lshr_b32 s42, s42, 12
    s_lshl_b32 s43, s18, 3
    s_add_u32 s42, s42, s43
    s_lshl_b32 s42, s42, 9
    s_add_u32 s42, s42, 42462208
    s_lshr_b32 s43, s17, 4
    s_lshl_b32 s43, s43, 2
    s_add_u32 s43, s43, s3
    s_lshl_b32 s44, s16, 3
    s_add_u32 s43, s43, s44
    s_lshl_b32 s43, s43, 4
    s_and_b32 s44, s17, 15
    s_add_u32 s43, s43, s44
    s_mul_i32 s44, s43, 2048
    s_mul_i32 s43, s43, 3072
    s_add_u32 s43, s43, s20
    s_add_u32 s44, s44, s20
    s_add_u32 s43, s43, 6815744
    s_add_u32 s44, s44, 9958400
    v_lshrrev_b32 v13, 4, v6
    v_min_u32 v13, 43, v13
    v_mov_b32 v5, s42
    v_max_u32 v13, 40, v13
    v_lshl_add_u32 v5, v13, 7, v5
    s_lshr_b32 s42, s17, 2
    s_min_u32 s42, s42, 6
    s_mul_i32 s35, s42, 229376
    s_mul_i32 s43, s3, 57344
    s_add_u32 s35, s35, s43
    s_add_u32 s35, s35, 4325376
    s_and_b32 s43, s3, 1
    s_lshl_b32 s43, s43, 10
    v_add_u32 v238, s43, v6
    v_xor_b32 v239, 1024, v238
    s_waitcnt lgkmcnt(0)
    s_barrier
    s_waitcnt vmcnt(0)
    v_cmp_eq_u32 vcc, 0, v232
    s_cbranch_vccnz pk_slow59
pk_back59:
    s_add_u32 s23, s31, s28
    s_mov_b32 s44, 0xffffff00
    s_mov_b32 s45, -1
    buffer_load_dwordx4 v[160:163], v6, s[8:11], s23 offen offset:0
    buffer_load_dwordx4 v[164:167], v6, s[8:11], s23 offen offset:1024
    buffer_load_dwordx4 v[168:171], v6, s[8:11], s23 offen offset:2048
    buffer_load_dwordx4 v[172:175], v6, s[8:11], s23 offen offset:3072
    s_add_u32 s23, s23, 4096
    buffer_load_dwordx4 v[176:179], v6, s[8:11], s23 offen offset:0
    buffer_load_dwordx4 v[180:183], v6, s[8:11], s23 offen offset:1024
    buffer_load_dwordx4 v[184:187], v6, s[8:11], s23 offen offset:2048
    buffer_load_dwordx4 v[188:191], v6, s[8:11], s23 offen offset:3072
    s_add_u32 s23, s23, 4096
    s_branch att_go
l0_go:
    s_mov_b32 s39, 0
    s_add_u32 s0, s0, 0x10000
    s_mov_b32 s28, 8388608
    s_mov_b32 s40, 41942784
    s_lshl_b32 s29, s16, 3
    s_lshl_b32 s42, s3, 1
    s_add_u32 s29, s29, s42
    v_bfe_u32 v15, v0, 2, 1
    v_and_b32 v13, 56, v0
    v_add3_u32 v8, v15, v13, s29
    v_and_b32 v8, 63, v8
    v_and_b32 v13, 3, v0
    v_lshlrev_b32 v13, 2, v13
    v_mul_u32_u24 v8, 4352, v8
    v_add_u32 v8, v8, v13
    s_mul_i32 s42, s39, 278528
    s_add_u32 s42, s42, 42729472
    v_add_u32 v8, s42, v8
    s_lshl_b32 s42, s16, 5
    s_add_u32 s42, s42, s17
    s_lshl_b32 s42, s42, 7
    s_add_u32 s42, s42, 41959424
    v_writelane_b32 v8, s42, 0
    s_lshl_b32 s31, s29, 12
    v_lshrrev_b32 v7, 2, v6
    s_add_u32 s23, s31, s28
    buffer_load_dwordx4 v[160:163], v6, s[8:11], s23 offen offset:0
    buffer_load_dwordx4 v[164:167], v6, s[8:11], s23 offen offset:1024
    buffer_load_dwordx4 v[168:171], v6, s[8:11], s23 offen offset:2048
    buffer_load_dwordx4 v[172:175], v6, s[8:11], s23 offen offset:3072
    s_add_u32 s23, s23, 4096
    buffer_load_dwordx4 v[176:179], v6, s[8:11], s23 offen offset:0
    buffer_load_dwordx4 v[180:183], v6, s[8:11], s23 offen offset:1024
    buffer_load_dwordx4 v[184:187], v6, s[8:11], s23 offen offset:2048
    buffer_load_dwordx4 v[188:191], v6, s[8:11], s23 offen offset:3072
    s_add_u32 s23, s23, 4096
    s_getreg_b32 s37, hwreg(HW_REG_XCC_ID)
    s_and_b32 s37, s37, 15
    s_add_u32 s37, s37, 1
    s_lshl_b32 s36, s16, 12
    s_add_u32 s36, s36, 41959424
    s_lshl_b32 s32, s19, 2
    s_add_u32 s32, s32, s3
    s_min_u32 s42, s32, 13
    s_lshl_b32 s24, s42, 15
    s_add_u32 s24, s24, 524288
    s_mul_i32 s34, s18, 28672
    s_lshl_b32 s42, s42, 11
    s_add_u32 s34, s34, s42
    v_and_b32 v3, 31, v0
    v_bfe_u32 v4, v0, 5, 1
    v_lshlrev_b32 v9, 7, v3
    v_lshlrev_b32 v10, 3, v6
    v_min_u32 v10, 5504, v10
    s_lshr_b32 s42, s42, 12
    s_lshl_b32 s43, s18, 3
    s_add_u32 s42, s42, s43
    s_lshl_b32 s42, s42, 9
    s_add_u32 s42, s42, 42462208
    s_lshr_b32 s43, s17, 4
    s_lshl_b32 s43, s43, 2
    s_add_u32 s43, s43, s3
    s_lshl_b32 s44, s16, 3
    s_add_u32 s43, s43, s44
    s_lshl_b32 s43, s43, 4
    s_and_b32 s44, s17, 15
    s_add_u32 s43, s43, s44
    s_mul_i32 s44, s43, 2048
    s_mul_i32 s43, s43, 3072
    s_add_u32 s43, s43, s20
    s_add_u32 s44, s44, s20
    s_add_u32 s43, s43, 6815744
    s_add_u32 s44, s44, 9958400
    v_lshrrev_b32 v13, 4, v6
    v_min_u32 v13, 43, v13
    v_mov_b32 v5, s42
    v_max_u32 v13, 40, v13
    v_lshl_add_u32 v5, v13, 7, v5
    s_lshr_b32 s42, s17, 2
    s_min_u32 s42, s42, 6
    s_mul_i32 s35, s42, 229376
    s_mul_i32 s43, s3, 57344
    s_add_u32 s35, s35, s43
    s_add_u32 s35, s35, 4325376
    s_and_b32 s43, s3, 1
    s_lshl_b32 s43, s43, 10
    v_add_u32 v238, s43, v6
    v_xor_b32 v239, 1024, v238
    s_waitcnt lgkmcnt(0)
    v_mov_b32 v1, s4
    v_add_f32 v1, s5, v1
    v_sqrt_f32 v1, v1
    s_nop 0
    v_mul_f32 v1, 0x3fc00000, v1
    s_nop 0
    v_readfirstlane_b32 s22, v1
    s_mov_b32 s44, 0xffffff00
    s_mov_b32 s45, -1
    s_waitcnt vmcnt(8)
    s_branch att_go
main_end:
    s_endpgm
pk_slow8:
    s_mov_b32 s41, 200000
pk_loop8:
    s_mov_b32 exec_lo, 0xff00
    s_mov_b32 exec_hi, 0x0
    buffer_load_dword v232, v8, s[8:11], 0 offen sc1
    s_mov_b64 exec, -1
    s_sub_u32 s41, s41, 1
    s_cmp_eq_u32 s41, 0
    s_cbranch_scc1 pk_back8
    s_waitcnt vmcnt(0)
    v_cmp_eq_u32 s[44:45], 0, v232
    s_nop 0
    s_and_b32 s42, s44, 0xff00
    s_cbranch_scc1 pk_loop8
    s_branch pk_back8
pk_slow9:
    s_mov_b32 s41, 200000
pk_loop9:
    s_mov_b32 exec_lo, 0xff0000
    s_mov_b32 exec_hi, 0x0
    buffer_load_dword v232, v8, s[8:11], 0 offen sc1
    s_mov_b64 exec, -1
    s_sub_u32 s41, s41, 1
    s_cmp_eq_u32 s41, 0
    s_cbranch_scc1 pk_back9
    s_waitcnt vmcnt(0)
    v_cmp_eq_u32 s[44:45], 0, v232
    s_nop 0
    s_and_b32 s42, s44, 0xff0000
    s_cbranch_scc1 pk_loop9
    s_branch pk_back9
pk_slow10:
    s_mov_b32 s41, 200000
pk_loop10:
    s_mov_b32 exec_lo, 0xff000000
    s_mov_b32 exec_hi, 0x0
    buffer_load_dword v232, v8, s[8:11], 0 offen sc1
    s_mov_b64 exec, -1
    s_sub_u32 s41, s41, 1
    s_cmp_eq_u32 s41, 0
    s_cbranch_scc1 pk_back10
    s_waitcnt vmcnt(0)
    v_cmp_eq_u32 s[44:45], 0, v232
    s_nop 0
    s_and_b32 s42, s44, 0xff000000
    s_cbranch_scc1 pk_loop10
    s_branch pk_back10
pk_slow11:
    s_mov_b32 s41, 200000
pk_loop11:
    s_mov_b32 exec_lo, 0x0
    s_mov_b32 exec_hi, 0xff
    buffer_load_dword v232, v8, s[8:11], 0 offen sc1
    s_mov_b64 exec, -1
    s_sub_u32 s41, s41, 1
    s_cmp_eq_u32 s41, 0
    s_cbranch_scc1 pk_back11
    s_waitcnt vmcnt(0)
    v_cmp_eq_u32 s[44:45], 0, v232
    s_nop 0
    s_and_b32 s42, s45, 0xff
    s_cbranch_scc1 pk_loop11
    s_branch pk_back11
pk_slow12:
    s_mov_b32 s41, 200000
pk_loop12:
    s_mov_b32 exec_lo, 0x0
    s_mov_b32 exec_hi, 0xff00
    buffer_load_dword v232, v8, s[8:11], 0 offen sc1
    s_mov_b64 exec, -1
    s_sub_u32 s41, s41, 1
    s_cmp_eq_u32 s41, 0
    s_cbranch_scc1 pk_back12
    s_waitcnt vmcnt(0)
    v_cmp_eq_u32 s[44:45], 0, v232
    s_nop 0
    s_and_b32 s42, s45, 0xff00
    s_cbranch_scc1 pk_loop12
    s_branch pk_back12
pk_slow13:
    s_mov_b32 s41, 200000
pk_loop13:
    s_mov_b32 exec_lo, 0x0
    s_mov_b32 exec_hi, 0xff0000
    buffer_load_dword v232, v8, s[8:11], 0 offen sc1
    s_mov_b64 exec, -1
    s_sub_u32 s41, s41, 1
    s_cmp_eq_u32 s41, 0
    s_cbranch_scc1 pk_back13
    s_waitcnt vmcnt(0)
    v_cmp_eq_u32 s[44:45], 0, v232
    s_nop 0
    s_and_b32 s42, s45, 0xff0000
    s_cbranch_scc1 pk_loop13
    s_branch pk_back13
pk_slow14:
    s_mov_b32 s41, 200000
pk_loop14:
    s_mov_b32 exec_lo, 0x0
    s_mov_b32 exec_hi, 0xff000000
    buffer_load_dword v232, v8, s[8:11], 0 offen sc1
    s_mov_b64 exec, -1
    s_sub_u32 s41, s41, 1
    s_cmp_eq_u32 s41, 0
    s_cbranch_scc1 pk_back14
    s_waitcnt vmcnt(0)
    v_cmp_eq_u32 s[44:45], 0, v232
    s_nop 0
    s_and_b32 s42, s45, 0xff000000
    s_cbranch_scc1 pk_loop14
    s_branch pk_back14
fc_slow15:
    s_mov_b32 s41, 200000
fc_loop15:
    buffer_load_dword v232, v7, s[8:11], s40 offen sc1
    s_sub_u32 s41, s41, 1
    s_cmp_eq_u32 s41, 0
    s_cbranch_scc1 fc_back15
    s_waitcnt vmcnt(0)
    v_cmp_eq_u32 vcc, 0, v232
    s_cbranch_vccnz fc_loop15
    s_branch fc_back15
wf_slow17:
    buffer_store_dword v10, v11, s[8:11], s30 offen sc1
    s_branch wf_done17
wf_slow21:
    buffer_store_dword v10, v11, s[8:11], s29 offen sc1
    s_branch wf_done21
fl_slow26:
    buffer_store_dword v252, v251, s[8:11], s42 offen sc1
    s_branch fl_done26
fl_slow29:
    buffer_store_dword v252, v251, s[8:11], s42 offen sc1
    s_branch fl_done29
ck_slow30:
    s_add_u32 s42, s36, 0
    s_mov_b32 s41, 200000
ck_loop30:
    buffer_load_dword v9, v250, s[8:11], s42 offen sc1
    s_sub_u32 s41, s41, 1
    s_cmp_eq_u32 s41, 0
    s_cbranch_scc1 ck_done30
    s_waitcnt vmcnt(0)
    v_cmp_ne_u32 vcc, 1, v9
    s_cbranch_vccnz ck_loop30
    s_branch ck_done30
ck_slow33:
    s_add_u32 s42, s36, 512
    s_mov_b32 s41, 200000
ck_loop33:
    buffer_load_dword v9, v250, s[8:11], s42 offen sc1
    s_sub_u32 s41, s41, 1
    s_cmp_eq_u32 s41, 0
    s_cbranch_scc1 ck_done33
    s_waitcnt vmcnt(0)
    v_cmp_ne_u32 vcc, 1, v9
    s_cbranch_vccnz ck_loop33
    s_branch ck_done33
fl_slow34:
    buffer_store_dword v252, v251, s[8:11], s42 offen sc1
    s_branch fl_done34
ck_slow35:
    s_add_u32 s42, s36, 1024
    s_mov_b32 s41, 200000
ck_loop35:
    buffer_load_dword v9, v250, s[8:11], s42 offen sc1
    s_sub_u32 s41, s41, 1
    s_cmp_eq_u32 s41, 0
    s_cbranch_scc1 ck_done35
    s_waitcnt vmcnt(0)
    v_cmp_ne_u32 vcc, 1, v9
    s_cbranch_vccnz ck_loop35
    s_branch ck_done35
wf_slow55:
    buffer_store_dword v252, v41, s[8:11], s24 offen sc1
    s_branch wf_done55
fl_slow56:
    buffer_store_dword v252, v251, s[8:11], s42 offen sc1
    s_branch fl_done56
pk_slow59:
    s_mov_b32 s41, 200000
pk_loop59:
    buffer_load_dword v232, v15, s[8:11], s30 offen sc1
    s_sub_u32 s41, s41, 1
    s_cmp_eq_u32 s41, 0
    s_cbranch_scc1 pk_back59
    s_waitcnt vmcnt(0)
    v_cmp_eq_u32 vcc, 0, v232
    s_cbranch_vccnz pk_loop59
    s_branch pk_back59
attn_fallback:
    s_waitcnt vmcnt(0) lgkmcnt(0)
    s_nop 15
    s_nop 7
    s_mov_b32 exec_lo, 0
    v_mov_b32 v22, 0
    v_mov_b32 v23, 0
    v_mov_b32 v30, 0
    v_mov_b32 v31, 0
    v_mov_b32 v38, 0
    v_mov_b32 v39, 0
    v_mov_b32 v46, 0
    v_mov_b32 v47, 0
    s_mov_b32 exec_lo, -1
    v_mov_b32 v12, 0xff800000
    v_mov_b32 v13, 0xff800000
    v_mov_b32 v14, 0xff800000
    v_mov_b32 v15, 0xff800000
    s_lshl_b32 s33, s3, 13
    s_add_u32 s33, s33, s28
    s_mov_b32 s44, 16
attn_fb_loop:
    buffer_load_dwordx4 v[244:247], v6, s[8:11], s33 offen
    buffer_load_dwordx4 v[248:251], v6, s[8:11], s33 offen offset:1024
    s_bitcmp1_b32 s44, 0
    s_cselect_b32 s42, 24576, 0
    s_add_u32 s33, s33, s42
    s_add_u32 s33, s33, 4096
    s_waitcnt vmcnt(0)
    v_mfma_f32_32x32x16_bf16 v[112:127], v[244:247], v[16:19], 0
    v_mfma_f32_32x32x16_bf16 v[112:127], v[248:251], v[20:23], v[112:127]
    s_nop 11
    v_max3_f32 v12, v112, v113, v12
    v_max3_f32 v12, v114, v115, v12
    v_max3_f32 v12, v116, v117, v12
    v_max3_f32 v12, v118, v119, v12
    v_max3_f32 v12, v120, v121, v12
    v_max3_f32 v12, v122, v123, v12
    v_max3_f32 v12, v124, v125, v12
    v_max3_f32 v12, v126, v127, v12
    v_mfma_f32_32x32x16_bf16 v[112:127], v[244:247], v[24:27], 0
    v_mfma_f32_32x32x16_bf16 v[112:127], v[248:251], v[28:31], v[112:127]
    s_nop 11
    v_max3_f32 v13, v112, v113, v13
    v_max3_f32 v13, v114, v115, v13
    v_max3_f32 v13, v116, v117, v13
    v_max3_f32 v13, v118, v119, v13
    v_max3_f32 v13, v120, v121, v13
    v_max3_f32 v13, v122, v123, v13
    v_max3_f32 v13, v124, v125, v13
    v_max3_f32 v13, v126, v127, v13
    v_mfma_f32_32x32x16_bf16 v[112:127], v[244:247], v[32:35], 0
    v_mfma_f32_32x32x16_bf16 v[112:127], v[248:251], v[36:39], v[112:127]
    s_nop 11
    v_max3_f32 v14, v112, v113, v14
    v_max3_f32 v14, v114, v115, v14
    v_max3_f32 v14, v116, v117, v14
    v_max3_f32 v14, v118, v119, v14
    v_max3_f32 v14, v120, v121, v14
    v_max3_f32 v14, v122, v123, v14
    v_max3_f32 v14, v124, v125, v14
    v_max3_f32 v14, v126, v127, v14
    v_mfma_f32_32x32x16_bf16 v[112:127], v[244:247], v[40:43], 0
    v_mfma_f32_32x32x16_bf16 v[112:127], v[248:251], v[44:47], v[112:127]
    s_nop 11
    v_max3_f32 v15, v112, v113, v15
    v_max3_f32 v15, v114, v115, v15
    v_max3_f32 v15, v116, v117, v15
    v_max3_f32 v15, v118, v119, v15
    v_max3_f32 v15, v120, v121, v15
    v_max3_f32 v15, v122, v123, v15
    v_max3_f32 v15, v124, v125, v15
    v_max3_f32 v15, v126, v127, v15
    s_sub_u32 s44, s44, 1
    s_cmp_lg_u32 s44, 0
    s_cbranch_scc1 attn_fb_loop
    s_nop 7
    v_mov_b32 v240, v12
    v_mov_b32 v241, v13
    v_mov_b32 v242, v14
    v_mov_b32 v243, v15
    v_permlane32_swap_b32 v12, v240
    v_permlane32_swap_b32 v13, v241
    v_permlane32_swap_b32 v14, v242
    v_permlane32_swap_b32 v15, v243
    v_max_f32 v12, v12, v240
    v_max_f32 v13, v13, v241
    v_max_f32 v14, v14, v242
    v_max_f32 v15, v15, v243
    v_and_b32 v240, 31, v0
    v_lshlrev_b32 v240, 2, v240
    v_add_u32 v240, 114688, v240
    s_xor_b32 s42, s3, 3
    s_lshl_b32 s42, s42, 7
    v_add_u32 v244, s42, v240
    s_lshl_b32 s42, s3, 9
    v_add_u32 v241, s42, v244
    ds_write_b32 v241, v12
    s_xor_b32 s42, s3, 2
    s_lshl_b32 s42, s42, 7
    v_add_u32 v245, s42, v240
    s_lshl_b32 s42, s3, 9
    v_add_u32 v241, s42, v245
    ds_write_b32 v241, v13
    s_xor_b32 s42, s3, 1
    s_lshl_b32 s42, s42, 7
    v_add_u32 v246, s42, v240
    s_lshl_b32 s42, s3, 9
    v_add_u32 v241, s42, v246
    ds_write_b32 v241, v14
    s_xor_b32 s42, s3, 0
    s_lshl_b32 s42, s42, 7
    v_add_u32 v247, s42, v240
    s_lshl_b32 s42, s3, 9
    v_add_u32 v241, s42, v247
    ds_write_b32 v241, v15
    s_waitcnt lgkmcnt(0)
    s_barrier
    ds_read_b32 v248, v244 offset:0
    ds_read_b32 v249, v244 offset:512
    ds_read_b32 v250, v244 offset:1024
    ds_read_b32 v251, v244 offset:1536
    s_waitcnt lgkmcnt(0)
    v_max3_f32 v12, v248, v249, v250
    v_max_f32 v12, v12, v251
    ds_read_b32 v248, v245 offset:0
    ds_read_b32 v249, v245 offset:512
    ds_read_b32 v250, v245 offset:1024
    ds_read_b32 v251, v245 offset:1536
    s_waitcnt lgkmcnt(0)
    v_max3_f32 v13, v248, v249, v250
    v_max_f32 v13, v13, v251
    ds_read_b32 v248, v246 offset:0
    ds_read_b32 v249, v246 offset:512
    ds_read_b32 v250, v246 offset:1024
    ds_read_b32 v251, v246 offset:1536
    s_waitcnt lgkmcnt(0)
    v_max3_f32 v14, v248, v249, v250
    v_max_f32 v14, v14, v251
    ds_read_b32 v248, v247 offset:0
    ds_read_b32 v249, v247 offset:512
    ds_read_b32 v250, v247 offset:1024
    ds_read_b32 v251, v247 offset:1536
    s_waitcnt lgkmcnt(0)
    v_max3_f32 v15, v248, v249, v250
    v_max_f32 v15, v15, v251
    s_barrier
    s_mov_b32 exec_lo, 0
    v_sub_f32 v12, 0, v12
    v_and_b32 v240, 0xffff0000, v12
    v_sub_f32 v12, v12, v240
    v_and_b32 v241, 0xffff0000, v12
    v_sub_f32 v12, v12, v241
    v_lshrrev_b32 v240, 16, v240
    v_or_b32 v22, v240, v241
    v_lshrrev_b32 v23, 16, v12
    v_sub_f32 v13, 0, v13
    v_and_b32 v240, 0xffff0000, v13
    v_sub_f32 v13, v13, v240
    v_and_b32 v241, 0xffff0000, v13
    v_sub_f32 v13, v13, v241
    v_lshrrev_b32 v240, 16, v240
    v_or_b32 v30, v240, v241
    v_lshrrev_b32 v31, 16, v13
    v_sub_f32 v14, 0, v14
    v_and_b32 v240, 0xffff0000, v14
    v_sub_f32 v14, v14, v240
    v_and_b32 v241, 0xffff0000, v14
    v_sub_f32 v14, v14, v241
    v_lshrrev_b32 v240, 16, v240
    v_or_b32 v38, v240, v241
    v_lshrrev_b32 v39, 16, v14
    v_sub_f32 v15, 0, v15
    v_and_b32 v240, 0xffff0000, v15
    v_sub_f32 v15, v15, v240
    v_and_b32 v241, 0xffff0000, v15
    v_sub_f32 v15, v15, v241
    v_lshrrev_b32 v240, 16, v240
    v_or_b32 v46, v240, v241
    v_lshrrev_b32 v47, 16, v15
    s_mov_b32 exec_lo, -1
    v_lshlrev_b32 v9, 7, v3
    v_mov_b32 v234, 0
    s_mov_b32 s22, 0
    s_lshl_b32 s31, s29, 12
    s_add_u32 s23, s31, s28
    s_mov_b64 s[44:45], 0
    v_mov_b32 v232, 1
    buffer_load_dwordx4 v[160:163], v6, s[8:11], s23 offen offset:0
    buffer_load_dwordx4 v[164:167], v6, s[8:11], s23 offen offset:1024
    buffer_load_dwordx4 v[168:171], v6, s[8:11], s23 offen offset:2048
    buffer_load_dwordx4 v[172:175], v6, s[8:11], s23 offen offset:3072
    s_add_u32 s23, s23, 4096
    buffer_load_dwordx4 v[176:179], v6, s[8:11], s23 offen offset:0
    buffer_load_dwordx4 v[180:183], v6, s[8:11], s23 offen offset:1024
    buffer_load_dwordx4 v[184:187], v6, s[8:11], s23 offen offset:2048
    buffer_load_dwordx4 v[188:191], v6, s[8:11], s23 offen offset:3072
    s_add_u32 s23, s23, 4096
    s_branch attn_main
code_end:
.section .rodata,"a"
.p2align 6
.amdhsa_kernel pq_kernel
  .amdhsa_next_free_vgpr 256
  .amdhsa_next_free_sgpr 102
  .amdhsa_accum_offset 256
  .amdhsa_group_segment_fixed_size 0
  .amdhsa_kernarg_size 96
  .amdhsa_user_sgpr_count 2
  .amdhsa_user_sgpr_kernarg_segment_ptr 1
  .amdhsa_system_sgpr_workgroup_id_x 1
.end_amdhsa_kernel
.p2align 6
.amdhsa_kernel main0_kernel
  .amdhsa_next_free_vgpr 512
  .amdhsa_next_free_sgpr 102
  .amdhsa_accum_offset 256
  .amdhsa_group_segment_fixed_size 0
  .amdhsa_kernarg_size 96
  .amdhsa_user_sgpr_count 2
  .amdhsa_user_sgpr_kernarg_segment_ptr 1
  .amdhsa_system_sgpr_workgroup_id_x 1
.end_amdhsa_kernel
```
